```python
import torch

def _softmax(x, axis=-1):
    return torch.softmax(x, dim=axis)
def _gelu(x):
    return torch.nn.functional.gelu(x, approximate="tanh")
def _silu(x):
    return torch.nn.functional.silu(x)
def _sigmoid(x):
    return torch.sigmoid(x)
def _layernorm(x, axis=-1, eps=1e-5):
    m = x.mean(dim=axis, keepdim=True)
    v = x.var(dim=axis, keepdim=True, unbiased=False)
    return (x - m) / torch.sqrt(v + eps)
def _scatter_add(tgt, idx, src, axis=0):
    return tgt.clone().index_add_(axis, idx, src)
def _segment_sum(src, seg, n):
    out = torch.zeros((n,) + src.shape[1:], dtype=src.dtype)
    return out.index_add_(0, seg, src)
def _pad(x, pw):
    flat = tuple(v for pair in reversed(pw) for v in pair)
    return torch.nn.functional.pad(x, flat)

kernel_name = 'recurrent_scan__mha_block_cached__dense_activation_silu__prompt'

def setup_inputs():

    _w = (lambda a: (lambda t: t.to(torch.bfloat16) if t.is_floating_point() else t)(torch.as_tensor(a)))
    def _A_setup():
        B, Sq, D = 1, 2048, 512
        H, Sk, Dh = 32, 2048, 128
        return {
            "x": _w((lambda *s: torch.randn(*s, dtype=torch.bfloat16) * 0.05)(B, Sq, D)),
            "k_cache": _w((lambda *s: torch.randn(*s, dtype=torch.bfloat16) * 3.2)(B, H, Sk, Dh)),
            "v_cache": _w((lambda *s: torch.randn(*s, dtype=torch.bfloat16) * 3.2)(B, H, Sk, Dh)),
            "wq": _w((lambda *s: torch.randn(*s, dtype=torch.bfloat16) * 3.2)(D, H * Dh) * (D ** -0.5)),
            "wo": _w((lambda *s: torch.randn(*s, dtype=torch.bfloat16) * 3.2)(H * Dh, D) * ((H * Dh) ** -0.5)),
        }
    _A_in = _A_setup()

    def _B_setup():
        B, S, D, F = 1, 2048, 512, 1792
        return {
            "x": _w((lambda *s: torch.randn(*s, dtype=torch.bfloat16) * 0.05)(B, S, D)),
            "w1": _w((lambda *s: torch.randn(*s, dtype=torch.bfloat16) * 3.2)(D, F) * (D ** -0.5)),
            "w2": _w((lambda *s: torch.randn(*s, dtype=torch.bfloat16) * 0.4)(F, D) * (F ** -0.5)),
        }
    _B_in = _B_setup()

    return {
        "A_x": _A_in["x"],
        "A_k_cache": _A_in["k_cache"],
        "A_v_cache": _A_in["v_cache"],
        "A_wq": _A_in["wq"],
        "A_wo": _A_in["wo"],
        "B_x": _B_in["x"],
        "B_w1": _B_in["w1"],
        "B_w2": _B_in["w2"],
    }

def reference(A_x, A_k_cache, A_v_cache, A_wq, A_wo, B_x, B_w1, B_w2):
    def _A_ref(x, k_cache, v_cache, wq, wo):
        B, Sq, D = x.shape
        H, Dh = 32, 128
        q = (lambda x, *d: x.permute(*d))((x @ wq).reshape(B, Sq, H, Dh), 0, 2, 1, 3)
        scores = torch.einsum("bhqd,bhkd->bhqk", q, k_cache) * (Dh ** -0.5)
        p = _softmax(scores, axis=-1)
        o = torch.einsum("bhqk,bhkd->bhqd", p, v_cache)
        return (lambda x, *d: x.permute(*d))(o, 0, 2, 1, 3).reshape(B, Sq, H * Dh) @ wo

    def _B_ref(x, w1, w2):
        h = torch.einsum("bsd,df->bsf", x, w1)
        h = _silu(h)
        out = torch.einsum("bsf,fd->bsd", h, w2)
        return out

    x = A_x
    xn = _layernorm(x, axis=-1)
    s = _A_ref(xn, A_k_cache, A_v_cache, A_wq, A_wo)
    g = _silu(_B_ref(xn, B_w1, B_w2))
    return x + s * g
```

```asm
; @launch grid=(256,1,1) block=(256,1,1) lds=163840
.amdgcn_target "amdgcn-amd-amdhsa--gfx950"
.text
.p2align 12
.globl recurrent_scan__mha_block_cached__dense_activation_silu__prompt_kernel
.p2align 8
.type recurrent_scan__mha_block_cached__dense_activation_silu__prompt_kernel,@function
recurrent_scan__mha_block_cached__dense_activation_silu__prompt_kernel:
    s_cmp_ge_u32 s2, 256
    s_cbranch_scc1 main_done
    s_load_dwordx4 s[48:51], s[0:1], 8
    s_load_dwordx2 s[52:53], s[0:1], 24
    s_load_dwordx2 s[54:55], s[0:1], 48
    s_load_dwordx2 s[56:57], s[0:1], 80
    s_load_dwordx2 s[62:63], s[0:1], 72
    s_load_dwordx2 s[84:85], s[0:1], 0
    s_load_dwordx2 s[86:87], s[0:1], 32
    s_load_dwordx4 s[88:91], s[0:1], 56
    v_lshrrev_b32 v1, 6, v0
    v_and_b32 v0, 63, v0
    s_and_b32 s3, s2, 7
    s_lshr_b32 s40, s2, 3
    v_readfirstlane_b32 s34, v1
    s_lshr_b32 s41, s3, 2
    s_lshl_b32 s41, s41, 3
    s_and_b32 s72, s40, 7
    s_add_u32 s72, s72, s41
    s_lshl_b32 s72, s72, 1
    s_and_b32 s41, s3, 1
    s_add_u32 s72, s72, s41
    s_lshr_b32 s41, s40, 3
    s_lshl_b32 s73, s41, 1
    s_bfe_u32 s43, s3, 65537
    s_add_u32 s73, s73, s43
    s_lshl_b32 s41, s41, 3
    s_add_u32 s32, s41, s3
    s_and_b32 s33, s40, 7
    s_lshl_b32 s35, s34, 12
    s_lshl_b32 s36, s34, 11
    s_mov_b32 s46, 0x3e0293ee
    s_mov_b32 s47, 0xbfb8aa3b
    s_mov_b32 s42, 0
    s_lshr_b32 s99, s2, 3
    s_and_b32 s99, s99, 3
    s_lshl_b32 s99, s99, 2
    s_add_u32 s99, s99, s34
    s_mov_b32 s98, 1
    s_cmp_eq_u32 s99, 0
    s_cbranch_scc1 wpad0
    s_cmp_eq_u32 s99, 1
    s_cbranch_scc1 wpad1
    s_cmp_eq_u32 s99, 2
    s_cbranch_scc1 wpad2
    s_cmp_eq_u32 s99, 3
    s_cbranch_scc1 wpad3
    s_cmp_eq_u32 s99, 4
    s_cbranch_scc1 wpad4
    s_cmp_eq_u32 s99, 5
    s_cbranch_scc1 wpad5
    s_cmp_eq_u32 s99, 6
    s_cbranch_scc1 wpad6
    s_cmp_eq_u32 s99, 7
    s_cbranch_scc1 wpad7
    s_cmp_eq_u32 s99, 8
    s_cbranch_scc1 wpad8
    s_cmp_eq_u32 s99, 9
    s_cbranch_scc1 wpad9
    s_cmp_eq_u32 s99, 10
    s_cbranch_scc1 wpad10
    s_cmp_eq_u32 s99, 11
    s_cbranch_scc1 wpad11
    s_cmp_eq_u32 s99, 12
    s_cbranch_scc1 wpad12
    s_cmp_eq_u32 s99, 13
    s_cbranch_scc1 wpad13
WARMA_done:
    s_mov_b32 s98, 0
    v_lshlrev_b32 v19, 4, v0
    v_lshrrev_b32 v32, 5, v0
    v_and_b32 v33, 15, v0
    v_lshrrev_b32 v34, 4, v0
    v_lshrrev_b32 v35, 2, v33
    v_and_b32 v36, 3, v0
    v_and_b32 v37, 1, v34
    v_lshrrev_b32 v1, 3, v0
    s_lshl_b32 s3, s34, 4
    v_add_u32 v1, s3, v1
    v_and_b32 v38, 7, v0
    v_lshlrev_b32 v39, 2, v37
    v_xor_b32 v38, v38, v39
    v_lshlrev_b32 v38, 4, v38
    v_mul_u32_u24 v39, 3584, v1
    v_add_u32 v30, v39, v38
    v_lshl_add_u32 v31, v1, 13, v38
    s_waitcnt lgkmcnt(0)
    s_lshl_b32 s3, s32, 8
    s_add_u32 s12, s52, s3
    s_addc_u32 s13, s53, 0
    s_sub_u32 s14, 4194304, s3
    s_mov_b32 s15, 0x20000
    s_min_u32 s3, s32, 27
    s_lshl_b32 s3, s3, 7
    s_add_u32 s24, s54, s3
    s_addc_u32 s25, s55, 0
    s_sub_u32 s26, 1835008, s3
    s_mov_b32 s27, 0x20000
    s_lshl_b32 s40, s33, 3
    s_lshl_b32 s41, s34, 1
    s_add_u32 s43, s40, s41
    s_lshl_b32 s3, s43, 15
    s_add_u32 s16, s84, s3
    s_addc_u32 s17, s85, 0
    s_mov_b32 s18, 0x10000
    s_mov_b32 s19, 0x20000
    s_lshl_b32 s3, s43, 18
    s_lshl_b32 s41, s32, 13
    s_add_u32 s3, s3, s41
    s_add_u32 s3, s3, 10485760
    s_add_u32 s20, s56, s3
    s_addc_u32 s21, s57, 0
    s_mov_b32 s22, 270336
    s_mov_b32 s23, 0x20000
    s_mul_i32 s3, s43, 114688
    s_lshl_b32 s41, s32, 12
    s_add_u32 s3, s3, s41
    s_add_u32 s3, s3, 2097152
    s_add_u32 s28, s56, s3
    s_addc_u32 s29, s57, 0
    s_cmp_lt_u32 s32, 28
    s_cselect_b32 s30, 118784, 0
    s_mov_b32 s31, 0x20000
    s_lshl_b32 s101, s34, 13
    s_lshl_b32 s3, s33, 8
    s_lshl_b32 s41, s32, 3
    s_add_u32 s3, s3, s41
    s_lshl_b32 s41, s34, 1
    s_add_u32 s3, s3, s41
    v_add_u32 v211, s3, v32
    v_and_b32 v210, 31, v0
    v_lshlrev_b32 v210, 5, v210
    v_lshl_add_u32 v210, v211, 10, v210
    v_and_b32 v38, 7, v0
    v_xor_b32 v38, v38, v34
    v_lshlrev_b32 v38, 4, v38
    v_lshrrev_b32 v39, 3, v0
    v_lshl_add_u32 v214, v39, 10, v38
    v_xor_b32 v215, 64, v214
    global_load_dwordx4 v[184:187], v210, s[84:85]
    global_load_dwordx4 v[188:191], v210, s[84:85] offset:16
    s_add_u32 m0, s36, 65536
    s_mov_b32 s40, 0
    buffer_load_dwordx4 v30, s[24:27], s40 offen offset:0 lds
    s_mov_b32 s40, 27648
    buffer_load_dwordx4 v30, s[24:27], s40 offen offset:1024 lds
    s_add_u32 m0, s36, 73728
    s_mov_b32 s40, 0
    buffer_load_dwordx4 v31, s[12:15], s40 offen offset:0 lds
    s_mov_b32 s40, 64512
    buffer_load_dwordx4 v31, s[12:15], s40 offen offset:1024 lds
    s_add_u32 m0, s101, 0
    s_mov_b32 s40, 0
    buffer_load_dwordx4 v214, s[16:19], s40 offen offset:0 lds
    s_mov_b32 s40, 7168
    buffer_load_dwordx4 v215, s[16:19], s40 offen offset:1024 lds
    s_mov_b32 s40, 14336
    buffer_load_dwordx4 v214, s[16:19], s40 offen offset:2048 lds
    s_mov_b32 s40, 21504
    buffer_load_dwordx4 v215, s[16:19], s40 offen offset:3072 lds
    s_add_u32 m0, s101, 4096
    s_mov_b32 s40, 32768
    buffer_load_dwordx4 v214, s[16:19], s40 offen offset:0 lds
    s_mov_b32 s40, 39936
    buffer_load_dwordx4 v215, s[16:19], s40 offen offset:1024 lds
    s_mov_b32 s40, 47104
    buffer_load_dwordx4 v214, s[16:19], s40 offen offset:2048 lds
    s_mov_b32 s40, 54272
    buffer_load_dwordx4 v215, s[16:19], s40 offen offset:3072 lds
    s_add_u32 m0, s36, 81920
    s_mov_b32 s40, 229376
    buffer_load_dwordx4 v30, s[24:27], s40 offen offset:0 lds
    s_mov_b32 s40, 257024
    buffer_load_dwordx4 v30, s[24:27], s40 offen offset:1024 lds
    s_add_u32 m0, s36, 90112
    s_mov_b32 s40, 524288
    buffer_load_dwordx4 v31, s[12:15], s40 offen offset:0 lds
    s_mov_b32 s40, 588800
    buffer_load_dwordx4 v31, s[12:15], s40 offen offset:1024 lds
    s_add_u32 m0, s101, 32768
    s_mov_b32 s40, 128
    buffer_load_dwordx4 v214, s[16:19], s40 offen offset:0 lds
    s_mov_b32 s40, 7296
    buffer_load_dwordx4 v215, s[16:19], s40 offen offset:1024 lds
    s_mov_b32 s40, 14464
    buffer_load_dwordx4 v214, s[16:19], s40 offen offset:2048 lds
    s_mov_b32 s40, 21632
    buffer_load_dwordx4 v215, s[16:19], s40 offen offset:3072 lds
    s_add_u32 m0, s101, 36864
    s_mov_b32 s40, 32896
    buffer_load_dwordx4 v214, s[16:19], s40 offen offset:0 lds
    s_mov_b32 s40, 40064
    buffer_load_dwordx4 v215, s[16:19], s40 offen offset:1024 lds
    s_mov_b32 s40, 47232
    buffer_load_dwordx4 v214, s[16:19], s40 offen offset:2048 lds
    s_mov_b32 s40, 54400
    buffer_load_dwordx4 v215, s[16:19], s40 offen offset:3072 lds
    s_lshl_b32 s3, s32, 19
    s_add_u32 s4, s48, s3
    s_addc_u32 s5, s49, 0
    s_mov_b32 s6, 0x80000
    s_mov_b32 s7, 0x20000
    s_add_u32 s8, s50, s3
    s_addc_u32 s9, s51, 0
    s_mov_b32 s10, 0x80000
    s_mov_b32 s11, 0x20000
    s_add_u32 s80, s56, 33554432
    s_addc_u32 s81, s57, 0
    s_mov_b32 s82, 6029312
    s_mov_b32 s83, 0x20000
    s_mov_b32 s55, 0x20000
    s_cmp_ge_u32 s34, 2
    s_cbranch_scc1 wp_w2
    s_mov_b32 s52, s86
    s_mov_b32 s53, s87
    s_mov_b32 s54, 4194304
    s_lshl_b32 s3, s2, 1
    s_add_u32 s3, s3, s34
    s_lshl_b32 s48, s3, 13
    s_mov_b32 s49, 2048
    s_add_u32 s50, s48, 6144
    s_lshr_b32 s40, s3, 7
    s_mul_i32 s40, s40, 188416
    s_and_b32 s3, s3, 127
    s_lshl_b32 s3, s3, 10
    s_add_u32 s3, s3, s40
    s_add_u32 s51, s3, 57344
    s_mov_b32 s92, 256
    s_add_u32 s93, s51, 768
    s_branch wp_set
wp_w2:
    s_mov_b32 s52, s88
    s_mov_b32 s53, s89
    s_mov_b32 s54, 1835008
    s_lshl_b32 s3, s2, 1
    s_add_u32 s3, s3, s34
    s_sub_u32 s3, s3, 2
    s_add_u32 s94, s3, 512
    s_cmp_lt_u32 s94, 896
    s_cselect_b32 s94, s94, s3
    s_lshl_b32 s48, s3, 11
    s_lshl_b32 s50, s94, 11
    s_sub_u32 s49, s50, s48
    s_mul_i32 s41, s3, 4682
    s_lshr_b32 s41, s41, 20
    s_mul_i32 s40, s41, 224
    s_sub_u32 s40, s3, s40
    s_lshl_b32 s40, s40, 8
    s_mul_i32 s41, s41, 188416
    s_add_u32 s51, s40, s41
    s_mul_i32 s41, s94, 4682
    s_lshr_b32 s41, s41, 20
    s_mul_i32 s40, s41, 224
    s_sub_u32 s40, s94, s40
    s_lshl_b32 s40, s40, 8
    s_mul_i32 s41, s41, 188416
    s_add_u32 s93, s40, s41
    s_sub_u32 s92, s93, s51
wp_set:
    v_lshl_add_u32 v38, v37, 1, v32
    v_xor_b32 v38, v38, v33
    v_lshlrev_b32 v38, 4, v38
    v_lshl_add_u32 v2, v33, 8, v38
    v_xor_b32 v3, 64, v2
    v_xor_b32 v4, 128, v2
    v_xor_b32 v5, 192, v2
    v_and_b32 v38, 1, v35
    v_lshrrev_b32 v39, 1, v35
    v_lshl_add_u32 v38, v39, 2, v38
    v_lshl_add_u32 v38, v37, 3, v38
    v_and_b32 v39, 2, v36
    v_xor_b32 v38, v38, v39
    v_lshlrev_b32 v38, 4, v38
    v_and_b32 v39, 1, v36
    v_lshl_add_u32 v38, v39, 3, v38
    v_lshl_add_u32 v39, v34, 2, v35
    v_lshl_add_u32 v38, v39, 8, v38
    v_add_u32 v6, 65536, v38
    v_xor_b32 v7, 16, v6
    v_xor_b32 v8, 64, v6
    v_xor_b32 v9, 80, v6
    v_xor_b32 v10, 128, v6
    v_xor_b32 v11, 144, v6
    v_xor_b32 v12, 192, v6
    v_xor_b32 v13, 208, v6
    v_lshl_add_u32 v38, v32, 3, v35
    v_lshlrev_b32 v39, 8, v34
    v_add_u32 v39, s35, v39
    v_add_u32 v1, 0, v34
    v_xor_b32 v1, v1, v33
    v_lshl_add_u32 v14, v1, 4, v39
    v_add_u32 v1, 4, v34
    v_xor_b32 v1, v1, v33
    v_lshl_add_u32 v15, v1, 4, v39
    v_add_u32 v1, 8, v34
    v_xor_b32 v1, v1, v33
    v_lshl_add_u32 v16, v1, 4, v39
    v_add_u32 v1, 12, v34
    v_xor_b32 v1, v1, v33
    v_lshl_add_u32 v17, v1, 4, v39
    v_lshl_add_u32 v1, v32, 2, v37
    v_xor_b32 v1, v1, v33
    v_lshl_add_u32 v18, v1, 4, v39
    v_lshlrev_b32 v39, 7, v38
    v_lshl_add_u32 v39, v37, 5, v39
    v_lshrrev_b32 v1, 1, v35
    v_lshl_add_u32 v41, v1, 6, v39
    v_xor_b32 v1, 1, v1
    v_lshl_add_u32 v42, v1, 6, v39
    v_lshlrev_b32 v43, 3, v36
    v_add_u32 v43, 65536, v43
    v_add_u32 v24, v41, v43
    v_add_u32 v25, v42, v43
    v_and_b32 v1, 1, v36
    v_lshlrev_b32 v1, 1, v1
    v_lshrrev_b32 v43, 1, v36
    v_or_b32 v1, v1, v43
    v_lshlrev_b32 v43, 3, v1
    v_add_u32 v26, v41, v43
    v_add_u32 v27, v42, v43
    v_add_u32 v28, 98304, v26
    v_add_u32 v29, 98304, v27
    v_add_u32 v26, 73728, v26
    v_add_u32 v27, 73728, v27
    s_bitcmp1_b32 s34, 0
    s_cselect_b64 vcc, -1, 0
    v_cndmask_b32 v41, v24, v25, vcc
    v_cndmask_b32 v42, v26, v27, vcc
    s_cmp_lt_u32 s34, 2
    s_cselect_b64 vcc, -1, 0
    v_cndmask_b32 v168, v42, v41, vcc
    v_and_b32 v41, 31, v0
    v_bfe_u32 v42, v0, 1, 3
    v_xor_b32 v42, v42, v32
    v_lshlrev_b32 v42, 4, v42
    v_lshl_add_u32 v42, v41, 7, v42
    v_add_u32 v160, s101, v42
    v_mov_b32 v180, 0
    v_mov_b32 v181, 0
    s_and_b32 s3, s33, 3
    s_lshl_b32 s3, s3, 6
    s_lshr_b32 s41, s33, 2
    s_lshl2_add_u32 s3, s41, s3
    s_add_u32 s3, s3, 40
    v_mov_b32 v212, s3
    v_xor_b32 v161, 32, v160
    v_xor_b32 v162, 64, v160
    v_xor_b32 v163, 96, v160
    v_add_u32 v164, 0x20000, v160
    v_add_u32 v165, 0x20000, v161
    v_add_u32 v166, 0x20000, v162
    v_add_u32 v167, 0x20000, v163
    v_xor_b32 v1, 128, v18
    s_add_u32 m0, s36, 98304
    s_mov_b32 s40, 458752
    buffer_load_dwordx4 v30, s[24:27], s40 offen offset:0 lds
    s_mov_b32 s40, 486400
    buffer_load_dwordx4 v30, s[24:27], s40 offen offset:1024 lds
    s_add_u32 m0, s36, 106496
    s_mov_b32 s40, 1048576
    buffer_load_dwordx4 v31, s[12:15], s40 offen offset:0 lds
    s_mov_b32 s40, 1113088
    buffer_load_dwordx4 v31, s[12:15], s40 offen offset:1024 lds
    s_add_u32 m0, s101, 131072
    s_mov_b32 s40, 256
    buffer_load_dwordx4 v214, s[16:19], s40 offen offset:0 lds
    s_mov_b32 s40, 7424
    buffer_load_dwordx4 v215, s[16:19], s40 offen offset:1024 lds
    s_mov_b32 s40, 14592
    buffer_load_dwordx4 v214, s[16:19], s40 offen offset:2048 lds
    s_mov_b32 s40, 21760
    buffer_load_dwordx4 v215, s[16:19], s40 offen offset:3072 lds
    s_add_u32 m0, s101, 135168
    s_mov_b32 s40, 33024
    buffer_load_dwordx4 v214, s[16:19], s40 offen offset:0 lds
    s_mov_b32 s40, 40192
    buffer_load_dwordx4 v215, s[16:19], s40 offen offset:1024 lds
    s_mov_b32 s40, 47360
    buffer_load_dwordx4 v214, s[16:19], s40 offen offset:2048 lds
    s_mov_b32 s40, 54528
    buffer_load_dwordx4 v215, s[16:19], s40 offen offset:3072 lds
    s_add_u32 m0, s36, 114688
    s_mov_b32 s40, 688128
    buffer_load_dwordx4 v30, s[24:27], s40 offen offset:0 lds
    s_mov_b32 s40, 715776
    buffer_load_dwordx4 v30, s[24:27], s40 offen offset:1024 lds
    s_add_u32 m0, s36, 122880
    s_mov_b32 s40, 1572864
    buffer_load_dwordx4 v31, s[12:15], s40 offen offset:0 lds
    s_mov_b32 s40, 1637376
    buffer_load_dwordx4 v31, s[12:15], s40 offen offset:1024 lds
    s_mov_b32 s76, 0xffff0000
    s_waitcnt vmcnt(28)
    ds_read_b128 a[0:3], v160 offset:0
    ds_read_b128 a[128:131], v160 offset:4096
    ds_read_b128 a[4:7], v161 offset:0
    ds_read_b128 a[132:135], v161 offset:4096
    ds_read_b128 a[8:11], v162 offset:0
    ds_read_b128 a[136:139], v162 offset:4096
    ds_read_b128 a[12:15], v163 offset:0
    ds_read_b128 a[140:143], v163 offset:4096
    s_barrier
    ds_read_b64_tr_b16 v[224:225], v24 offset:0
    ds_read_b64_tr_b16 v[226:227], v24 offset:512
    ds_read_b64_tr_b16 v[228:229], v25 offset:0
    ds_read_b64_tr_b16 v[230:231], v25 offset:512
    ds_read_b64_tr_b16 v[232:233], v26 offset:0
    ds_read_b64_tr_b16 v[234:235], v26 offset:512
    ds_read_b64_tr_b16 v[236:237], v27 offset:0
    ds_read_b64_tr_b16 v[238:239], v27 offset:512
    ds_read_b64_tr_b16 v[170:171], v168 offset:0
    ds_read_b64_tr_b16 v[172:173], v168 offset:512
    s_waitcnt lgkmcnt(8)
    v_mfma_f32_32x32x16_bf16 v[32:47], v[224:227], a[0:3], 0
    ds_read_b64_tr_b16 v[240:241], v24 offset:2048
    v_mfma_f32_32x32x16_bf16 v[48:63], v[224:227], a[128:131], 0
    ds_read_b64_tr_b16 v[242:243], v24 offset:2560
    s_waitcnt lgkmcnt(8)
    v_mfma_f32_32x32x16_bf16 v[64:79], v[228:231], a[0:3], 0
    ds_read_b64_tr_b16 v[244:245], v25 offset:2048
    ds_read_b64_tr_b16 v[174:175], v168 offset:2048
    s_waitcnt lgkmcnt(4)
    v_lshlrev_b32 v178, 16, v170
    v_lshlrev_b32 v179, 16, v171
    v_and_b32 v170, s76, v170
    v_mfma_f32_32x32x16_bf16 v[80:95], v[228:231], a[128:131], 0
    ds_read_b64_tr_b16 v[246:247], v25 offset:2560
    ds_read_b64_tr_b16 v[176:177], v168 offset:2560
    v_add_f32 v180, v180, v178
    v_and_b32 v171, s76, v171
    v_add_f32 v181, v181, v179
    v_mfma_f32_32x32x16_bf16 v[96:111], v[232:235], a[0:3], 0
    ds_read_b64_tr_b16 v[248:249], v26 offset:2048
    s_waitcnt vmcnt(16)
    ds_read_b128 a[16:19], v160 offset:32768
    v_add_f32 v180, v180, v170
    v_add_f32 v181, v181, v171
    v_mfma_f32_32x32x16_bf16 v[112:127], v[232:235], a[128:131], 0
    ds_read_b64_tr_b16 v[250:251], v26 offset:2560
    ds_read_b128 a[144:147], v160 offset:36864
    v_lshlrev_b32 v178, 16, v172
    v_lshlrev_b32 v179, 16, v173
    v_and_b32 v172, s76, v172
    v_mfma_f32_32x32x16_bf16 v[128:143], v[236:239], a[0:3], 0
    ds_read_b64_tr_b16 v[252:253], v27 offset:2048
    v_add_f32 v180, v180, v178
    v_and_b32 v173, s76, v173
    v_add_f32 v181, v181, v179
    v_mfma_f32_32x32x16_bf16 v[144:159], v[236:239], a[128:131], 0
    ds_read_b64_tr_b16 v[254:255], v27 offset:2560
    v_add_f32 v180, v180, v172
    v_add_f32 v181, v181, v173
    s_waitcnt lgkmcnt(10)
    v_mfma_f32_32x32x16_bf16 v[32:47], v[240:243], a[4:7], v[32:47]
    ds_read_b64_tr_b16 v[224:225], v24 offset:4096
    s_add_u32 m0, s101, 0
    s_mov_b32 s40, 384
    buffer_load_dwordx4 v214, s[16:19], s40 offen offset:0 lds
    v_lshlrev_b32 v192, 16, v184
    v_and_b32 v193, s76, v184
    v_lshlrev_b32 v194, 16, v185
    v_and_b32 v195, s76, v185
    v_mfma_f32_32x32x16_bf16 v[48:63], v[240:243], a[132:135], v[48:63]
    ds_read_b64_tr_b16 v[226:227], v24 offset:4608
    s_mov_b32 s40, 7552
    buffer_load_dwordx4 v215, s[16:19], s40 offen offset:1024 lds
    v_lshlrev_b32 v196, 16, v186
    v_and_b32 v197, s76, v186
    v_lshlrev_b32 v198, 16, v187
    v_and_b32 v199, s76, v187
    s_waitcnt lgkmcnt(9)
    v_mfma_f32_32x32x16_bf16 v[64:79], v[244:247], a[4:7], v[64:79]
    ds_read_b64_tr_b16 v[228:229], v25 offset:4096
    ds_read_b64_tr_b16 v[170:171], v168 offset:4096
    s_waitcnt lgkmcnt(10)
    v_lshlrev_b32 v178, 16, v174
    v_lshlrev_b32 v179, 16, v175
    v_and_b32 v174, s76, v174
    v_lshlrev_b32 v200, 16, v188
    v_and_b32 v201, s76, v188
    v_lshlrev_b32 v202, 16, v189
    v_mfma_f32_32x32x16_bf16 v[80:95], v[244:247], a[132:135], v[80:95]
    ds_read_b64_tr_b16 v[230:231], v25 offset:4608
    ds_read_b64_tr_b16 v[172:173], v168 offset:4608
    v_add_f32 v180, v180, v178
    v_and_b32 v175, s76, v175
    v_add_f32 v181, v181, v179
    v_and_b32 v203, s76, v189
    v_lshlrev_b32 v204, 16, v190
    v_and_b32 v205, s76, v190
    s_waitcnt lgkmcnt(9)
    v_mfma_f32_32x32x16_bf16 v[96:111], v[248:251], a[4:7], v[96:111]
    ds_read_b64_tr_b16 v[232:233], v26 offset:4096
    ds_read_b128 a[20:23], v161 offset:32768
    v_add_f32 v180, v180, v174
    v_add_f32 v181, v181, v175
    v_lshlrev_b32 v206, 16, v191
    v_and_b32 v207, s76, v191
    v_add_f32 v208, v192, v193
    v_add_f32 v209, v194, v195
    v_mfma_f32_32x32x16_bf16 v[112:127], v[248:251], a[132:135], v[112:127]
    ds_read_b64_tr_b16 v[234:235], v26 offset:4608
    ds_read_b128 a[148:151], v161 offset:36864
    v_lshlrev_b32 v178, 16, v176
    v_lshlrev_b32 v179, 16, v177
    v_and_b32 v176, s76, v176
    v_add_f32 v208, v208, v196
    v_add_f32 v209, v209, v197
    v_add_f32 v208, v208, v198
    s_waitcnt lgkmcnt(10)
    v_mfma_f32_32x32x16_bf16 v[128:143], v[252:255], a[4:7], v[128:143]
    ds_read_b64_tr_b16 v[236:237], v27 offset:4096
    v_add_f32 v180, v180, v178
    v_and_b32 v177, s76, v177
    v_add_f32 v181, v181, v179
    s_mov_b32 s40, 14720
    buffer_load_dwordx4 v214, s[16:19], s40 offen offset:2048 lds
    v_add_f32 v209, v209, v199
    v_mfma_f32_32x32x16_bf16 v[144:159], v[252:255], a[132:135], v[144:159]
    ds_read_b64_tr_b16 v[238:239], v27 offset:4608
    v_add_f32 v180, v180, v176
    v_add_f32 v181, v181, v177
    v_add_f32 v208, v208, v200
    v_add_f32 v209, v209, v201
    v_add_f32 v208, v208, v202
    v_add_f32 v209, v209, v203
    s_waitcnt lgkmcnt(10)
    v_mfma_f32_32x32x16_bf16 v[32:47], v[224:227], a[8:11], v[32:47]
    ds_read_b64_tr_b16 v[240:241], v24 offset:6144
    s_mov_b32 s40, 21888
    buffer_load_dwordx4 v215, s[16:19], s40 offen offset:3072 lds
    v_add_f32 v208, v208, v204
    v_add_f32 v209, v209, v205
    v_add_f32 v208, v208, v206
    v_add_f32 v209, v209, v207
    v_mfma_f32_32x32x16_bf16 v[48:63], v[224:227], a[136:139], v[48:63]
    ds_read_b64_tr_b16 v[242:243], v24 offset:6656
    s_add_u32 m0, s101, 4096
    s_mov_b32 s40, 33152
    buffer_load_dwordx4 v214, s[16:19], s40 offen offset:0 lds
    v_add_f32 v208, v208, v209
    s_nop 1
    v_add_f32_dpp v208, v208, v208 row_ror:8 row_mask:0xf bank_mask:0xf
    s_nop 1
    v_add_f32_dpp v208, v208, v208 row_ror:4 row_mask:0xf bank_mask:0xf
    s_nop 1
    v_add_f32_dpp v208, v208, v208 row_ror:2 row_mask:0xf bank_mask:0xf
    s_waitcnt lgkmcnt(9)
    v_mfma_f32_32x32x16_bf16 v[64:79], v[228:231], a[8:11], v[64:79]
    ds_read_b64_tr_b16 v[244:245], v25 offset:6144
    ds_read_b64_tr_b16 v[174:175], v168 offset:6144
    s_waitcnt lgkmcnt(10)
    v_lshlrev_b32 v178, 16, v170
    v_lshlrev_b32 v179, 16, v171
    v_and_b32 v170, s76, v170
    s_nop 1
    v_add_f32_dpp v208, v208, v208 row_ror:1 row_mask:0xf bank_mask:0xf
    v_mov_b32 v210, v208
    s_nop 1
    v_permlane16_swap_b32 v208, v210
    v_mfma_f32_32x32x16_bf16 v[80:95], v[228:231], a[136:139], v[80:95]
    ds_read_b64_tr_b16 v[246:247], v25 offset:6656
    ds_read_b64_tr_b16 v[176:177], v168 offset:6656
    v_add_f32 v180, v180, v178
    v_and_b32 v171, s76, v171
    v_add_f32 v181, v181, v179
    s_nop 1
wpad0:
    s_cmp_eq_u32 s98, 1
    s_cbranch_scc1 WARMA_done
    v_add_f32 v208, v208, v210
    v_mul_f32 v188, 0xbb000000, v208
    v_add_f32 v192, v192, v188
    s_waitcnt lgkmcnt(9)
    v_mfma_f32_32x32x16_bf16 v[96:111], v[232:235], a[8:11], v[96:111]
    ds_read_b64_tr_b16 v[248:249], v26 offset:6144
    ds_read_b128 a[24:27], v162 offset:32768
    v_add_f32 v180, v180, v170
    v_add_f32 v181, v181, v171
    v_add_f32 v193, v193, v188
    v_add_f32 v194, v194, v188
    v_add_f32 v195, v195, v188
    v_add_f32 v196, v196, v188
    v_mfma_f32_32x32x16_bf16 v[112:127], v[232:235], a[136:139], v[112:127]
    ds_read_b64_tr_b16 v[250:251], v26 offset:6656
    ds_read_b128 a[152:155], v162 offset:36864
    v_lshlrev_b32 v178, 16, v172
    v_lshlrev_b32 v179, 16, v173
    v_and_b32 v172, s76, v172
    v_add_f32 v197, v197, v188
    v_add_f32 v198, v198, v188
    v_add_f32 v199, v199, v188
    s_waitcnt lgkmcnt(10)
    v_mfma_f32_32x32x16_bf16 v[128:143], v[236:239], a[8:11], v[128:143]
    ds_read_b64_tr_b16 v[252:253], v27 offset:6144
    v_add_f32 v180, v180, v178
    v_and_b32 v173, s76, v173
    v_add_f32 v181, v181, v179
    s_mov_b32 s40, 40320
    buffer_load_dwordx4 v215, s[16:19], s40 offen offset:1024 lds
    v_add_f32 v200, v200, v188
    v_mfma_f32_32x32x16_bf16 v[144:159], v[236:239], a[136:139], v[144:159]
    ds_read_b64_tr_b16 v[254:255], v27 offset:6656
    v_add_f32 v180, v180, v172
    v_add_f32 v181, v181, v173
    v_add_f32 v201, v201, v188
    v_add_f32 v202, v202, v188
    v_add_f32 v203, v203, v188
    v_add_f32 v204, v204, v188
    s_barrier
    s_waitcnt lgkmcnt(10)
    v_mfma_f32_32x32x16_bf16 v[32:47], v[240:243], a[12:15], v[32:47]
    ds_read_b64_tr_b16 v[224:225], v24 offset:16384
    s_mov_b32 s40, 47488
    buffer_load_dwordx4 v214, s[16:19], s40 offen offset:2048 lds
    v_add_f32 v205, v205, v188
    v_add_f32 v206, v206, v188
    v_add_f32 v207, v207, v188
    v_mul_f32 v208, v192, v192
    v_mfma_f32_32x32x16_bf16 v[48:63], v[240:243], a[140:143], v[48:63]
    ds_read_b64_tr_b16 v[226:227], v24 offset:16896
    s_mov_b32 s40, 54656
    buffer_load_dwordx4 v215, s[16:19], s40 offen offset:3072 lds
    v_mul_f32 v209, v193, v193
    v_fmac_f32 v208, v194, v194
    v_fmac_f32 v209, v195, v195
    v_fmac_f32 v208, v196, v196
    s_waitcnt lgkmcnt(9)
    v_mfma_f32_32x32x16_bf16 v[64:79], v[244:247], a[12:15], v[64:79]
    ds_read_b64_tr_b16 v[228:229], v25 offset:16384
    ds_read_b64_tr_b16 v[170:171], v168 offset:16384
    s_waitcnt lgkmcnt(10)
    v_lshlrev_b32 v178, 16, v174
    v_lshlrev_b32 v179, 16, v175
    v_and_b32 v174, s76, v174
    v_fmac_f32 v209, v197, v197
    v_fmac_f32 v208, v198, v198
    v_fmac_f32 v209, v199, v199
    v_mfma_f32_32x32x16_bf16 v[80:95], v[244:247], a[140:143], v[80:95]
    ds_read_b64_tr_b16 v[230:231], v25 offset:16896
    ds_read_b64_tr_b16 v[172:173], v168 offset:16896
    v_add_f32 v180, v180, v178
    v_and_b32 v175, s76, v175
    v_add_f32 v181, v181, v179
    v_fmac_f32 v208, v200, v200
    v_fmac_f32 v209, v201, v201
    v_fmac_f32 v208, v202, v202
    s_waitcnt lgkmcnt(9)
    v_mfma_f32_32x32x16_bf16 v[96:111], v[248:251], a[12:15], v[96:111]
    ds_read_b64_tr_b16 v[232:233], v26 offset:16384
    ds_read_b128 a[28:31], v163 offset:32768
    v_add_f32 v180, v180, v174
    v_add_f32 v181, v181, v175
    v_fmac_f32 v209, v203, v203
    v_fmac_f32 v208, v204, v204
    v_fmac_f32 v209, v205, v205
    v_fmac_f32 v208, v206, v206
    v_mfma_f32_32x32x16_bf16 v[112:127], v[248:251], a[140:143], v[112:127]
    ds_read_b64_tr_b16 v[234:235], v26 offset:16896
    ds_read_b128 a[156:159], v163 offset:36864
    v_lshlrev_b32 v178, 16, v176
    v_lshlrev_b32 v179, 16, v177
    v_and_b32 v176, s76, v176
    v_fmac_f32 v209, v207, v207
    v_add_f32 v208, v208, v209
    s_nop 1
    v_add_f32_dpp v208, v208, v208 row_ror:8 row_mask:0xf bank_mask:0xf
    s_waitcnt lgkmcnt(10)
    v_mfma_f32_32x32x16_bf16 v[128:143], v[252:255], a[12:15], v[128:143]
    ds_read_b64_tr_b16 v[236:237], v27 offset:16384
    v_add_f32 v180, v180, v178
    v_and_b32 v177, s76, v177
    v_add_f32 v181, v181, v179
    s_nop 1
    v_add_f32_dpp v208, v208, v208 row_ror:4 row_mask:0xf bank_mask:0xf
    s_nop 1
    v_add_f32_dpp v208, v208, v208 row_ror:2 row_mask:0xf bank_mask:0xf
    s_nop 1
    v_add_f32_dpp v208, v208, v208 row_ror:1 row_mask:0xf bank_mask:0xf
    v_mfma_f32_32x32x16_bf16 v[144:159], v[252:255], a[140:143], v[144:159]
    ds_read_b64_tr_b16 v[238:239], v27 offset:16896
    v_add_f32 v180, v180, v176
    v_add_f32 v181, v181, v177
    v_mov_b32 v210, v208
    s_nop 1
    v_permlane16_swap_b32 v208, v210
    s_nop 1
    v_add_f32 v208, v208, v210
    v_mov_b32 v209, 0x3727c5ac
    s_waitcnt lgkmcnt(10)
    v_mfma_f32_32x32x16_bf16 v[32:47], v[224:227], a[16:19], v[32:47]
    ds_read_b64_tr_b16 v[240:241], v24 offset:18432
    v_fmac_f32 v209, 0x3b000000, v208
    v_rsq_f32 v208, v209
    v_mov_b32 v184, v188
    v_mul_f32 v185, 0xbfb8aa3b, v208
    v_mul_f32 v186, v209, v208
    v_mfma_f32_32x32x16_bf16 v[48:63], v[224:227], a[144:147], v[48:63]
    ds_read_b64_tr_b16 v[242:243], v24 offset:18944
    v_mov_b32 v187, v208
    v_lshlrev_b32 v211, 4, v211
    s_mov_b32 exec_lo, 1
    s_mov_b32 exec_hi, 1
    global_store_dwordx4 v211, v[184:187], s[56:57] offset:0 sc1
    s_mov_b64 exec, -1
    s_waitcnt lgkmcnt(9)
    v_mfma_f32_32x32x16_bf16 v[64:79], v[228:231], a[16:19], v[64:79]
    ds_read_b64_tr_b16 v[244:245], v25 offset:18432
    ds_read_b64_tr_b16 v[174:175], v168 offset:18432
    s_waitcnt lgkmcnt(10)
    v_lshlrev_b32 v178, 16, v170
    v_lshlrev_b32 v179, 16, v171
    v_and_b32 v170, s76, v170
    s_lshl_b32 s75, s33, 2
    s_add_u32 s75, s75, s34
    s_lshl_b32 s75, s75, 2
    s_lshr_b32 s3, s32, 3
    s_add_u32 s75, s75, s3
    s_mul_i32 s75, s75, 4352
    s_and_b32 s3, s32, 7
    s_lshl_b32 s3, s3, 2
    s_add_u32 s75, s75, s3
    s_add_u32 s75, s75, 29360128
    v_mov_b32 v208, s75
    v_mov_b32 v209, 0
    s_mov_b64 exec, 1
    global_store_dword v208, v209, s[56:57] sc1
    s_mov_b64 exec, -1
    v_mfma_f32_32x32x16_bf16 v[80:95], v[228:231], a[144:147], v[80:95]
    ds_read_b64_tr_b16 v[246:247], v25 offset:18944
    ds_read_b64_tr_b16 v[176:177], v168 offset:18944
    v_add_f32 v180, v180, v178
    v_and_b32 v171, s76, v171
    v_add_f32 v181, v181, v179
    s_waitcnt lgkmcnt(9)
    v_mfma_f32_32x32x16_bf16 v[96:111], v[232:235], a[16:19], v[96:111]
    ds_read_b64_tr_b16 v[248:249], v26 offset:18432
    s_waitcnt vmcnt(14)
    ds_read_b128 a[32:35], v164 offset:0
    v_add_f32 v180, v180, v170
    v_add_f32 v181, v181, v171
    v_mfma_f32_32x32x16_bf16 v[112:127], v[232:235], a[144:147], v[112:127]
    ds_read_b64_tr_b16 v[250:251], v26 offset:18944
    ds_read_b128 a[160:163], v164 offset:4096
    v_lshlrev_b32 v178, 16, v172
    v_lshlrev_b32 v179, 16, v173
    v_and_b32 v172, s76, v172
    s_waitcnt lgkmcnt(10)
    v_mfma_f32_32x32x16_bf16 v[128:143], v[236:239], a[16:19], v[128:143]
    ds_read_b64_tr_b16 v[252:253], v27 offset:18432
    v_add_f32 v180, v180, v178
    v_and_b32 v173, s76, v173
    v_add_f32 v181, v181, v179
    v_mfma_f32_32x32x16_bf16 v[144:159], v[236:239], a[144:147], v[144:159]
    ds_read_b64_tr_b16 v[254:255], v27 offset:18944
    v_add_f32 v180, v180, v172
    v_add_f32 v181, v181, v173
    s_waitcnt lgkmcnt(10)
    v_mfma_f32_32x32x16_bf16 v[32:47], v[240:243], a[20:23], v[32:47]
    ds_read_b64_tr_b16 v[224:225], v24 offset:20480
    s_add_u32 m0, s101, 32768
    s_mov_b32 s40, 512
    buffer_load_dwordx4 v214, s[16:19], s40 offen offset:0 lds
    v_mfma_f32_32x32x16_bf16 v[48:63], v[240:243], a[148:151], v[48:63]
    ds_read_b64_tr_b16 v[226:227], v24 offset:20992
    s_mov_b32 s40, 7680
    buffer_load_dwordx4 v215, s[16:19], s40 offen offset:1024 lds
    s_waitcnt lgkmcnt(9)
    v_mfma_f32_32x32x16_bf16 v[64:79], v[244:247], a[20:23], v[64:79]
    ds_read_b64_tr_b16 v[228:229], v25 offset:20480
    ds_read_b64_tr_b16 v[170:171], v168 offset:20480
    s_waitcnt lgkmcnt(10)
    v_lshlrev_b32 v178, 16, v174
    v_lshlrev_b32 v179, 16, v175
    v_and_b32 v174, s76, v174
    v_mfma_f32_32x32x16_bf16 v[80:95], v[244:247], a[148:151], v[80:95]
    ds_read_b64_tr_b16 v[230:231], v25 offset:20992
    ds_read_b64_tr_b16 v[172:173], v168 offset:20992
    v_add_f32 v180, v180, v178
    v_and_b32 v175, s76, v175
    v_add_f32 v181, v181, v179
    s_waitcnt lgkmcnt(9)
    v_mfma_f32_32x32x16_bf16 v[96:111], v[248:251], a[20:23], v[96:111]
    ds_read_b64_tr_b16 v[232:233], v26 offset:20480
    ds_read_b128 a[36:39], v165 offset:0
    v_add_f32 v180, v180, v174
    v_add_f32 v181, v181, v175
    v_mfma_f32_32x32x16_bf16 v[112:127], v[248:251], a[148:151], v[112:127]
    ds_read_b64_tr_b16 v[234:235], v26 offset:20992
    ds_read_b128 a[164:167], v165 offset:4096
    v_lshlrev_b32 v178, 16, v176
    v_lshlrev_b32 v179, 16, v177
    v_and_b32 v176, s76, v176
    s_waitcnt lgkmcnt(10)
    v_mfma_f32_32x32x16_bf16 v[128:143], v[252:255], a[20:23], v[128:143]
    ds_read_b64_tr_b16 v[236:237], v27 offset:20480
    v_add_f32 v180, v180, v178
    v_and_b32 v177, s76, v177
    v_add_f32 v181, v181, v179
    s_mov_b32 s40, 14848
    buffer_load_dwordx4 v214, s[16:19], s40 offen offset:2048 lds
    v_mfma_f32_32x32x16_bf16 v[144:159], v[252:255], a[148:151], v[144:159]
    ds_read_b64_tr_b16 v[238:239], v27 offset:20992
    v_add_f32 v180, v180, v176
    v_add_f32 v181, v181, v177
    s_waitcnt lgkmcnt(10)
    v_mfma_f32_32x32x16_bf16 v[32:47], v[224:227], a[24:27], v[32:47]
    ds_read_b64_tr_b16 v[240:241], v24 offset:22528
    s_mov_b32 s40, 22016
    buffer_load_dwordx4 v215, s[16:19], s40 offen offset:3072 lds
    v_mfma_f32_32x32x16_bf16 v[48:63], v[224:227], a[152:155], v[48:63]
    ds_read_b64_tr_b16 v[242:243], v24 offset:23040
    s_add_u32 m0, s101, 36864
    s_mov_b32 s40, 33280
    buffer_load_dwordx4 v214, s[16:19], s40 offen offset:0 lds
    s_waitcnt lgkmcnt(9)
    v_mfma_f32_32x32x16_bf16 v[64:79], v[228:231], a[24:27], v[64:79]
    ds_read_b64_tr_b16 v[244:245], v25 offset:22528
    ds_read_b64_tr_b16 v[174:175], v168 offset:22528
    s_waitcnt lgkmcnt(10)
    v_lshlrev_b32 v178, 16, v170
    v_lshlrev_b32 v179, 16, v171
    v_and_b32 v170, s76, v170
    v_mfma_f32_32x32x16_bf16 v[80:95], v[228:231], a[152:155], v[80:95]
    ds_read_b64_tr_b16 v[246:247], v25 offset:23040
    ds_read_b64_tr_b16 v[176:177], v168 offset:23040
    v_add_f32 v180, v180, v178
    v_and_b32 v171, s76, v171
    v_add_f32 v181, v181, v179
    s_waitcnt lgkmcnt(9)
    v_mfma_f32_32x32x16_bf16 v[96:111], v[232:235], a[24:27], v[96:111]
    ds_read_b64_tr_b16 v[248:249], v26 offset:22528
    ds_read_b128 a[40:43], v166 offset:0
    v_add_f32 v180, v180, v170
    v_add_f32 v181, v181, v171
    v_mfma_f32_32x32x16_bf16 v[112:127], v[232:235], a[152:155], v[112:127]
    ds_read_b64_tr_b16 v[250:251], v26 offset:23040
    ds_read_b128 a[168:171], v166 offset:4096
    v_lshlrev_b32 v178, 16, v172
    v_lshlrev_b32 v179, 16, v173
    v_and_b32 v172, s76, v172
    s_waitcnt lgkmcnt(10)
    v_mfma_f32_32x32x16_bf16 v[128:143], v[236:239], a[24:27], v[128:143]
    ds_read_b64_tr_b16 v[252:253], v27 offset:22528
    v_add_f32 v180, v180, v178
    v_and_b32 v173, s76, v173
    v_add_f32 v181, v181, v179
    s_mov_b32 s40, 40448
    buffer_load_dwordx4 v215, s[16:19], s40 offen offset:1024 lds
    v_mfma_f32_32x32x16_bf16 v[144:159], v[236:239], a[152:155], v[144:159]
    ds_read_b64_tr_b16 v[254:255], v27 offset:23040
    v_add_f32 v180, v180, v172
    v_add_f32 v181, v181, v173
    s_waitcnt vmcnt(7)
    s_barrier
    s_cmp_lg_u32 s34, 0
    s_cbranch_scc1 stat_pub_skip
    v_mov_b32 v208, 1
    s_mov_b64 exec, 1
    global_atomic_add v212, v208, s[62:63]
    s_mov_b64 exec, -1
stat_pub_skip:
    s_waitcnt lgkmcnt(10)
    v_mfma_f32_32x32x16_bf16 v[32:47], v[240:243], a[28:31], v[32:47]
    ds_read_b64_tr_b16 v[224:225], v24 offset:32768
    s_mov_b32 s40, 47616
    buffer_load_dwordx4 v214, s[16:19], s40 offen offset:2048 lds
    v_mfma_f32_32x32x16_bf16 v[48:63], v[240:243], a[156:159], v[48:63]
    ds_read_b64_tr_b16 v[226:227], v24 offset:33280
    s_mov_b32 s40, 54784
    buffer_load_dwordx4 v215, s[16:19], s40 offen offset:3072 lds
    s_waitcnt lgkmcnt(9)
    v_mfma_f32_32x32x16_bf16 v[64:79], v[244:247], a[28:31], v[64:79]
    ds_read_b64_tr_b16 v[228:229], v25 offset:32768
    ds_read_b64_tr_b16 v[170:171], v168 offset:32768
    s_waitcnt lgkmcnt(10)
    v_lshlrev_b32 v178, 16, v174
    v_lshlrev_b32 v179, 16, v175
    v_and_b32 v174, s76, v174
    v_mfma_f32_32x32x16_bf16 v[80:95], v[244:247], a[156:159], v[80:95]
    ds_read_b64_tr_b16 v[230:231], v25 offset:33280
    ds_read_b64_tr_b16 v[172:173], v168 offset:33280
    v_add_f32 v180, v180, v178
    v_and_b32 v175, s76, v175
    v_add_f32 v181, v181, v179
    s_waitcnt lgkmcnt(9)
    v_mfma_f32_32x32x16_bf16 v[96:111], v[248:251], a[28:31], v[96:111]
    ds_read_b64_tr_b16 v[232:233], v26 offset:32768
    ds_read_b128 a[44:47], v167 offset:0
    v_add_f32 v180, v180, v174
    v_add_f32 v181, v181, v175
    v_mfma_f32_32x32x16_bf16 v[112:127], v[248:251], a[156:159], v[112:127]
    ds_read_b64_tr_b16 v[234:235], v26 offset:33280
    ds_read_b128 a[172:175], v167 offset:4096
    v_lshlrev_b32 v178, 16, v176
    v_lshlrev_b32 v179, 16, v177
    v_and_b32 v176, s76, v176
    s_waitcnt lgkmcnt(10)
    v_mfma_f32_32x32x16_bf16 v[128:143], v[252:255], a[28:31], v[128:143]
    ds_read_b64_tr_b16 v[236:237], v27 offset:32768
    v_add_f32 v180, v180, v178
    v_and_b32 v177, s76, v177
    v_add_f32 v181, v181, v179
    s_add_u32 m0, s36, 65536
    s_mov_b32 s40, 917504
    buffer_load_dwordx4 v30, s[24:27], s40 offen offset:0 lds
    v_mfma_f32_32x32x16_bf16 v[144:159], v[252:255], a[156:159], v[144:159]
    ds_read_b64_tr_b16 v[238:239], v27 offset:33280
    v_add_f32 v180, v180, v176
    v_add_f32 v181, v181, v177
    s_waitcnt lgkmcnt(10)
    v_mfma_f32_32x32x16_bf16 v[32:47], v[224:227], a[32:35], v[32:47]
    ds_read_b64_tr_b16 v[240:241], v24 offset:34816
    s_mov_b32 s40, 945152
    buffer_load_dwordx4 v30, s[24:27], s40 offen offset:1024 lds
    v_mfma_f32_32x32x16_bf16 v[48:63], v[224:227], a[160:163], v[48:63]
    ds_read_b64_tr_b16 v[242:243], v24 offset:35328
    s_add_u32 m0, s36, 73728
    s_mov_b32 s40, 2097152
    buffer_load_dwordx4 v31, s[12:15], s40 offen offset:0 lds
    s_waitcnt lgkmcnt(9)
    v_mfma_f32_32x32x16_bf16 v[64:79], v[228:231], a[32:35], v[64:79]
    ds_read_b64_tr_b16 v[244:245], v25 offset:34816
    ds_read_b64_tr_b16 v[174:175], v168 offset:34816
    s_waitcnt lgkmcnt(10)
    v_lshlrev_b32 v178, 16, v170
    v_lshlrev_b32 v179, 16, v171
    v_and_b32 v170, s76, v170
    v_mfma_f32_32x32x16_bf16 v[80:95], v[228:231], a[160:163], v[80:95]
    ds_read_b64_tr_b16 v[246:247], v25 offset:35328
    ds_read_b64_tr_b16 v[176:177], v168 offset:35328
    v_add_f32 v180, v180, v178
    v_and_b32 v171, s76, v171
    v_add_f32 v181, v181, v179
    s_waitcnt lgkmcnt(9)
    v_mfma_f32_32x32x16_bf16 v[96:111], v[232:235], a[32:35], v[96:111]
    ds_read_b64_tr_b16 v[248:249], v26 offset:34816
    ds_read_b128 a[48:51], v160 offset:0
    v_add_f32 v180, v180, v170
    v_add_f32 v181, v181, v171
    v_mfma_f32_32x32x16_bf16 v[112:127], v[232:235], a[160:163], v[112:127]
    ds_read_b64_tr_b16 v[250:251], v26 offset:35328
    ds_read_b128 a[176:179], v160 offset:4096
    v_lshlrev_b32 v178, 16, v172
    v_lshlrev_b32 v179, 16, v173
    v_and_b32 v172, s76, v172
    s_waitcnt lgkmcnt(10)
    v_mfma_f32_32x32x16_bf16 v[128:143], v[236:239], a[32:35], v[128:143]
    ds_read_b64_tr_b16 v[252:253], v27 offset:34816
    v_add_f32 v180, v180, v178
    v_and_b32 v173, s76, v173
    v_add_f32 v181, v181, v179
    s_mov_b32 s40, 2161664
    buffer_load_dwordx4 v31, s[12:15], s40 offen offset:1024 lds
    v_mfma_f32_32x32x16_bf16 v[144:159], v[236:239], a[160:163], v[144:159]
    ds_read_b64_tr_b16 v[254:255], v27 offset:35328
    v_add_f32 v180, v180, v172
    v_add_f32 v181, v181, v173
    s_waitcnt lgkmcnt(10)
    v_mfma_f32_32x32x16_bf16 v[32:47], v[240:243], a[36:39], v[32:47]
    ds_read_b64_tr_b16 v[224:225], v24 offset:36864
    s_add_u32 m0, s101, 131072
    s_mov_b32 s40, 640
    buffer_load_dwordx4 v214, s[16:19], s40 offen offset:0 lds
    v_mfma_f32_32x32x16_bf16 v[48:63], v[240:243], a[164:167], v[48:63]
    ds_read_b64_tr_b16 v[226:227], v24 offset:37376
    s_mov_b32 s40, 7808
    buffer_load_dwordx4 v215, s[16:19], s40 offen offset:1024 lds
    s_waitcnt lgkmcnt(9)
    v_mfma_f32_32x32x16_bf16 v[64:79], v[244:247], a[36:39], v[64:79]
    ds_read_b64_tr_b16 v[228:229], v25 offset:36864
    ds_read_b64_tr_b16 v[170:171], v168 offset:36864
    s_waitcnt lgkmcnt(10)
    v_lshlrev_b32 v178, 16, v174
    v_lshlrev_b32 v179, 16, v175
    v_and_b32 v174, s76, v174
    v_mfma_f32_32x32x16_bf16 v[80:95], v[244:247], a[164:167], v[80:95]
    ds_read_b64_tr_b16 v[230:231], v25 offset:37376
    ds_read_b64_tr_b16 v[172:173], v168 offset:37376
    v_add_f32 v180, v180, v178
    v_and_b32 v175, s76, v175
    v_add_f32 v181, v181, v179
    s_waitcnt lgkmcnt(9)
    v_mfma_f32_32x32x16_bf16 v[96:111], v[248:251], a[36:39], v[96:111]
    ds_read_b64_tr_b16 v[232:233], v26 offset:36864
    ds_read_b128 a[52:55], v161 offset:0
    v_add_f32 v180, v180, v174
    v_add_f32 v181, v181, v175
    v_mfma_f32_32x32x16_bf16 v[112:127], v[248:251], a[164:167], v[112:127]
    ds_read_b64_tr_b16 v[234:235], v26 offset:37376
    ds_read_b128 a[180:183], v161 offset:4096
    v_lshlrev_b32 v178, 16, v176
    v_lshlrev_b32 v179, 16, v177
    v_and_b32 v176, s76, v176
    s_waitcnt lgkmcnt(10)
    v_mfma_f32_32x32x16_bf16 v[128:143], v[252:255], a[36:39], v[128:143]
    ds_read_b64_tr_b16 v[236:237], v27 offset:36864
    v_add_f32 v180, v180, v178
    v_and_b32 v177, s76, v177
    v_add_f32 v181, v181, v179
    s_mov_b32 s40, 14976
    buffer_load_dwordx4 v214, s[16:19], s40 offen offset:2048 lds
    v_mfma_f32_32x32x16_bf16 v[144:159], v[252:255], a[164:167], v[144:159]
    ds_read_b64_tr_b16 v[238:239], v27 offset:37376
    v_add_f32 v180, v180, v176
    v_add_f32 v181, v181, v177
    s_waitcnt lgkmcnt(10)
    v_mfma_f32_32x32x16_bf16 v[32:47], v[224:227], a[40:43], v[32:47]
    ds_read_b64_tr_b16 v[240:241], v24 offset:38912
    s_mov_b32 s40, 22144
    buffer_load_dwordx4 v215, s[16:19], s40 offen offset:3072 lds
    v_mfma_f32_32x32x16_bf16 v[48:63], v[224:227], a[168:171], v[48:63]
    ds_read_b64_tr_b16 v[242:243], v24 offset:39424
    s_add_u32 m0, s101, 135168
    s_mov_b32 s40, 33408
    buffer_load_dwordx4 v214, s[16:19], s40 offen offset:0 lds
    s_waitcnt lgkmcnt(9)
    v_mfma_f32_32x32x16_bf16 v[64:79], v[228:231], a[40:43], v[64:79]
    ds_read_b64_tr_b16 v[244:245], v25 offset:38912
    ds_read_b64_tr_b16 v[174:175], v168 offset:38912
    s_waitcnt lgkmcnt(10)
    v_lshlrev_b32 v178, 16, v170
    v_lshlrev_b32 v179, 16, v171
    v_and_b32 v170, s76, v170
    v_mfma_f32_32x32x16_bf16 v[80:95], v[228:231], a[168:171], v[80:95]
    ds_read_b64_tr_b16 v[246:247], v25 offset:39424
    ds_read_b64_tr_b16 v[176:177], v168 offset:39424
    v_add_f32 v180, v180, v178
    v_and_b32 v171, s76, v171
    v_add_f32 v181, v181, v179
    s_waitcnt lgkmcnt(9)
    v_mfma_f32_32x32x16_bf16 v[96:111], v[232:235], a[40:43], v[96:111]
    ds_read_b64_tr_b16 v[248:249], v26 offset:38912
    ds_read_b128 a[56:59], v162 offset:0
    v_add_f32 v180, v180, v170
    v_add_f32 v181, v181, v171
    v_mfma_f32_32x32x16_bf16 v[112:127], v[232:235], a[168:171], v[112:127]
    ds_read_b64_tr_b16 v[250:251], v26 offset:39424
    ds_read_b128 a[184:187], v162 offset:4096
    v_lshlrev_b32 v178, 16, v172
    v_lshlrev_b32 v179, 16, v173
    v_and_b32 v172, s76, v172
    s_waitcnt lgkmcnt(10)
    v_mfma_f32_32x32x16_bf16 v[128:143], v[236:239], a[40:43], v[128:143]
    ds_read_b64_tr_b16 v[252:253], v27 offset:38912
    v_add_f32 v180, v180, v178
    v_and_b32 v173, s76, v173
    v_add_f32 v181, v181, v179
    s_mov_b32 s40, 40576
    buffer_load_dwordx4 v215, s[16:19], s40 offen offset:1024 lds
    v_mfma_f32_32x32x16_bf16 v[144:159], v[236:239], a[168:171], v[144:159]
    ds_read_b64_tr_b16 v[254:255], v27 offset:39424
    v_add_f32 v180, v180, v172
    v_add_f32 v181, v181, v173
    s_barrier
    s_waitcnt lgkmcnt(10)
    v_mfma_f32_32x32x16_bf16 v[32:47], v[240:243], a[44:47], v[32:47]
    ds_read_b64_tr_b16 v[224:225], v24 offset:49152
    s_mov_b32 s40, 47744
    buffer_load_dwordx4 v214, s[16:19], s40 offen offset:2048 lds
    v_mfma_f32_32x32x16_bf16 v[48:63], v[240:243], a[172:175], v[48:63]
    ds_read_b64_tr_b16 v[226:227], v24 offset:49664
    s_mov_b32 s40, 54912
    buffer_load_dwordx4 v215, s[16:19], s40 offen offset:3072 lds
    s_waitcnt lgkmcnt(9)
    v_mfma_f32_32x32x16_bf16 v[64:79], v[244:247], a[44:47], v[64:79]
    ds_read_b64_tr_b16 v[228:229], v25 offset:49152
    ds_read_b64_tr_b16 v[170:171], v168 offset:49152
    s_waitcnt lgkmcnt(10)
    v_lshlrev_b32 v178, 16, v174
    v_lshlrev_b32 v179, 16, v175
    v_and_b32 v174, s76, v174
    v_mfma_f32_32x32x16_bf16 v[80:95], v[244:247], a[172:175], v[80:95]
    ds_read_b64_tr_b16 v[230:231], v25 offset:49664
    ds_read_b64_tr_b16 v[172:173], v168 offset:49664
    v_add_f32 v180, v180, v178
    v_and_b32 v175, s76, v175
    v_add_f32 v181, v181, v179
    s_waitcnt lgkmcnt(9)
    v_mfma_f32_32x32x16_bf16 v[96:111], v[248:251], a[44:47], v[96:111]
    ds_read_b64_tr_b16 v[232:233], v26 offset:49152
    ds_read_b128 a[60:63], v163 offset:0
    v_add_f32 v180, v180, v174
    v_add_f32 v181, v181, v175
    v_mfma_f32_32x32x16_bf16 v[112:127], v[248:251], a[172:175], v[112:127]
    ds_read_b64_tr_b16 v[234:235], v26 offset:49664
    ds_read_b128 a[188:191], v163 offset:4096
    v_lshlrev_b32 v178, 16, v176
    v_lshlrev_b32 v179, 16, v177
    v_and_b32 v176, s76, v176
    s_waitcnt lgkmcnt(10)
    v_mfma_f32_32x32x16_bf16 v[128:143], v[252:255], a[44:47], v[128:143]
    ds_read_b64_tr_b16 v[236:237], v27 offset:49152
    v_add_f32 v180, v180, v178
    v_and_b32 v177, s76, v177
    v_add_f32 v181, v181, v179
    s_add_u32 m0, s36, 81920
    s_mov_b32 s40, 1146880
    buffer_load_dwordx4 v30, s[24:27], s40 offen offset:0 lds
    v_mfma_f32_32x32x16_bf16 v[144:159], v[252:255], a[172:175], v[144:159]
    ds_read_b64_tr_b16 v[238:239], v27 offset:49664
    v_add_f32 v180, v180, v176
    v_add_f32 v181, v181, v177
    s_waitcnt lgkmcnt(10)
    v_mfma_f32_32x32x16_bf16 v[32:47], v[224:227], a[48:51], v[32:47]
    ds_read_b64_tr_b16 v[240:241], v24 offset:51200
    s_mov_b32 s40, 1174528
    buffer_load_dwordx4 v30, s[24:27], s40 offen offset:1024 lds
    v_mfma_f32_32x32x16_bf16 v[48:63], v[224:227], a[176:179], v[48:63]
    ds_read_b64_tr_b16 v[242:243], v24 offset:51712
    s_add_u32 m0, s36, 90112
    s_mov_b32 s40, 2621440
    buffer_load_dwordx4 v31, s[12:15], s40 offen offset:0 lds
    s_waitcnt lgkmcnt(9)
    v_mfma_f32_32x32x16_bf16 v[64:79], v[228:231], a[48:51], v[64:79]
    ds_read_b64_tr_b16 v[244:245], v25 offset:51200
    ds_read_b64_tr_b16 v[174:175], v168 offset:51200
    s_waitcnt lgkmcnt(10)
    v_lshlrev_b32 v178, 16, v170
    v_lshlrev_b32 v179, 16, v171
    v_and_b32 v170, s76, v170
    v_mfma_f32_32x32x16_bf16 v[80:95], v[228:231], a[176:179], v[80:95]
    ds_read_b64_tr_b16 v[246:247], v25 offset:51712
    ds_read_b64_tr_b16 v[176:177], v168 offset:51712
    v_add_f32 v180, v180, v178
    v_and_b32 v171, s76, v171
    v_add_f32 v181, v181, v179
    s_waitcnt lgkmcnt(9)
    v_mfma_f32_32x32x16_bf16 v[96:111], v[232:235], a[48:51], v[96:111]
    ds_read_b64_tr_b16 v[248:249], v26 offset:51200
    s_waitcnt vmcnt(15)
    ds_read_b128 a[64:67], v160 offset:32768
    v_add_f32 v180, v180, v170
    v_add_f32 v181, v181, v171
    v_mfma_f32_32x32x16_bf16 v[112:127], v[232:235], a[176:179], v[112:127]
    ds_read_b64_tr_b16 v[250:251], v26 offset:51712
    ds_read_b128 a[192:195], v160 offset:36864
    v_lshlrev_b32 v178, 16, v172
    v_lshlrev_b32 v179, 16, v173
    v_and_b32 v172, s76, v172
    s_waitcnt lgkmcnt(10)
    v_mfma_f32_32x32x16_bf16 v[128:143], v[236:239], a[48:51], v[128:143]
    ds_read_b64_tr_b16 v[252:253], v27 offset:51200
    v_add_f32 v180, v180, v178
    v_and_b32 v173, s76, v173
    v_add_f32 v181, v181, v179
    s_mov_b32 s40, 2685952
    buffer_load_dwordx4 v31, s[12:15], s40 offen offset:1024 lds
    v_mfma_f32_32x32x16_bf16 v[144:159], v[236:239], a[176:179], v[144:159]
    ds_read_b64_tr_b16 v[254:255], v27 offset:51712
    v_add_f32 v180, v180, v172
    v_add_f32 v181, v181, v173
    s_waitcnt lgkmcnt(10)
    v_mfma_f32_32x32x16_bf16 v[32:47], v[240:243], a[52:55], v[32:47]
    ds_read_b64_tr_b16 v[224:225], v24 offset:53248
    s_add_u32 m0, s101, 0
    s_mov_b32 s40, 768
    buffer_load_dwordx4 v214, s[16:19], s40 offen offset:0 lds
    v_mfma_f32_32x32x16_bf16 v[48:63], v[240:243], a[180:183], v[48:63]
    ds_read_b64_tr_b16 v[226:227], v24 offset:53760
    s_mov_b32 s40, 7936
    buffer_load_dwordx4 v215, s[16:19], s40 offen offset:1024 lds
    s_waitcnt lgkmcnt(9)
    v_mfma_f32_32x32x16_bf16 v[64:79], v[244:247], a[52:55], v[64:79]
    ds_read_b64_tr_b16 v[228:229], v25 offset:53248
    ds_read_b64_tr_b16 v[170:171], v168 offset:53248
    s_waitcnt lgkmcnt(10)
    v_lshlrev_b32 v178, 16, v174
    v_lshlrev_b32 v179, 16, v175
    v_and_b32 v174, s76, v174
    v_mfma_f32_32x32x16_bf16 v[80:95], v[244:247], a[180:183], v[80:95]
    ds_read_b64_tr_b16 v[230:231], v25 offset:53760
    ds_read_b64_tr_b16 v[172:173], v168 offset:53760
    v_add_f32 v180, v180, v178
    v_and_b32 v175, s76, v175
    v_add_f32 v181, v181, v179
    s_waitcnt lgkmcnt(9)
    v_mfma_f32_32x32x16_bf16 v[96:111], v[248:251], a[52:55], v[96:111]
    ds_read_b64_tr_b16 v[232:233], v26 offset:53248
    ds_read_b128 a[68:71], v161 offset:32768
    v_add_f32 v180, v180, v174
    v_add_f32 v181, v181, v175
    v_mfma_f32_32x32x16_bf16 v[112:127], v[248:251], a[180:183], v[112:127]
    ds_read_b64_tr_b16 v[234:235], v26 offset:53760
    ds_read_b128 a[196:199], v161 offset:36864
    v_lshlrev_b32 v178, 16, v176
    v_lshlrev_b32 v179, 16, v177
    v_and_b32 v176, s76, v176
    s_waitcnt lgkmcnt(10)
    v_mfma_f32_32x32x16_bf16 v[128:143], v[252:255], a[52:55], v[128:143]
    ds_read_b64_tr_b16 v[236:237], v27 offset:53248
    v_add_f32 v180, v180, v178
    v_and_b32 v177, s76, v177
    v_add_f32 v181, v181, v179
    s_mov_b32 s40, 15104
    buffer_load_dwordx4 v214, s[16:19], s40 offen offset:2048 lds
    v_mfma_f32_32x32x16_bf16 v[144:159], v[252:255], a[180:183], v[144:159]
    ds_read_b64_tr_b16 v[238:239], v27 offset:53760
    v_add_f32 v180, v180, v176
    v_add_f32 v181, v181, v177
    s_waitcnt lgkmcnt(10)
    v_mfma_f32_32x32x16_bf16 v[32:47], v[224:227], a[56:59], v[32:47]
    ds_read_b64_tr_b16 v[240:241], v24 offset:55296
    s_mov_b32 s40, 22272
    buffer_load_dwordx4 v215, s[16:19], s40 offen offset:3072 lds
    v_mfma_f32_32x32x16_bf16 v[48:63], v[224:227], a[184:187], v[48:63]
    ds_read_b64_tr_b16 v[242:243], v24 offset:55808
    s_add_u32 m0, s101, 4096
    s_mov_b32 s40, 33536
    buffer_load_dwordx4 v214, s[16:19], s40 offen offset:0 lds
    s_waitcnt lgkmcnt(9)
    v_mfma_f32_32x32x16_bf16 v[64:79], v[228:231], a[56:59], v[64:79]
    ds_read_b64_tr_b16 v[244:245], v25 offset:55296
    ds_read_b64_tr_b16 v[174:175], v168 offset:55296
    s_waitcnt lgkmcnt(10)
    v_lshlrev_b32 v178, 16, v170
    v_lshlrev_b32 v179, 16, v171
    v_and_b32 v170, s76, v170
    v_mfma_f32_32x32x16_bf16 v[80:95], v[228:231], a[184:187], v[80:95]
    ds_read_b64_tr_b16 v[246:247], v25 offset:55808
    ds_read_b64_tr_b16 v[176:177], v168 offset:55808
    v_add_f32 v180, v180, v178
    v_and_b32 v171, s76, v171
    v_add_f32 v181, v181, v179
    s_waitcnt lgkmcnt(9)
    v_mfma_f32_32x32x16_bf16 v[96:111], v[232:235], a[56:59], v[96:111]
    ds_read_b64_tr_b16 v[248:249], v26 offset:55296
    ds_read_b128 a[72:75], v162 offset:32768
    v_add_f32 v180, v180, v170
    v_add_f32 v181, v181, v171
    v_mfma_f32_32x32x16_bf16 v[112:127], v[232:235], a[184:187], v[112:127]
    ds_read_b64_tr_b16 v[250:251], v26 offset:55808
    ds_read_b128 a[200:203], v162 offset:36864
    v_lshlrev_b32 v178, 16, v172
    v_lshlrev_b32 v179, 16, v173
    v_and_b32 v172, s76, v172
    s_waitcnt lgkmcnt(10)
    v_mfma_f32_32x32x16_bf16 v[128:143], v[236:239], a[56:59], v[128:143]
    ds_read_b64_tr_b16 v[252:253], v27 offset:55296
    v_add_f32 v180, v180, v178
    v_and_b32 v173, s76, v173
    v_add_f32 v181, v181, v179
    s_mov_b32 s40, 40704
    buffer_load_dwordx4 v215, s[16:19], s40 offen offset:1024 lds
    v_mfma_f32_32x32x16_bf16 v[144:159], v[236:239], a[184:187], v[144:159]
    ds_read_b64_tr_b16 v[254:255], v27 offset:55808
    v_add_f32 v180, v180, v172
    v_add_f32 v181, v181, v173
    s_waitcnt vmcnt(18)
    s_barrier
    s_waitcnt lgkmcnt(10)
    v_mfma_f32_32x32x16_bf16 v[32:47], v[240:243], a[60:63], v[32:47]
    ds_read_b64_tr_b16 v[224:225], v24 offset:0
wpad1:
    s_cmp_eq_u32 s98, 1
    s_cbranch_scc1 WARMA_done
    s_mov_b32 s40, 47872
    buffer_load_dwordx4 v214, s[16:19], s40 offen offset:2048 lds
    v_mfma_f32_32x32x16_bf16 v[48:63], v[240:243], a[188:191], v[48:63]
    ds_read_b64_tr_b16 v[226:227], v24 offset:512
    s_mov_b32 s40, 55040
    buffer_load_dwordx4 v215, s[16:19], s40 offen offset:3072 lds
    s_waitcnt lgkmcnt(9)
    v_mfma_f32_32x32x16_bf16 v[64:79], v[244:247], a[60:63], v[64:79]
    ds_read_b64_tr_b16 v[228:229], v25 offset:0
    ds_read_b64_tr_b16 v[170:171], v168 offset:0
    s_waitcnt lgkmcnt(10)
    v_lshlrev_b32 v178, 16, v174
    v_lshlrev_b32 v179, 16, v175
    v_and_b32 v174, s76, v174
    v_mfma_f32_32x32x16_bf16 v[80:95], v[244:247], a[188:191], v[80:95]
    ds_read_b64_tr_b16 v[230:231], v25 offset:512
    ds_read_b64_tr_b16 v[172:173], v168 offset:512
    v_add_f32 v180, v180, v178
    v_and_b32 v175, s76, v175
    v_add_f32 v181, v181, v179
    s_waitcnt lgkmcnt(9)
    v_mfma_f32_32x32x16_bf16 v[96:111], v[248:251], a[60:63], v[96:111]
    ds_read_b64_tr_b16 v[232:233], v26 offset:0
    ds_read_b128 a[76:79], v163 offset:32768
    v_add_f32 v180, v180, v174
    v_add_f32 v181, v181, v175
    v_mfma_f32_32x32x16_bf16 v[112:127], v[248:251], a[188:191], v[112:127]
    ds_read_b64_tr_b16 v[234:235], v26 offset:512
    ds_read_b128 a[204:207], v163 offset:36864
    v_lshlrev_b32 v178, 16, v176
    v_lshlrev_b32 v179, 16, v177
    v_and_b32 v176, s76, v176
    s_waitcnt lgkmcnt(10)
    v_mfma_f32_32x32x16_bf16 v[128:143], v[252:255], a[60:63], v[128:143]
    ds_read_b64_tr_b16 v[236:237], v27 offset:0
    v_add_f32 v180, v180, v178
    v_and_b32 v177, s76, v177
    v_add_f32 v181, v181, v179
    s_add_u32 m0, s36, 98304
    s_mov_b32 s40, 1376256
    buffer_load_dwordx4 v30, s[24:27], s40 offen offset:0 lds
    v_mfma_f32_32x32x16_bf16 v[144:159], v[252:255], a[188:191], v[144:159]
    ds_read_b64_tr_b16 v[238:239], v27 offset:512
    v_add_f32 v180, v180, v176
    v_add_f32 v181, v181, v177
    s_waitcnt lgkmcnt(10)
    v_mfma_f32_32x32x16_bf16 v[32:47], v[224:227], a[64:67], v[32:47]
    ds_read_b64_tr_b16 v[240:241], v24 offset:2048
    s_mov_b32 s40, 1403904
    buffer_load_dwordx4 v30, s[24:27], s40 offen offset:1024 lds
    v_mfma_f32_32x32x16_bf16 v[48:63], v[224:227], a[192:195], v[48:63]
    ds_read_b64_tr_b16 v[242:243], v24 offset:2560
    s_add_u32 m0, s36, 106496
    s_mov_b32 s40, 3145728
    buffer_load_dwordx4 v31, s[12:15], s40 offen offset:0 lds
    s_waitcnt lgkmcnt(9)
    v_mfma_f32_32x32x16_bf16 v[64:79], v[228:231], a[64:67], v[64:79]
    ds_read_b64_tr_b16 v[244:245], v25 offset:2048
    ds_read_b64_tr_b16 v[174:175], v168 offset:2048
    s_waitcnt lgkmcnt(10)
    v_lshlrev_b32 v178, 16, v170
    v_lshlrev_b32 v179, 16, v171
    v_and_b32 v170, s76, v170
    v_mfma_f32_32x32x16_bf16 v[80:95], v[228:231], a[192:195], v[80:95]
    ds_read_b64_tr_b16 v[246:247], v25 offset:2560
    ds_read_b64_tr_b16 v[176:177], v168 offset:2560
    v_add_f32 v180, v180, v178
    v_and_b32 v171, s76, v171
    v_add_f32 v181, v181, v179
    s_waitcnt lgkmcnt(9)
    v_mfma_f32_32x32x16_bf16 v[96:111], v[232:235], a[64:67], v[96:111]
    ds_read_b64_tr_b16 v[248:249], v26 offset:2048
    s_waitcnt vmcnt(15)
    ds_read_b128 a[80:83], v164 offset:0
    v_add_f32 v180, v180, v170
    v_add_f32 v181, v181, v171
    v_mfma_f32_32x32x16_bf16 v[112:127], v[232:235], a[192:195], v[112:127]
    ds_read_b64_tr_b16 v[250:251], v26 offset:2560
    ds_read_b128 a[208:211], v164 offset:4096
    v_lshlrev_b32 v178, 16, v172
    v_lshlrev_b32 v179, 16, v173
    v_and_b32 v172, s76, v172
    s_waitcnt lgkmcnt(10)
    v_mfma_f32_32x32x16_bf16 v[128:143], v[236:239], a[64:67], v[128:143]
    ds_read_b64_tr_b16 v[252:253], v27 offset:2048
    v_add_f32 v180, v180, v178
    v_and_b32 v173, s76, v173
    v_add_f32 v181, v181, v179
    s_mov_b32 s40, 3210240
    buffer_load_dwordx4 v31, s[12:15], s40 offen offset:1024 lds
    v_mfma_f32_32x32x16_bf16 v[144:159], v[236:239], a[192:195], v[144:159]
    ds_read_b64_tr_b16 v[254:255], v27 offset:2560
    v_add_f32 v180, v180, v172
    v_add_f32 v181, v181, v173
    s_waitcnt lgkmcnt(10)
    v_mfma_f32_32x32x16_bf16 v[32:47], v[240:243], a[68:71], v[32:47]
    ds_read_b64_tr_b16 v[224:225], v24 offset:4096
    s_add_u32 m0, s101, 32768
    s_mov_b32 s40, 896
    buffer_load_dwordx4 v214, s[16:19], s40 offen offset:0 lds
    v_mfma_f32_32x32x16_bf16 v[48:63], v[240:243], a[196:199], v[48:63]
    ds_read_b64_tr_b16 v[226:227], v24 offset:4608
    s_mov_b32 s40, 8064
    buffer_load_dwordx4 v215, s[16:19], s40 offen offset:1024 lds
    s_waitcnt lgkmcnt(9)
    v_mfma_f32_32x32x16_bf16 v[64:79], v[244:247], a[68:71], v[64:79]
    ds_read_b64_tr_b16 v[228:229], v25 offset:4096
    ds_read_b64_tr_b16 v[170:171], v168 offset:4096
    s_waitcnt lgkmcnt(10)
    v_lshlrev_b32 v178, 16, v174
    v_lshlrev_b32 v179, 16, v175
    v_and_b32 v174, s76, v174
    v_mfma_f32_32x32x16_bf16 v[80:95], v[244:247], a[196:199], v[80:95]
    ds_read_b64_tr_b16 v[230:231], v25 offset:4608
    ds_read_b64_tr_b16 v[172:173], v168 offset:4608
    v_add_f32 v180, v180, v178
    v_and_b32 v175, s76, v175
    v_add_f32 v181, v181, v179
    s_waitcnt lgkmcnt(9)
    v_mfma_f32_32x32x16_bf16 v[96:111], v[248:251], a[68:71], v[96:111]
    ds_read_b64_tr_b16 v[232:233], v26 offset:4096
    ds_read_b128 a[84:87], v165 offset:0
    v_add_f32 v180, v180, v174
    v_add_f32 v181, v181, v175
    v_mfma_f32_32x32x16_bf16 v[112:127], v[248:251], a[196:199], v[112:127]
    ds_read_b64_tr_b16 v[234:235], v26 offset:4608
    ds_read_b128 a[212:215], v165 offset:4096
    v_lshlrev_b32 v178, 16, v176
    v_lshlrev_b32 v179, 16, v177
    v_and_b32 v176, s76, v176
    s_waitcnt lgkmcnt(10)
    v_mfma_f32_32x32x16_bf16 v[128:143], v[252:255], a[68:71], v[128:143]
    ds_read_b64_tr_b16 v[236:237], v27 offset:4096
    v_add_f32 v180, v180, v178
    v_and_b32 v177, s76, v177
    v_add_f32 v181, v181, v179
    s_mov_b32 s40, 15232
    buffer_load_dwordx4 v214, s[16:19], s40 offen offset:2048 lds
    v_mfma_f32_32x32x16_bf16 v[144:159], v[252:255], a[196:199], v[144:159]
    ds_read_b64_tr_b16 v[238:239], v27 offset:4608
    v_add_f32 v180, v180, v176
    v_add_f32 v181, v181, v177
    s_waitcnt lgkmcnt(10)
    v_mfma_f32_32x32x16_bf16 v[32:47], v[224:227], a[72:75], v[32:47]
    ds_read_b64_tr_b16 v[240:241], v24 offset:6144
    s_mov_b32 s40, 22400
    buffer_load_dwordx4 v215, s[16:19], s40 offen offset:3072 lds
    v_mfma_f32_32x32x16_bf16 v[48:63], v[224:227], a[200:203], v[48:63]
    ds_read_b64_tr_b16 v[242:243], v24 offset:6656
    s_add_u32 m0, s101, 36864
    s_mov_b32 s40, 33664
    buffer_load_dwordx4 v214, s[16:19], s40 offen offset:0 lds
    s_waitcnt lgkmcnt(9)
    v_mfma_f32_32x32x16_bf16 v[64:79], v[228:231], a[72:75], v[64:79]
    ds_read_b64_tr_b16 v[244:245], v25 offset:6144
    ds_read_b64_tr_b16 v[174:175], v168 offset:6144
    s_waitcnt lgkmcnt(10)
    v_lshlrev_b32 v178, 16, v170
    v_lshlrev_b32 v179, 16, v171
    v_and_b32 v170, s76, v170
    v_mfma_f32_32x32x16_bf16 v[80:95], v[228:231], a[200:203], v[80:95]
    ds_read_b64_tr_b16 v[246:247], v25 offset:6656
    ds_read_b64_tr_b16 v[176:177], v168 offset:6656
    v_add_f32 v180, v180, v178
    v_and_b32 v171, s76, v171
    v_add_f32 v181, v181, v179
    s_waitcnt lgkmcnt(9)
    v_mfma_f32_32x32x16_bf16 v[96:111], v[232:235], a[72:75], v[96:111]
    ds_read_b64_tr_b16 v[248:249], v26 offset:6144
    ds_read_b128 a[88:91], v166 offset:0
    v_add_f32 v180, v180, v170
    v_add_f32 v181, v181, v171
    v_mfma_f32_32x32x16_bf16 v[112:127], v[232:235], a[200:203], v[112:127]
    ds_read_b64_tr_b16 v[250:251], v26 offset:6656
    ds_read_b128 a[216:219], v166 offset:4096
    v_lshlrev_b32 v178, 16, v172
    v_lshlrev_b32 v179, 16, v173
    v_and_b32 v172, s76, v172
    s_waitcnt lgkmcnt(10)
    v_mfma_f32_32x32x16_bf16 v[128:143], v[236:239], a[72:75], v[128:143]
    ds_read_b64_tr_b16 v[252:253], v27 offset:6144
    v_add_f32 v180, v180, v178
    v_and_b32 v173, s76, v173
    v_add_f32 v181, v181, v179
    s_mov_b32 s40, 40832
    buffer_load_dwordx4 v215, s[16:19], s40 offen offset:1024 lds
    v_mfma_f32_32x32x16_bf16 v[144:159], v[236:239], a[200:203], v[144:159]
    ds_read_b64_tr_b16 v[254:255], v27 offset:6656
    v_add_f32 v180, v180, v172
    v_add_f32 v181, v181, v173
    s_waitcnt vmcnt(18)
    s_barrier
    s_cmp_lg_u32 s34, 0
    s_cbranch_scc1 stat_poll_skip
    global_load_dword v209, v212, s[62:63] sc1
stat_poll_skip:
    s_waitcnt lgkmcnt(10)
    v_mfma_f32_32x32x16_bf16 v[32:47], v[240:243], a[76:79], v[32:47]
    ds_read_b64_tr_b16 v[224:225], v24 offset:16384
    s_mov_b32 s40, 48000
    buffer_load_dwordx4 v214, s[16:19], s40 offen offset:2048 lds
    v_mfma_f32_32x32x16_bf16 v[48:63], v[240:243], a[204:207], v[48:63]
    ds_read_b64_tr_b16 v[226:227], v24 offset:16896
    s_mov_b32 s40, 55168
    buffer_load_dwordx4 v215, s[16:19], s40 offen offset:3072 lds
    s_waitcnt lgkmcnt(9)
    v_mfma_f32_32x32x16_bf16 v[64:79], v[244:247], a[76:79], v[64:79]
    ds_read_b64_tr_b16 v[228:229], v25 offset:16384
    ds_read_b64_tr_b16 v[170:171], v168 offset:16384
    s_waitcnt lgkmcnt(10)
    v_lshlrev_b32 v178, 16, v174
    v_lshlrev_b32 v179, 16, v175
    v_and_b32 v174, s76, v174
    v_mfma_f32_32x32x16_bf16 v[80:95], v[244:247], a[204:207], v[80:95]
    ds_read_b64_tr_b16 v[230:231], v25 offset:16896
    ds_read_b64_tr_b16 v[172:173], v168 offset:16896
    v_add_f32 v180, v180, v178
    v_and_b32 v175, s76, v175
    v_add_f32 v181, v181, v179
    s_waitcnt lgkmcnt(9)
    v_mfma_f32_32x32x16_bf16 v[96:111], v[248:251], a[76:79], v[96:111]
    ds_read_b64_tr_b16 v[232:233], v26 offset:16384
    ds_read_b128 a[92:95], v167 offset:0
    v_add_f32 v180, v180, v174
    v_add_f32 v181, v181, v175
    v_mfma_f32_32x32x16_bf16 v[112:127], v[248:251], a[204:207], v[112:127]
    ds_read_b64_tr_b16 v[234:235], v26 offset:16896
    ds_read_b128 a[220:223], v167 offset:4096
    v_lshlrev_b32 v178, 16, v176
    v_lshlrev_b32 v179, 16, v177
    v_and_b32 v176, s76, v176
    s_waitcnt lgkmcnt(10)
    v_mfma_f32_32x32x16_bf16 v[128:143], v[252:255], a[76:79], v[128:143]
    ds_read_b64_tr_b16 v[236:237], v27 offset:16384
    v_add_f32 v180, v180, v178
    v_and_b32 v177, s76, v177
    v_add_f32 v181, v181, v179
    s_add_u32 m0, s36, 114688
    s_mov_b32 s40, 1605632
    buffer_load_dwordx4 v30, s[24:27], s40 offen offset:0 lds
    v_mfma_f32_32x32x16_bf16 v[144:159], v[252:255], a[204:207], v[144:159]
    ds_read_b64_tr_b16 v[238:239], v27 offset:16896
    v_add_f32 v180, v180, v176
    v_add_f32 v181, v181, v177
    s_waitcnt lgkmcnt(10)
    v_mfma_f32_32x32x16_bf16 v[32:47], v[224:227], a[80:83], v[32:47]
    ds_read_b64_tr_b16 v[240:241], v24 offset:18432
    s_mov_b32 s40, 1633280
    buffer_load_dwordx4 v30, s[24:27], s40 offen offset:1024 lds
    v_mfma_f32_32x32x16_bf16 v[48:63], v[224:227], a[208:211], v[48:63]
    ds_read_b64_tr_b16 v[242:243], v24 offset:18944
    s_add_u32 m0, s36, 122880
    s_mov_b32 s40, 3670016
    buffer_load_dwordx4 v31, s[12:15], s40 offen offset:0 lds
    s_waitcnt lgkmcnt(9)
    v_mfma_f32_32x32x16_bf16 v[64:79], v[228:231], a[80:83], v[64:79]
    ds_read_b64_tr_b16 v[244:245], v25 offset:18432
    ds_read_b64_tr_b16 v[174:175], v168 offset:18432
    s_waitcnt lgkmcnt(10)
    v_lshlrev_b32 v178, 16, v170
    v_lshlrev_b32 v179, 16, v171
    v_and_b32 v170, s76, v170
    v_mfma_f32_32x32x16_bf16 v[80:95], v[228:231], a[208:211], v[80:95]
    ds_read_b64_tr_b16 v[246:247], v25 offset:18944
    ds_read_b64_tr_b16 v[176:177], v168 offset:18944
    v_add_f32 v180, v180, v178
    v_and_b32 v171, s76, v171
    v_add_f32 v181, v181, v179
    s_waitcnt lgkmcnt(9)
    v_mfma_f32_32x32x16_bf16 v[96:111], v[232:235], a[80:83], v[96:111]
    ds_read_b64_tr_b16 v[248:249], v26 offset:18432
    s_waitcnt vmcnt(15)
    ds_read_b128 a[96:99], v160 offset:0
    v_add_f32 v180, v180, v170
    v_add_f32 v181, v181, v171
    v_mfma_f32_32x32x16_bf16 v[112:127], v[232:235], a[208:211], v[112:127]
    ds_read_b64_tr_b16 v[250:251], v26 offset:18944
    ds_read_b128 a[224:227], v160 offset:4096
    v_lshlrev_b32 v178, 16, v172
    v_lshlrev_b32 v179, 16, v173
    v_and_b32 v172, s76, v172
    s_waitcnt lgkmcnt(10)
    v_mfma_f32_32x32x16_bf16 v[128:143], v[236:239], a[80:83], v[128:143]
    ds_read_b64_tr_b16 v[252:253], v27 offset:18432
    v_add_f32 v180, v180, v178
    v_and_b32 v173, s76, v173
    v_add_f32 v181, v181, v179
    s_mov_b32 s40, 3734528
    buffer_load_dwordx4 v31, s[12:15], s40 offen offset:1024 lds
    v_mfma_f32_32x32x16_bf16 v[144:159], v[236:239], a[208:211], v[144:159]
    ds_read_b64_tr_b16 v[254:255], v27 offset:18944
    v_add_f32 v180, v180, v172
    v_add_f32 v181, v181, v173
    s_waitcnt lgkmcnt(10)
    v_mfma_f32_32x32x16_bf16 v[32:47], v[240:243], a[84:87], v[32:47]
    ds_read_b64_tr_b16 v[224:225], v24 offset:20480
    v_mfma_f32_32x32x16_bf16 v[48:63], v[240:243], a[212:215], v[48:63]
    ds_read_b64_tr_b16 v[226:227], v24 offset:20992
    s_waitcnt lgkmcnt(9)
    v_mfma_f32_32x32x16_bf16 v[64:79], v[244:247], a[84:87], v[64:79]
    ds_read_b64_tr_b16 v[228:229], v25 offset:20480
    ds_read_b64_tr_b16 v[170:171], v168 offset:20480
    s_waitcnt lgkmcnt(10)
    v_lshlrev_b32 v178, 16, v174
    v_lshlrev_b32 v179, 16, v175
    v_and_b32 v174, s76, v174
    v_mfma_f32_32x32x16_bf16 v[80:95], v[244:247], a[212:215], v[80:95]
    ds_read_b64_tr_b16 v[230:231], v25 offset:20992
    ds_read_b64_tr_b16 v[172:173], v168 offset:20992
    v_add_f32 v180, v180, v178
    v_and_b32 v175, s76, v175
    v_add_f32 v181, v181, v179
    s_waitcnt lgkmcnt(9)
    v_mfma_f32_32x32x16_bf16 v[96:111], v[248:251], a[84:87], v[96:111]
    ds_read_b64_tr_b16 v[232:233], v26 offset:20480
    ds_read_b128 a[100:103], v161 offset:0
    v_add_f32 v180, v180, v174
    v_add_f32 v181, v181, v175
    v_mfma_f32_32x32x16_bf16 v[112:127], v[248:251], a[212:215], v[112:127]
    ds_read_b64_tr_b16 v[234:235], v26 offset:20992
    ds_read_b128 a[228:231], v161 offset:4096
    v_lshlrev_b32 v178, 16, v176
    v_lshlrev_b32 v179, 16, v177
    v_and_b32 v176, s76, v176
    s_waitcnt lgkmcnt(10)
    v_mfma_f32_32x32x16_bf16 v[128:143], v[252:255], a[84:87], v[128:143]
    ds_read_b64_tr_b16 v[236:237], v27 offset:20480
    v_add_f32 v180, v180, v178
    v_and_b32 v177, s76, v177
    v_add_f32 v181, v181, v179
    v_mfma_f32_32x32x16_bf16 v[144:159], v[252:255], a[212:215], v[144:159]
    ds_read_b64_tr_b16 v[238:239], v27 offset:20992
    v_add_f32 v180, v180, v176
    v_add_f32 v181, v181, v177
    s_waitcnt lgkmcnt(10)
    v_mfma_f32_32x32x16_bf16 v[32:47], v[224:227], a[88:91], v[32:47]
    ds_read_b64_tr_b16 v[240:241], v24 offset:22528
    v_mfma_f32_32x32x16_bf16 v[48:63], v[224:227], a[216:219], v[48:63]
    ds_read_b64_tr_b16 v[242:243], v24 offset:23040
    s_waitcnt lgkmcnt(9)
    v_mfma_f32_32x32x16_bf16 v[64:79], v[228:231], a[88:91], v[64:79]
    ds_read_b64_tr_b16 v[244:245], v25 offset:22528
    ds_read_b64_tr_b16 v[174:175], v168 offset:22528
    s_waitcnt lgkmcnt(10)
    v_lshlrev_b32 v178, 16, v170
    v_lshlrev_b32 v179, 16, v171
    v_and_b32 v170, s76, v170
    v_mfma_f32_32x32x16_bf16 v[80:95], v[228:231], a[216:219], v[80:95]
    ds_read_b64_tr_b16 v[246:247], v25 offset:23040
    ds_read_b64_tr_b16 v[176:177], v168 offset:23040
    v_add_f32 v180, v180, v178
    v_and_b32 v171, s76, v171
    v_add_f32 v181, v181, v179
    s_waitcnt lgkmcnt(9)
    v_mfma_f32_32x32x16_bf16 v[96:111], v[232:235], a[88:91], v[96:111]
    ds_read_b64_tr_b16 v[248:249], v26 offset:22528
    ds_read_b128 a[104:107], v162 offset:0
    v_add_f32 v180, v180, v170
    v_add_f32 v181, v181, v171
    v_mfma_f32_32x32x16_bf16 v[112:127], v[232:235], a[216:219], v[112:127]
    ds_read_b64_tr_b16 v[250:251], v26 offset:23040
    ds_read_b128 a[232:235], v162 offset:4096
    v_lshlrev_b32 v178, 16, v172
    v_lshlrev_b32 v179, 16, v173
    v_and_b32 v172, s76, v172
    s_waitcnt lgkmcnt(10)
    v_mfma_f32_32x32x16_bf16 v[128:143], v[236:239], a[88:91], v[128:143]
    ds_read_b64_tr_b16 v[252:253], v27 offset:22528
    v_add_f32 v180, v180, v178
    v_and_b32 v173, s76, v173
    v_add_f32 v181, v181, v179
    v_mfma_f32_32x32x16_bf16 v[144:159], v[236:239], a[216:219], v[144:159]
    ds_read_b64_tr_b16 v[254:255], v27 offset:23040
    v_add_f32 v180, v180, v172
    v_add_f32 v181, v181, v173
    s_waitcnt vmcnt(12)
    s_cmp_lg_u32 s34, 0
    s_cbranch_scc1 stat_ok
    s_waitcnt vmcnt(6)
    v_readfirstlane_b32 s3, v209
    s_mov_b32 s79, 0x10000
    s_nop 2
    s_cmp_ge_u32 s3, 32
    s_cbranch_scc1 stat_ok
stat_loop:
    global_load_dword v209, v212, s[62:63] sc1
    s_waitcnt vmcnt(0)
    v_readfirstlane_b32 s3, v209
    s_nop 3
    s_cmp_ge_u32 s3, 32
    s_cbranch_scc1 stat_ok
    s_sub_u32 s79, s79, 1
    s_cbranch_scc1 stat_ok
    s_sleep 1
    s_branch stat_loop
stat_ok:
    s_barrier
    v_and_b32 v210, 0x1f0, v19
    s_lshl_b32 s3, s33, 12
    s_lshl_b32 s75, s34, 10
    s_add_u32 s3, s3, s75
    v_add_u32 v210, s3, v210
    global_load_dwordx4 v[216:219], v210, s[56:57] offset:0 sc1
    global_load_dwordx4 v[220:223], v210, s[56:57] offset:512 sc1
    s_waitcnt lgkmcnt(10)
    v_mfma_f32_32x32x16_bf16 v[32:47], v[240:243], a[92:95], v[32:47]
    ds_read_b64_tr_b16 v[224:225], v24 offset:32768
    s_add_u32 m0, s36, 131072
    s_mov_b32 s40, 128
    buffer_load_dwordx4 v31, s[12:15], s40 offen offset:0 lds
    v_mfma_f32_32x32x16_bf16 v[48:63], v[240:243], a[220:223], v[48:63]
    ds_read_b64_tr_b16 v[226:227], v24 offset:33280
    s_mov_b32 s40, 64640
    buffer_load_dwordx4 v31, s[12:15], s40 offen offset:1024 lds
    s_waitcnt lgkmcnt(9)
    v_mfma_f32_32x32x16_bf16 v[64:79], v[244:247], a[92:95], v[64:79]
    ds_read_b64_tr_b16 v[228:229], v25 offset:32768
    ds_read_b64_tr_b16 v[170:171], v168 offset:32768
    s_waitcnt lgkmcnt(10)
    v_lshlrev_b32 v178, 16, v174
    v_lshlrev_b32 v179, 16, v175
    v_and_b32 v174, s76, v174
    v_mfma_f32_32x32x16_bf16 v[80:95], v[244:247], a[220:223], v[80:95]
    ds_read_b64_tr_b16 v[230:231], v25 offset:33280
    ds_read_b64_tr_b16 v[172:173], v168 offset:33280
    v_add_f32 v180, v180, v178
    v_and_b32 v175, s76, v175
    v_add_f32 v181, v181, v179
    s_waitcnt lgkmcnt(9)
    v_mfma_f32_32x32x16_bf16 v[96:111], v[248:251], a[92:95], v[96:111]
    ds_read_b64_tr_b16 v[232:233], v26 offset:32768
    ds_read_b128 a[108:111], v163 offset:0
    v_add_f32 v180, v180, v174
    v_add_f32 v181, v181, v175
    v_mfma_f32_32x32x16_bf16 v[112:127], v[248:251], a[220:223], v[112:127]
    ds_read_b64_tr_b16 v[234:235], v26 offset:33280
    ds_read_b128 a[236:239], v163 offset:4096
    v_lshlrev_b32 v178, 16, v176
    v_lshlrev_b32 v179, 16, v177
    v_and_b32 v176, s76, v176
    s_waitcnt lgkmcnt(10)
    v_mfma_f32_32x32x16_bf16 v[128:143], v[252:255], a[92:95], v[128:143]
    ds_read_b64_tr_b16 v[236:237], v27 offset:32768
    v_add_f32 v180, v180, v178
    v_and_b32 v177, s76, v177
    v_add_f32 v181, v181, v179
    s_add_u32 m0, s36, 139264
    s_mov_b32 s40, 524416
    buffer_load_dwordx4 v31, s[12:15], s40 offen offset:0 lds
    v_mfma_f32_32x32x16_bf16 v[144:159], v[252:255], a[220:223], v[144:159]
    ds_read_b64_tr_b16 v[238:239], v27 offset:33280
    v_add_f32 v180, v180, v176
    v_add_f32 v181, v181, v177
    s_waitcnt lgkmcnt(10)
    v_mfma_f32_32x32x16_bf16 v[32:47], v[224:227], a[96:99], v[32:47]
    ds_read_b64_tr_b16 v[240:241], v24 offset:34816
    s_mov_b32 s40, 588928
    buffer_load_dwordx4 v31, s[12:15], s40 offen offset:1024 lds
    v_mfma_f32_32x32x16_bf16 v[48:63], v[224:227], a[224:227], v[48:63]
    ds_read_b64_tr_b16 v[242:243], v24 offset:35328
    s_add_u32 m0, s36, 147456
    s_mov_b32 s40, 1048704
    buffer_load_dwordx4 v31, s[12:15], s40 offen offset:0 lds
    s_waitcnt lgkmcnt(9)
    v_mfma_f32_32x32x16_bf16 v[64:79], v[228:231], a[96:99], v[64:79]
    ds_read_b64_tr_b16 v[244:245], v25 offset:34816
    ds_read_b64_tr_b16 v[174:175], v168 offset:34816
    s_waitcnt lgkmcnt(10)
    v_lshlrev_b32 v178, 16, v170
    v_lshlrev_b32 v179, 16, v171
    v_and_b32 v170, s76, v170
    v_mfma_f32_32x32x16_bf16 v[80:95], v[228:231], a[224:227], v[80:95]
    ds_read_b64_tr_b16 v[246:247], v25 offset:35328
    ds_read_b64_tr_b16 v[176:177], v168 offset:35328
    v_add_f32 v180, v180, v178
    v_and_b32 v171, s76, v171
    v_add_f32 v181, v181, v179
    s_waitcnt lgkmcnt(9)
    v_mfma_f32_32x32x16_bf16 v[96:111], v[232:235], a[96:99], v[96:111]
    ds_read_b64_tr_b16 v[248:249], v26 offset:34816
    s_waitcnt vmcnt(11)
    ds_read_b128 a[112:115], v160 offset:32768
    v_add_f32 v180, v180, v170
    v_add_f32 v181, v181, v171
    v_mfma_f32_32x32x16_bf16 v[112:127], v[232:235], a[224:227], v[112:127]
    ds_read_b64_tr_b16 v[250:251], v26 offset:35328
    ds_read_b128 a[240:243], v160 offset:36864
    v_lshlrev_b32 v178, 16, v172
    v_lshlrev_b32 v179, 16, v173
    v_and_b32 v172, s76, v172
    s_waitcnt lgkmcnt(10)
    v_mfma_f32_32x32x16_bf16 v[128:143], v[236:239], a[96:99], v[128:143]
    ds_read_b64_tr_b16 v[252:253], v27 offset:34816
    v_add_f32 v180, v180, v178
    v_and_b32 v173, s76, v173
    v_add_f32 v181, v181, v179
    s_mov_b32 s40, 1113216
    buffer_load_dwordx4 v31, s[12:15], s40 offen offset:1024 lds
    v_mfma_f32_32x32x16_bf16 v[144:159], v[236:239], a[224:227], v[144:159]
    ds_read_b64_tr_b16 v[254:255], v27 offset:35328
    v_add_f32 v180, v180, v172
    v_add_f32 v181, v181, v173
    s_waitcnt lgkmcnt(10)
    v_mfma_f32_32x32x16_bf16 v[32:47], v[240:243], a[100:103], v[32:47]
    ds_read_b64_tr_b16 v[224:225], v24 offset:36864
    s_add_u32 m0, s36, 155648
    s_mov_b32 s40, 1572992
    buffer_load_dwordx4 v31, s[12:15], s40 offen offset:0 lds
    v_mfma_f32_32x32x16_bf16 v[48:63], v[240:243], a[228:231], v[48:63]
    ds_read_b64_tr_b16 v[226:227], v24 offset:37376
    s_mov_b32 s40, 1637504
    buffer_load_dwordx4 v31, s[12:15], s40 offen offset:1024 lds
    s_waitcnt lgkmcnt(9)
    v_mfma_f32_32x32x16_bf16 v[64:79], v[244:247], a[100:103], v[64:79]
    ds_read_b64_tr_b16 v[228:229], v25 offset:36864
    ds_read_b64_tr_b16 v[170:171], v168 offset:36864
    s_waitcnt lgkmcnt(10)
    v_lshlrev_b32 v178, 16, v174
    v_lshlrev_b32 v179, 16, v175
    v_and_b32 v174, s76, v174
    v_mfma_f32_32x32x16_bf16 v[80:95], v[244:247], a[228:231], v[80:95]
    ds_read_b64_tr_b16 v[230:231], v25 offset:37376
    ds_read_b64_tr_b16 v[172:173], v168 offset:37376
    v_add_f32 v180, v180, v178
    v_and_b32 v175, s76, v175
    v_add_f32 v181, v181, v179
    s_waitcnt lgkmcnt(9)
    v_mfma_f32_32x32x16_bf16 v[96:111], v[248:251], a[100:103], v[96:111]
    ds_read_b64_tr_b16 v[232:233], v26 offset:36864
    ds_read_b128 a[116:119], v161 offset:32768
    v_add_f32 v180, v180, v174
    v_add_f32 v181, v181, v175
    v_mfma_f32_32x32x16_bf16 v[112:127], v[248:251], a[228:231], v[112:127]
    ds_read_b64_tr_b16 v[234:235], v26 offset:37376
    ds_read_b128 a[244:247], v161 offset:36864
    v_lshlrev_b32 v178, 16, v176
    v_lshlrev_b32 v179, 16, v177
    v_and_b32 v176, s76, v176
    s_waitcnt lgkmcnt(10)
    v_mfma_f32_32x32x16_bf16 v[128:143], v[252:255], a[100:103], v[128:143]
    ds_read_b64_tr_b16 v[236:237], v27 offset:36864
    v_add_f32 v180, v180, v178
    v_and_b32 v177, s76, v177
    v_add_f32 v181, v181, v179
    v_mfma_f32_32x32x16_bf16 v[144:159], v[252:255], a[228:231], v[144:159]
    ds_read_b64_tr_b16 v[238:239], v27 offset:37376
    v_add_f32 v180, v180, v176
    v_add_f32 v181, v181, v177
    s_waitcnt lgkmcnt(10)
    v_mfma_f32_32x32x16_bf16 v[32:47], v[224:227], a[104:107], v[32:47]
    ds_read_b64_tr_b16 v[240:241], v24 offset:38912
    v_mfma_f32_32x32x16_bf16 v[48:63], v[224:227], a[232:235], v[48:63]
    ds_read_b64_tr_b16 v[242:243], v24 offset:39424
    s_waitcnt lgkmcnt(9)
    v_mfma_f32_32x32x16_bf16 v[64:79], v[228:231], a[104:107], v[64:79]
    ds_read_b64_tr_b16 v[244:245], v25 offset:38912
    ds_read_b64_tr_b16 v[174:175], v168 offset:38912
    s_waitcnt lgkmcnt(10)
    v_lshlrev_b32 v178, 16, v170
    v_lshlrev_b32 v179, 16, v171
    v_and_b32 v170, s76, v170
    v_mfma_f32_32x32x16_bf16 v[80:95], v[228:231], a[232:235], v[80:95]
    ds_read_b64_tr_b16 v[246:247], v25 offset:39424
    ds_read_b64_tr_b16 v[176:177], v168 offset:39424
    v_add_f32 v180, v180, v178
    v_and_b32 v171, s76, v171
    v_add_f32 v181, v181, v179
    s_waitcnt lgkmcnt(9)
    v_mfma_f32_32x32x16_bf16 v[96:111], v[232:235], a[104:107], v[96:111]
    ds_read_b64_tr_b16 v[248:249], v26 offset:38912
    ds_read_b128 a[120:123], v162 offset:32768
    v_add_f32 v180, v180, v170
    v_add_f32 v181, v181, v171
    v_mfma_f32_32x32x16_bf16 v[112:127], v[232:235], a[232:235], v[112:127]
    ds_read_b64_tr_b16 v[250:251], v26 offset:39424
    ds_read_b128 a[248:251], v162 offset:36864
    v_lshlrev_b32 v178, 16, v172
    v_lshlrev_b32 v179, 16, v173
    v_and_b32 v172, s76, v172
    s_waitcnt lgkmcnt(10)
    v_mfma_f32_32x32x16_bf16 v[128:143], v[236:239], a[104:107], v[128:143]
    ds_read_b64_tr_b16 v[252:253], v27 offset:38912
    v_add_f32 v180, v180, v178
    v_and_b32 v173, s76, v173
    v_add_f32 v181, v181, v179
    v_mfma_f32_32x32x16_bf16 v[144:159], v[236:239], a[232:235], v[144:159]
    ds_read_b64_tr_b16 v[254:255], v27 offset:39424
    v_add_f32 v180, v180, v172
    v_add_f32 v181, v181, v173
    s_waitcnt vmcnt(10)
    s_barrier
    s_waitcnt lgkmcnt(10)
    v_mfma_f32_32x32x16_bf16 v[32:47], v[240:243], a[108:111], v[32:47]
    ds_read_b64_tr_b16 v[224:225], v24 offset:49152
    v_mfma_f32_32x32x16_bf16 v[48:63], v[240:243], a[236:239], v[48:63]
    ds_read_b64_tr_b16 v[226:227], v24 offset:49664
    s_waitcnt lgkmcnt(9)
    v_mfma_f32_32x32x16_bf16 v[64:79], v[244:247], a[108:111], v[64:79]
    ds_read_b64_tr_b16 v[228:229], v25 offset:49152
    ds_read_b64_tr_b16 v[170:171], v168 offset:49152
    s_waitcnt lgkmcnt(10)
    v_lshlrev_b32 v178, 16, v174
    v_lshlrev_b32 v179, 16, v175
    v_and_b32 v174, s76, v174
    v_mfma_f32_32x32x16_bf16 v[80:95], v[244:247], a[236:239], v[80:95]
    ds_read_b64_tr_b16 v[230:231], v25 offset:49664
    ds_read_b64_tr_b16 v[172:173], v168 offset:49664
    v_add_f32 v180, v180, v178
    v_and_b32 v175, s76, v175
    v_add_f32 v181, v181, v179
    s_waitcnt lgkmcnt(9)
    v_mfma_f32_32x32x16_bf16 v[96:111], v[248:251], a[108:111], v[96:111]
    ds_read_b64_tr_b16 v[232:233], v26 offset:49152
    ds_read_b128 a[124:127], v163 offset:32768
    v_add_f32 v180, v180, v174
    v_add_f32 v181, v181, v175
    v_mfma_f32_32x32x16_bf16 v[112:127], v[248:251], a[236:239], v[112:127]
    ds_read_b64_tr_b16 v[234:235], v26 offset:49664
    ds_read_b128 a[252:255], v163 offset:36864
    v_lshlrev_b32 v178, 16, v176
    v_lshlrev_b32 v179, 16, v177
    v_and_b32 v176, s76, v176
    s_waitcnt lgkmcnt(10)
    v_mfma_f32_32x32x16_bf16 v[128:143], v[252:255], a[108:111], v[128:143]
    ds_read_b64_tr_b16 v[236:237], v27 offset:49152
    v_add_f32 v180, v180, v178
    v_and_b32 v177, s76, v177
    v_add_f32 v181, v181, v179
    v_mfma_f32_32x32x16_bf16 v[144:159], v[252:255], a[236:239], v[144:159]
    ds_read_b64_tr_b16 v[238:239], v27 offset:49664
    v_add_f32 v180, v180, v176
    v_add_f32 v181, v181, v177
    s_waitcnt lgkmcnt(10)
    v_mfma_f32_32x32x16_bf16 v[32:47], v[224:227], a[112:115], v[32:47]
    ds_read_b64_tr_b16 v[240:241], v24 offset:51200
    v_mfma_f32_32x32x16_bf16 v[48:63], v[224:227], a[240:243], v[48:63]
    ds_read_b64_tr_b16 v[242:243], v24 offset:51712
    s_waitcnt lgkmcnt(9)
    v_mfma_f32_32x32x16_bf16 v[64:79], v[228:231], a[112:115], v[64:79]
    ds_read_b64_tr_b16 v[244:245], v25 offset:51200
    ds_read_b64_tr_b16 v[174:175], v168 offset:51200
    s_waitcnt lgkmcnt(10)
    v_lshlrev_b32 v178, 16, v170
    v_lshlrev_b32 v179, 16, v171
    v_and_b32 v170, s76, v170
    v_mfma_f32_32x32x16_bf16 v[80:95], v[228:231], a[240:243], v[80:95]
    ds_read_b64_tr_b16 v[246:247], v25 offset:51712
    ds_read_b64_tr_b16 v[176:177], v168 offset:51712
    v_add_f32 v180, v180, v178
    v_and_b32 v171, s76, v171
    v_add_f32 v181, v181, v179
    s_waitcnt lgkmcnt(9)
    v_mfma_f32_32x32x16_bf16 v[96:111], v[232:235], a[112:115], v[96:111]
    ds_read_b64_tr_b16 v[248:249], v26 offset:51200
    ds_read_b64_tr_b16 v[192:193], v168 offset:53248
    v_add_f32 v180, v180, v170
    v_add_f32 v181, v181, v171
    v_mfma_f32_32x32x16_bf16 v[112:127], v[232:235], a[240:243], v[112:127]
    ds_read_b64_tr_b16 v[250:251], v26 offset:51712
    ds_read_b64_tr_b16 v[194:195], v168 offset:53760
    v_lshlrev_b32 v178, 16, v172
    v_lshlrev_b32 v179, 16, v173
    v_and_b32 v172, s76, v172
    s_waitcnt lgkmcnt(10)
    v_mfma_f32_32x32x16_bf16 v[128:143], v[236:239], a[112:115], v[128:143]
    ds_read_b64_tr_b16 v[252:253], v27 offset:51200
    v_add_f32 v180, v180, v178
    v_and_b32 v173, s76, v173
    v_add_f32 v181, v181, v179
    v_mfma_f32_32x32x16_bf16 v[144:159], v[236:239], a[240:243], v[144:159]
    ds_read_b64_tr_b16 v[254:255], v27 offset:51712
    v_add_f32 v180, v180, v172
    v_add_f32 v181, v181, v173
    s_waitcnt lgkmcnt(10)
    v_mfma_f32_32x32x16_bf16 v[32:47], v[240:243], a[116:119], v[32:47]
    ds_read_b64_tr_b16 v[224:225], v24 offset:53248
    v_lshrrev_b32 v30, 1, v19
wpad2:
    s_cmp_eq_u32 s98, 1
    s_cbranch_scc1 WARMA_done
    s_lshl_b32 s3, s34, 9
    s_add_u32 s3, s3, 49152
    v_add_u32 v182, s3, v30
    v_add_u32 v30, 49152, v30
    v_mfma_f32_32x32x16_bf16 v[48:63], v[240:243], a[244:247], v[48:63]
    ds_read_b64_tr_b16 v[226:227], v24 offset:53760
    s_waitcnt lgkmcnt(9)
    v_mfma_f32_32x32x16_bf16 v[64:79], v[244:247], a[116:119], v[64:79]
    ds_read_b64_tr_b16 v[228:229], v25 offset:53248
    ds_read_b64_tr_b16 v[196:197], v168 offset:55296
    s_waitcnt lgkmcnt(10)
    s_waitcnt lgkmcnt(6)
    v_lshlrev_b32 v178, 16, v174
    v_lshlrev_b32 v179, 16, v175
    v_and_b32 v174, s76, v174
    v_add_f32 v180, v180, v178
    v_and_b32 v175, s76, v175
    v_add_f32 v181, v181, v179
    v_mfma_f32_32x32x16_bf16 v[80:95], v[244:247], a[244:247], v[80:95]
    ds_read_b64_tr_b16 v[230:231], v25 offset:53760
    ds_read_b64_tr_b16 v[198:199], v168 offset:55808
    v_add_f32 v180, v180, v174
    v_add_f32 v181, v181, v175
    v_lshlrev_b32 v178, 16, v176
    v_lshlrev_b32 v179, 16, v177
    v_and_b32 v176, s76, v176
    v_mfma_f32_32x32x16_bf16 v[96:111], v[248:251], a[116:119], v[96:111]
    ds_read_b64_tr_b16 v[232:233], v26 offset:53248
    v_add_f32 v180, v180, v178
    v_and_b32 v177, s76, v177
    v_add_f32 v181, v181, v179
    v_add_f32 v180, v180, v176
    v_add_f32 v181, v181, v177
    v_mfma_f32_32x32x16_bf16 v[112:127], v[248:251], a[244:247], v[112:127]
    ds_read_b64_tr_b16 v[234:235], v26 offset:53760
    v_lshlrev_b32 v178, 16, v192
    v_lshlrev_b32 v179, 16, v193
    v_and_b32 v192, s76, v192
    v_add_f32 v180, v180, v178
    v_and_b32 v193, s76, v193
    v_add_f32 v181, v181, v179
    s_waitcnt lgkmcnt(8)
    v_mfma_f32_32x32x16_bf16 v[128:143], v[252:255], a[116:119], v[128:143]
    ds_read_b64_tr_b16 v[236:237], v27 offset:53248
    v_add_f32 v180, v180, v192
    v_add_f32 v181, v181, v193
    v_lshlrev_b32 v178, 16, v194
    v_lshlrev_b32 v179, 16, v195
    v_and_b32 v194, s76, v194
    v_mfma_f32_32x32x16_bf16 v[144:159], v[252:255], a[244:247], v[144:159]
    ds_read_b64_tr_b16 v[238:239], v27 offset:53760
    v_add_f32 v180, v180, v178
    v_and_b32 v195, s76, v195
    v_add_f32 v181, v181, v179
    v_add_f32 v180, v180, v194
    v_add_f32 v181, v181, v195
    s_waitcnt vmcnt(0)
    s_barrier
    s_waitcnt lgkmcnt(8)
    v_mfma_f32_32x32x16_bf16 v[32:47], v[224:227], a[120:123], v[32:47]
    ds_read_b64_tr_b16 v[240:241], v24 offset:55296
    s_add_u32 m0, s36, 98304
    s_mov_b32 s40, 2097280
    buffer_load_dwordx4 v31, s[12:15], s40 offen offset:0 lds
    v_mfma_f32_32x32x16_bf16 v[48:63], v[224:227], a[248:251], v[48:63]
    ds_read_b64_tr_b16 v[242:243], v24 offset:55808
    s_mov_b32 s40, 2161792
    buffer_load_dwordx4 v31, s[12:15], s40 offen offset:1024 lds
    s_waitcnt lgkmcnt(7)
    v_mfma_f32_32x32x16_bf16 v[64:79], v[228:231], a[120:123], v[64:79]
    ds_read_b64_tr_b16 v[244:245], v25 offset:55296
    s_waitcnt lgkmcnt(7)
    v_lshlrev_b32 v178, 16, v196
    v_lshlrev_b32 v179, 16, v197
    v_and_b32 v196, s76, v196
    v_add_f32 v180, v180, v178
    v_and_b32 v197, s76, v197
    v_add_f32 v181, v181, v179
    v_mfma_f32_32x32x16_bf16 v[80:95], v[228:231], a[248:251], v[80:95]
    ds_read_b64_tr_b16 v[246:247], v25 offset:55808
    v_add_f32 v180, v180, v196
    v_add_f32 v181, v181, v197
    v_lshlrev_b32 v178, 16, v198
    v_lshlrev_b32 v179, 16, v199
    v_and_b32 v198, s76, v198
    s_waitcnt lgkmcnt(6)
    v_mfma_f32_32x32x16_bf16 v[96:111], v[232:235], a[120:123], v[96:111]
    ds_read_b64_tr_b16 v[248:249], v26 offset:55296
    v_add_f32 v180, v180, v178
    v_and_b32 v199, s76, v199
    v_add_f32 v181, v181, v179
    v_add_f32 v180, v180, v198
    v_add_f32 v181, v181, v199
    v_add_f32 v180, v180, v181
    v_mfma_f32_32x32x16_bf16 v[112:127], v[232:235], a[248:251], v[112:127]
    ds_read_b64_tr_b16 v[250:251], v26 offset:55808
    v_mov_b32 v178, v180
    s_mov_b32 vcc_lo, 0
    s_mov_b32 vcc_hi, -1
    v_permlane32_swap_b32 v180, v178
    s_nop 1
    s_waitcnt lgkmcnt(6)
    v_mfma_f32_32x32x16_bf16 v[128:143], v[236:239], a[120:123], v[128:143]
    ds_read_b64_tr_b16 v[252:253], v27 offset:55296
    v_add_f32 v180, v180, v178
    v_cvt_pk_bf16_f32 v170, v180, v180
    v_lshlrev_b32 v178, 16, v170
    v_sub_f32 v183, v180, v178
    v_cvt_pk_bf16_f32 v171, v183, v183
    v_lshlrev_b32 v178, 16, v171
    s_add_u32 m0, s36, 106496
    s_mov_b32 s40, 2621568
    buffer_load_dwordx4 v31, s[12:15], s40 offen offset:0 lds
    v_mfma_f32_32x32x16_bf16 v[144:159], v[236:239], a[248:251], v[144:159]
    ds_read_b64_tr_b16 v[254:255], v27 offset:55808
    v_sub_f32 v169, v183, v178
    v_cvt_pk_bf16_f32 v178, v180, v169
    v_cvt_pk_bf16_f32 v169, v183, v169
    v_cndmask_b32 v170, v170, v178, vcc
    v_cndmask_b32 v171, v171, v169, vcc
    ds_write_b64 v182, v[170:171]
    s_waitcnt lgkmcnt(7)
    v_mfma_f32_32x32x16_bf16 v[32:47], v[240:243], a[124:127], v[32:47]
    ds_read_b64_tr_b16 v[224:225], v28 offset:32768
    s_mov_b32 vcc_lo, 0
    s_mov_b32 vcc_hi, -1
    v_cvt_pk_bf16_f32 v208, v216, v216
    v_lshlrev_b32 v213, 16, v208
    v_sub_f32 v183, v216, v213
    v_cvt_pk_bf16_f32 v209, v183, v183
    v_lshlrev_b32 v213, 16, v209
    v_sub_f32 v169, v183, v213
    s_mov_b32 s40, 2686080
    buffer_load_dwordx4 v31, s[12:15], s40 offen offset:1024 lds
    v_mfma_f32_32x32x16_bf16 v[48:63], v[240:243], a[252:255], v[48:63]
    ds_read_b64_tr_b16 v[226:227], v28 offset:33280
    v_cvt_pk_bf16_f32 v208, v216, v183
    v_cvt_pk_bf16_f32 v213, v169, v216
    v_cvt_pk_bf16_f32 v169, v169, v183
    v_cndmask_b32 v209, v208, v169, vcc
    v_cndmask_b32 v208, v208, v213, vcc
    v_mov_b32 v24, v217
    v_mov_b32 v26, v218
    v_mov_b32 v25, v221
    v_mov_b32 v27, v222
    s_waitcnt lgkmcnt(7)
    v_mfma_f32_32x32x16_bf16 v[64:79], v[244:247], a[124:127], v[64:79]
    ds_read_b64_tr_b16 v[228:229], v29 offset:32768
    v_cvt_pk_bf16_f32 v210, v220, v220
    v_lshlrev_b32 v213, 16, v210
    v_sub_f32 v183, v220, v213
    v_cvt_pk_bf16_f32 v211, v183, v183
    v_lshlrev_b32 v213, 16, v211
    v_sub_f32 v169, v183, v213
    v_mfma_f32_32x32x16_bf16 v[80:95], v[244:247], a[252:255], v[80:95]
    ds_read_b64_tr_b16 v[230:231], v29 offset:33280
    s_waitcnt lgkmcnt(4)
    s_barrier
    ds_read_b64 v[200:201], v30 offset:0
    v_cvt_pk_bf16_f32 v210, v220, v183
    v_cvt_pk_bf16_f32 v213, v169, v220
    v_cvt_pk_bf16_f32 v169, v169, v183
    v_cndmask_b32 v211, v210, v169, vcc
    v_cndmask_b32 v210, v210, v213, vcc
    v_mfma_f32_32x32x16_bf16 v[96:111], v[248:251], a[124:127], v[96:111]
    ds_read_b64_tr_b16 v[232:233], v28 offset:34816
    ds_read_b64 v[202:203], v30 offset:512
    v_mfma_f32_32x32x16_bf16 v[112:127], v[248:251], a[252:255], v[112:127]
    ds_read_b64_tr_b16 v[234:235], v28 offset:35328
    ds_read_b64 v[204:205], v30 offset:1024
    v_mfma_f32_32x32x16_bf16 v[128:143], v[252:255], a[124:127], v[128:143]
    ds_read_b64_tr_b16 v[236:237], v29 offset:34816
    ds_read_b64 v[206:207], v30 offset:1536
    v_mfma_f32_32x32x16_bf16 v[144:159], v[252:255], a[252:255], v[144:159]
    ds_read_b64_tr_b16 v[238:239], v29 offset:35328
    s_waitcnt lgkmcnt(7)
    v_mfma_f32_32x32x8_bf16 v[32:47], v[200:201], v[208:209], v[32:47]
    v_mfma_f32_32x32x8_bf16 v[48:63], v[200:201], v[210:211], v[48:63]
    s_waitcnt lgkmcnt(5)
    v_mfma_f32_32x32x8_bf16 v[64:79], v[202:203], v[208:209], v[64:79]
    v_mfma_f32_32x32x8_bf16 v[80:95], v[202:203], v[210:211], v[80:95]
    s_waitcnt lgkmcnt(3)
    v_mfma_f32_32x32x8_bf16 v[96:111], v[204:205], v[208:209], v[96:111]
    v_mfma_f32_32x32x8_bf16 v[112:127], v[204:205], v[210:211], v[112:127]
    s_waitcnt lgkmcnt(1)
    v_mfma_f32_32x32x8_bf16 v[128:143], v[206:207], v[208:209], v[128:143]
    v_mfma_f32_32x32x8_bf16 v[144:159], v[206:207], v[210:211], v[144:159]
    v_mov_b32 v254, v208
    v_mov_b32 v255, v210
    v_mov_b32 v250, v209
    v_mov_b32 v251, v211
    s_barrier
    v_mfma_f32_32x32x16_bf16 v[160:175], v[224:227], a[0:3], 0
    ds_read_b64_tr_b16 v[240:241], v28 offset:36864
    v_mfma_f32_32x32x16_bf16 v[176:191], v[224:227], a[128:131], 0
    ds_read_b64_tr_b16 v[242:243], v28 offset:37376
    s_add_u32 m0, s36, 114688
    s_mov_b32 s40, 3145856
    buffer_load_dwordx4 v31, s[12:15], s40 offen offset:0 lds
    v_mfma_f32_32x32x16_bf16 v[192:207], v[228:231], a[0:3], 0
    ds_read_b64_tr_b16 v[244:245], v29 offset:36864
    v_mfma_f32_32x32x16_bf16 v[208:223], v[228:231], a[128:131], 0
    ds_read_b64_tr_b16 v[246:247], v29 offset:37376
    s_mov_b32 s40, 3210368
    buffer_load_dwordx4 v31, s[12:15], s40 offen offset:1024 lds
    v_mfma_f32_32x32x16_bf16 v[160:175], v[232:235], a[4:7], v[160:175]
    ds_read_b64_tr_b16 v[224:225], v28 offset:38912
    s_bitcmp1_b32 s34, 0
    s_cselect_b64 vcc, -1, 0
    s_lshr_b32 s3, s34, 1
    s_lshl_b32 s3, s3, 11
    v_cndmask_b32 v30, v28, v29, vcc
    v_add_u32 v30, s3, v30
    v_mfma_f32_32x32x16_bf16 v[176:191], v[232:235], a[132:135], v[176:191]
    ds_read_b64_tr_b16 v[226:227], v28 offset:39424
    v_mov_b32 v248, 0x3f803f80
    v_lshrrev_b32 v253, 1, v19
    s_lshl_b32 s3, s34, 9
    s_add_u32 s3, s3, 51200
    v_add_u32 v252, s3, v253
    v_add_u32 v253, 51200, v253
    s_add_u32 m0, s36, 122880
    s_mov_b32 s40, 3670144
    buffer_load_dwordx4 v31, s[12:15], s40 offen offset:0 lds
    s_waitcnt lgkmcnt(6)
    v_mfma_f32_32x32x16_bf16 v[192:207], v[236:239], a[4:7], v[192:207]
    ds_read_b64_tr_b16 v[228:229], v29 offset:38912
    v_accvgpr_write_b32 a0, v248
    v_accvgpr_write_b32 a1, v248
    v_mul_f32 v20, v24, v32
    v_mul_f32 v21, v24, v33
    v_exp_f32 v20, v20
    v_mfma_f32_32x32x16_bf16 v[208:223], v[236:239], a[132:135], v[208:223]
    ds_read_b64_tr_b16 v[230:231], v29 offset:39424
    s_mov_b32 s40, 3734656
    buffer_load_dwordx4 v31, s[12:15], s40 offen offset:1024 lds
    v_exp_f32 v21, v21
    v_fma_f32 v20, v20, v26, v26
    s_waitcnt lgkmcnt(6)
    v_mfma_f32_32x32x16_bf16 v[160:175], v[240:243], a[8:11], v[160:175]
    ds_read_b64_tr_b16 v[232:233], v28 offset:40960
    ds_read_b64_tr_b16 a[128:129], v30 offset:32768
    v_fma_f32 v21, v21, v26, v26
    v_rcp_f32 v20, v20
    v_rcp_f32 v21, v21
    v_mul_f32 v32, v32, v20
    v_mfma_f32_32x32x16_bf16 v[176:191], v[240:243], a[136:139], v[176:191]
    ds_read_b64_tr_b16 v[234:235], v28 offset:41472
    s_add_u32 m0, s35, 65536
    s_mov_b32 s43, 0
    buffer_load_dwordx4 v18, s[8:11], s43 offen offset:0 lds
    v_mul_f32 v33, v33, v21
    v_cvt_pk_bf16_f32 v32, v32, v33
    v_mul_f32 v22, v24, v34
    s_waitcnt lgkmcnt(7)
    v_mfma_f32_32x32x16_bf16 v[192:207], v[244:247], a[8:11], v[192:207]
    ds_read_b64_tr_b16 v[236:237], v29 offset:40960
    ds_read_b64_tr_b16 a[130:131], v30 offset:33280
    v_mul_f32 v23, v24, v35
    v_exp_f32 v22, v22
    v_exp_f32 v23, v23
    v_fma_f32 v22, v22, v26, v26
    v_mfma_f32_32x32x16_bf16 v[208:223], v[244:247], a[136:139], v[208:223]
    ds_read_b64_tr_b16 v[238:239], v29 offset:41472
    buffer_load_dwordx4 v1, s[8:11], s43 offen offset:1024 lds
    v_fma_f32 v23, v23, v26, v26
    v_rcp_f32 v22, v22
    s_waitcnt lgkmcnt(8)
    v_mfma_f32_32x32x16_bf16 v[160:175], v[224:227], a[12:15], v[160:175]
    ds_read_b64_tr_b16 v[240:241], v28 offset:43008
    ds_read_b64_tr_b16 a[132:133], v30 offset:36864
    s_waitcnt lgkmcnt(6)
    v_mfma_f32_4x4x4_16b_bf16 a[4:7], a[0:1], a[128:129], 0
    v_rcp_f32 v23, v23
    v_mul_f32 v34, v34, v22
    v_mul_f32 v35, v35, v23
    v_cvt_pk_bf16_f32 v33, v34, v35
    v_mfma_f32_32x32x16_bf16 v[176:191], v[224:227], a[140:143], v[176:191]
    ds_read_b64_tr_b16 v[242:243], v28 offset:43520
    buffer_load_dwordx4 v18, s[8:11], s43 offen offset:2048 lds
    v_mul_f32 v20, v24, v36
    v_mul_f32 v21, v24, v37
    v_mfma_f32_32x32x16_bf16 v[192:207], v[228:231], a[12:15], v[192:207]
    ds_read_b64_tr_b16 v[244:245], v29 offset:43008
    ds_read_b64_tr_b16 a[134:135], v30 offset:37376
    s_waitcnt lgkmcnt(6)
    v_mfma_f32_4x4x4_16b_bf16 a[4:7], a[0:1], a[130:131], a[4:7]
    v_exp_f32 v20, v20
    v_exp_f32 v21, v21
    v_fma_f32 v20, v20, v26, v26
    v_mfma_f32_32x32x16_bf16 v[208:223], v[228:231], a[140:143], v[208:223]
    ds_read_b64_tr_b16 v[246:247], v29 offset:43520
    buffer_load_dwordx4 v1, s[8:11], s43 offen offset:3072 lds
    v_fma_f32 v21, v21, v26, v26
    v_rcp_f32 v20, v20
    v_mfma_f32_32x32x16_bf16 v[160:175], v[232:235], a[16:19], v[160:175]
    ds_read_b64_tr_b16 v[224:225], v28 offset:45056
    ds_read_b64_tr_b16 a[128:129], v30 offset:40960
    s_waitcnt lgkmcnt(6)
    v_mfma_f32_4x4x4_16b_bf16 a[4:7], a[0:1], a[132:133], a[4:7]
    v_rcp_f32 v21, v21
    v_mul_f32 v36, v36, v20
    v_mul_f32 v37, v37, v21
    v_cvt_pk_bf16_f32 v34, v36, v37
    v_mfma_f32_32x32x16_bf16 v[176:191], v[232:235], a[144:147], v[176:191]
    ds_read_b64_tr_b16 v[226:227], v28 offset:45568
    s_add_u32 m0, s35, 81920
    s_mov_b32 s43, 16384
    buffer_load_dwordx4 v18, s[8:11], s43 offen offset:0 lds
    v_mul_f32 v22, v24, v38
    v_mul_f32 v23, v24, v39
    v_mfma_f32_32x32x16_bf16 v[192:207], v[236:239], a[16:19], v[192:207]
    ds_read_b64_tr_b16 v[228:229], v29 offset:45056
    ds_read_b64_tr_b16 a[130:131], v30 offset:41472
    s_waitcnt lgkmcnt(6)
    v_mfma_f32_4x4x4_16b_bf16 a[4:7], a[0:1], a[134:135], a[4:7]
    v_exp_f32 v22, v22
    v_exp_f32 v23, v23
    v_fma_f32 v22, v22, v26, v26
    v_mfma_f32_32x32x16_bf16 v[208:223], v[236:239], a[144:147], v[208:223]
    ds_read_b64_tr_b16 v[230:231], v29 offset:45568
    buffer_load_dwordx4 v1, s[8:11], s43 offen offset:1024 lds
    v_fma_f32 v23, v23, v26, v26
    v_rcp_f32 v22, v22
    v_mfma_f32_32x32x16_bf16 v[160:175], v[240:243], a[20:23], v[160:175]
    ds_read_b64_tr_b16 v[232:233], v28 offset:47104
    ds_read_b64_tr_b16 a[132:133], v30 offset:45056
    s_waitcnt lgkmcnt(6)
    v_mfma_f32_4x4x4_16b_bf16 a[4:7], a[0:1], a[128:129], a[4:7]
    v_rcp_f32 v23, v23
    v_mul_f32 v38, v38, v22
    v_mul_f32 v39, v39, v23
    v_cvt_pk_bf16_f32 v35, v38, v39
    v_mfma_f32_32x32x16_bf16 v[176:191], v[240:243], a[148:151], v[176:191]
    ds_read_b64_tr_b16 v[234:235], v28 offset:47616
    buffer_load_dwordx4 v18, s[8:11], s43 offen offset:2048 lds
    s_mov_b32 s41, 0
    buffer_store_dwordx4 v[32:35], v19, s[28:31], s41 offen offset:0 sc1
    v_mfma_f32_32x32x16_bf16 v[192:207], v[244:247], a[20:23], v[192:207]
    ds_read_b64_tr_b16 v[236:237], v29 offset:47104
    ds_read_b64_tr_b16 a[134:135], v30 offset:45568
    s_waitcnt lgkmcnt(6)
    v_mfma_f32_4x4x4_16b_bf16 a[4:7], a[0:1], a[130:131], a[4:7]
    v_mul_f32 v20, v24, v40
    v_mul_f32 v21, v24, v41
    v_exp_f32 v20, v20
    v_mfma_f32_32x32x16_bf16 v[208:223], v[244:247], a[148:151], v[208:223]
    ds_read_b64_tr_b16 v[238:239], v29 offset:47616
    buffer_load_dwordx4 v1, s[8:11], s43 offen offset:3072 lds
    v_exp_f32 v21, v21
    v_fma_f32 v20, v20, v26, v26
    v_mfma_f32_32x32x16_bf16 v[160:175], v[224:227], a[24:27], v[160:175]
    ds_read_b64_tr_b16 v[240:241], v28 offset:49152
    ds_read_b64_tr_b16 a[128:129], v30 offset:49152
    v_accvgpr_write_b32 a8, v254
    v_accvgpr_write_b32 a9, v250
    s_waitcnt lgkmcnt(6)
    v_mfma_f32_4x4x4_16b_bf16 a[4:7], a[0:1], a[132:133], a[4:7]
    v_fma_f32 v21, v21, v26, v26
    v_rcp_f32 v20, v20
    v_mfma_f32_32x32x16_bf16 v[176:191], v[224:227], a[152:155], v[176:191]
    ds_read_b64_tr_b16 v[242:243], v28 offset:49664
    v_accvgpr_write_b32 a10, v254
    v_accvgpr_write_b32 a11, v250
    s_add_u32 m0, s35, 0
    s_mov_b32 s43, 0
    buffer_load_dwordx4 v14, s[4:7], s43 offen offset:0 lds
    v_mfma_f32_32x32x16_bf16 v[192:207], v[228:231], a[24:27], v[192:207]
    ds_read_b64_tr_b16 v[244:245], v29 offset:49152
    ds_read_b64_tr_b16 a[130:131], v30 offset:49664
    v_accvgpr_write_b32 a12, v255
    v_accvgpr_write_b32 a13, v251
    s_waitcnt lgkmcnt(6)
    v_mfma_f32_4x4x4_16b_bf16 a[4:7], a[0:1], a[134:135], a[4:7]
    v_rcp_f32 v21, v21
    v_mul_f32 v40, v40, v20
    v_mfma_f32_32x32x16_bf16 v[208:223], v[228:231], a[152:155], v[208:223]
    ds_read_b64_tr_b16 v[246:247], v29 offset:49664
    v_accvgpr_write_b32 a14, v255
    v_accvgpr_write_b32 a15, v251
    buffer_load_dwordx4 v15, s[4:7], s43 offen offset:1024 lds
    v_mul_f32 v41, v41, v21
    v_mfma_f32_32x32x16_bf16 v[160:175], v[232:235], a[28:31], v[160:175]
    ds_read_b64_tr_b16 v[224:225], v28 offset:51200
    ds_read_b64_tr_b16 a[132:133], v30 offset:53248
    s_waitcnt lgkmcnt(6)
    v_mfma_f32_4x4x4_16b_bf16 a[4:7], a[0:1], a[128:129], a[4:7]
    v_cvt_pk_bf16_f32 v40, v40, v41
    v_mul_f32 v22, v24, v42
    v_mul_f32 v23, v24, v43
    v_exp_f32 v22, v22
    v_mfma_f32_32x32x16_bf16 v[176:191], v[232:235], a[156:159], v[176:191]
    ds_read_b64_tr_b16 v[226:227], v28 offset:51712
    buffer_load_dwordx4 v16, s[4:7], s43 offen offset:2048 lds
    v_exp_f32 v23, v23
    v_fma_f32 v22, v22, v26, v26
    v_mfma_f32_32x32x16_bf16 v[192:207], v[236:239], a[28:31], v[192:207]
    ds_read_b64_tr_b16 v[228:229], v29 offset:51200
    ds_read_b64_tr_b16 a[134:135], v30 offset:53760
    s_waitcnt lgkmcnt(6)
    v_mfma_f32_4x4x4_16b_bf16 a[4:7], a[0:1], a[130:131], a[4:7]
    v_fma_f32 v23, v23, v26, v26
    v_rcp_f32 v22, v22
    v_rcp_f32 v23, v23
    v_mfma_f32_32x32x16_bf16 v[208:223], v[236:239], a[156:159], v[208:223]
    ds_read_b64_tr_b16 v[230:231], v29 offset:51712
    buffer_load_dwordx4 v17, s[4:7], s43 offen offset:3072 lds
    v_mul_f32 v42, v42, v22
    v_mul_f32 v43, v43, v23
    v_cvt_pk_bf16_f32 v41, v42, v43
    v_mfma_f32_32x32x16_bf16 v[160:175], v[240:243], a[32:35], v[160:175]
    ds_read_b64_tr_b16 v[232:233], v28 offset:53248
    ds_read_b64_tr_b16 a[128:129], v30 offset:57344
    s_waitcnt lgkmcnt(6)
    v_mfma_f32_4x4x4_16b_bf16 a[4:7], a[0:1], a[132:133], a[4:7]
    v_mul_f32 v20, v24, v44
    v_mul_f32 v21, v24, v45
    v_exp_f32 v20, v20
    v_mfma_f32_32x32x16_bf16 v[176:191], v[240:243], a[160:163], v[176:191]
    ds_read_b64_tr_b16 v[234:235], v28 offset:53760
    v_exp_f32 v21, v21
    v_fma_f32 v20, v20, v26, v26
    v_fma_f32 v21, v21, v26, v26
    v_rcp_f32 v20, v20
    v_mfma_f32_32x32x16_bf16 v[192:207], v[244:247], a[32:35], v[192:207]
    ds_read_b64_tr_b16 v[236:237], v29 offset:53248
    ds_read_b64_tr_b16 a[130:131], v30 offset:57856
    s_waitcnt lgkmcnt(6)
    v_mfma_f32_4x4x4_16b_bf16 a[4:7], a[0:1], a[134:135], a[4:7]
    v_rcp_f32 v21, v21
    v_mul_f32 v44, v44, v20
    v_mul_f32 v45, v45, v21
    v_cvt_pk_bf16_f32 v42, v44, v45
    v_mfma_f32_32x32x16_bf16 v[208:223], v[244:247], a[160:163], v[208:223]
    ds_read_b64_tr_b16 v[238:239], v29 offset:53760
    v_mul_f32 v22, v24, v46
    v_mul_f32 v23, v24, v47
    v_exp_f32 v22, v22
    v_exp_f32 v23, v23
    v_mfma_f32_32x32x16_bf16 v[160:175], v[224:227], a[36:39], v[160:175]
    ds_read_b64_tr_b16 v[240:241], v28 offset:55296
    ds_read_b64_tr_b16 a[132:133], v30 offset:61440
    s_waitcnt lgkmcnt(6)
    v_mfma_f32_4x4x4_16b_bf16 a[4:7], a[0:1], a[128:129], a[4:7]
    v_fma_f32 v22, v22, v26, v26
    v_fma_f32 v23, v23, v26, v26
    v_rcp_f32 v22, v22
    v_mfma_f32_32x32x16_bf16 v[176:191], v[224:227], a[164:167], v[176:191]
    ds_read_b64_tr_b16 v[242:243], v28 offset:55808
    v_rcp_f32 v23, v23
    v_mul_f32 v46, v46, v22
    v_mul_f32 v47, v47, v23
    v_cvt_pk_bf16_f32 v43, v46, v47
    s_mov_b32 s41, 0
    buffer_store_dwordx4 v[40:43], v19, s[28:31], s41 offen offset:1024 sc1
    v_mfma_f32_32x32x16_bf16 v[192:207], v[228:231], a[36:39], v[192:207]
    ds_read_b64_tr_b16 v[244:245], v29 offset:55296
    ds_read_b64_tr_b16 a[134:135], v30 offset:61952
    s_waitcnt lgkmcnt(6)
    v_mfma_f32_4x4x4_16b_bf16 a[4:7], a[0:1], a[130:131], a[4:7]
    v_mul_f32 v20, v25, v48
    v_mul_f32 v21, v25, v49
    v_exp_f32 v20, v20
    v_mfma_f32_32x32x16_bf16 v[208:223], v[228:231], a[164:167], v[208:223]
    ds_read_b64_tr_b16 v[246:247], v29 offset:55808
    v_exp_f32 v21, v21
    v_fma_f32 v20, v20, v27, v27
    v_fma_f32 v21, v21, v27, v27
    v_rcp_f32 v20, v20
    v_mfma_f32_32x32x16_bf16 v[160:175], v[232:235], a[40:43], v[160:175]
    ds_read_b64_tr_b16 v[224:225], v28 offset:57344
    s_waitcnt lgkmcnt(5)
    v_mfma_f32_4x4x4_16b_bf16 a[4:7], a[0:1], a[132:133], a[4:7]
    v_rcp_f32 v21, v21
    v_mul_f32 v48, v48, v20
    v_mul_f32 v49, v49, v21
    v_cvt_pk_bf16_f32 v48, v48, v49
    v_mfma_f32_32x32x16_bf16 v[176:191], v[232:235], a[168:171], v[176:191]
    ds_read_b64_tr_b16 v[226:227], v28 offset:57856
    v_mul_f32 v22, v25, v50
    v_mul_f32 v23, v25, v51
    v_exp_f32 v22, v22
    v_exp_f32 v23, v23
    v_mfma_f32_32x32x16_bf16 v[192:207], v[236:239], a[40:43], v[192:207]
    ds_read_b64_tr_b16 v[228:229], v29 offset:57344
    s_waitcnt lgkmcnt(4)
    v_mfma_f32_4x4x4_16b_bf16 a[4:7], a[0:1], a[134:135], a[4:7]
    v_fma_f32 v22, v22, v27, v27
    v_fma_f32 v23, v23, v27, v27
    v_rcp_f32 v22, v22
    v_mfma_f32_32x32x16_bf16 v[208:223], v[236:239], a[168:171], v[208:223]
    ds_read_b64_tr_b16 v[230:231], v29 offset:57856
    v_rcp_f32 v23, v23
    v_mul_f32 v50, v50, v22
    v_mul_f32 v51, v51, v23
    v_cvt_pk_bf16_f32 v49, v50, v51
    v_mul_f32 v20, v25, v52
    v_mfma_f32_32x32x16_bf16 v[160:175], v[240:243], a[44:47], v[160:175]
    ds_read_b64_tr_b16 v[232:233], v28 offset:59392
    v_mul_f32 v21, v25, v53
    v_exp_f32 v20, v20
    v_exp_f32 v21, v21
    v_fma_f32 v20, v20, v27, v27
    v_mfma_f32_32x32x16_bf16 v[176:191], v[240:243], a[172:175], v[176:191]
    ds_read_b64_tr_b16 v[234:235], v28 offset:59904
    v_fma_f32 v21, v21, v27, v27
    v_rcp_f32 v20, v20
    v_rcp_f32 v21, v21
    v_mul_f32 v52, v52, v20
    s_waitcnt lgkmcnt(6)
    v_mfma_f32_32x32x16_bf16 v[192:207], v[244:247], a[44:47], v[192:207]
    ds_read_b64_tr_b16 v[236:237], v29 offset:59392
    v_mul_f32 v53, v53, v21
    v_cvt_pk_bf16_f32 v50, v52, v53
    v_mul_f32 v22, v25, v54
    v_mul_f32 v23, v25, v55
    v_exp_f32 v22, v22
    v_mfma_f32_32x32x16_bf16 v[208:223], v[244:247], a[172:175], v[208:223]
    ds_read_b64_tr_b16 v[238:239], v29 offset:59904
    v_exp_f32 v23, v23
    v_fma_f32 v22, v22, v27, v27
    v_fma_f32 v23, v23, v27, v27
    v_rcp_f32 v22, v22
    s_waitcnt lgkmcnt(6)
    v_mfma_f32_32x32x16_bf16 v[160:175], v[224:227], a[48:51], v[160:175]
    ds_read_b64_tr_b16 v[240:241], v28 offset:61440
    v_rcp_f32 v23, v23
    v_mul_f32 v54, v54, v22
    v_mul_f32 v55, v55, v23
    v_cvt_pk_bf16_f32 v51, v54, v55
    s_mov_b32 s41, 114688
    buffer_store_dwordx4 v[48:51], v19, s[28:31], s41 offen offset:0 sc1
    v_mfma_f32_32x32x16_bf16 v[176:191], v[224:227], a[176:179], v[176:191]
    ds_read_b64_tr_b16 v[242:243], v28 offset:61952
    v_mul_f32 v20, v25, v56
    v_mul_f32 v21, v25, v57
    v_exp_f32 v20, v20
    v_exp_f32 v21, v21
    s_waitcnt lgkmcnt(6)
    v_mfma_f32_32x32x16_bf16 v[192:207], v[228:231], a[48:51], v[192:207]
    ds_read_b64_tr_b16 v[244:245], v29 offset:61440
    v_fma_f32 v20, v20, v27, v27
    v_fma_f32 v21, v21, v27, v27
    v_rcp_f32 v20, v20
    v_rcp_f32 v21, v21
    v_mfma_f32_32x32x16_bf16 v[208:223], v[228:231], a[176:179], v[208:223]
    ds_read_b64_tr_b16 v[246:247], v29 offset:61952
    v_mul_f32 v56, v56, v20
    v_mul_f32 v57, v57, v21
    v_cvt_pk_bf16_f32 v56, v56, v57
    v_mul_f32 v22, v25, v58
    v_mul_f32 v23, v25, v59
    s_waitcnt lgkmcnt(6)
    v_mfma_f32_32x32x16_bf16 v[160:175], v[232:235], a[52:55], v[160:175]
    ds_read_b64_tr_b16 v[224:225], v28 offset:63488
    v_exp_f32 v22, v22
    v_exp_f32 v23, v23
    v_fma_f32 v22, v22, v27, v27
    v_fma_f32 v23, v23, v27, v27
    v_mfma_f32_32x32x16_bf16 v[176:191], v[232:235], a[180:183], v[176:191]
    ds_read_b64_tr_b16 v[226:227], v28 offset:64000
    v_rcp_f32 v22, v22
    v_rcp_f32 v23, v23
    v_mul_f32 v58, v58, v22
    v_mul_f32 v59, v59, v23
    s_waitcnt lgkmcnt(6)
    v_mfma_f32_32x32x16_bf16 v[192:207], v[236:239], a[52:55], v[192:207]
    ds_read_b64_tr_b16 v[228:229], v29 offset:63488
    v_cvt_pk_bf16_f32 v57, v58, v59
    v_mul_f32 v20, v25, v60
    v_mul_f32 v21, v25, v61
    v_exp_f32 v20, v20
    v_mfma_f32_32x32x16_bf16 v[208:223], v[236:239], a[180:183], v[208:223]
    ds_read_b64_tr_b16 v[230:231], v29 offset:64000
    v_exp_f32 v21, v21
    v_fma_f32 v20, v20, v27, v27
    v_fma_f32 v21, v21, v27, v27
    v_rcp_f32 v20, v20
    s_waitcnt vmcnt(15)
    s_barrier
    s_waitcnt lgkmcnt(6)
    v_mfma_f32_32x32x16_bf16 v[160:175], v[240:243], a[56:59], v[160:175]
    ds_read_b64_tr_b16 v[232:233], v28 offset:0
    ds_read_b64_tr_b16 a[128:129], v30 offset:0
    v_rcp_f32 v21, v21
    v_mul_f32 v60, v60, v20
    v_mul_f32 v61, v61, v21
    v_cvt_pk_bf16_f32 v58, v60, v61
    v_mul_f32 v22, v25, v62
    v_mfma_f32_32x32x16_bf16 v[176:191], v[240:243], a[184:187], v[176:191]
    ds_read_b64_tr_b16 v[234:235], v28 offset:512
    v_mul_f32 v23, v25, v63
    v_exp_f32 v22, v22
    v_exp_f32 v23, v23
    v_fma_f32 v22, v22, v27, v27
    s_waitcnt lgkmcnt(7)
    v_mfma_f32_32x32x16_bf16 v[192:207], v[244:247], a[56:59], v[192:207]
    ds_read_b64_tr_b16 v[236:237], v29 offset:0
    ds_read_b64_tr_b16 a[130:131], v30 offset:512
    v_fma_f32 v23, v23, v27, v27
    v_rcp_f32 v22, v22
    v_rcp_f32 v23, v23
    v_mul_f32 v62, v62, v22
    v_mfma_f32_32x32x16_bf16 v[208:223], v[244:247], a[184:187], v[208:223]
    ds_read_b64_tr_b16 v[238:239], v29 offset:512
    v_mul_f32 v63, v63, v23
    v_cvt_pk_bf16_f32 v59, v62, v63
    s_mov_b32 s41, 114688
    buffer_store_dwordx4 v[56:59], v19, s[28:31], s41 offen offset:1024 sc1
    v_mul_f32 v20, v24, v64
    s_waitcnt lgkmcnt(8)
    v_mfma_f32_32x32x16_bf16 v[160:175], v[224:227], a[60:63], v[160:175]
    ds_read_b64_tr_b16 v[240:241], v28 offset:2048
    ds_read_b64_tr_b16 a[132:133], v30 offset:4096
    s_waitcnt lgkmcnt(6)
    v_mfma_f32_4x4x4_16b_bf16 a[4:7], a[0:1], a[128:129], a[4:7]
    v_mul_f32 v21, v24, v65
    v_exp_f32 v20, v20
    v_exp_f32 v21, v21
    v_mfma_f32_32x32x16_bf16 v[176:191], v[224:227], a[188:191], v[176:191]
    ds_read_b64_tr_b16 v[242:243], v28 offset:2560
    v_fma_f32 v20, v20, v26, v26
    v_fma_f32 v21, v21, v26, v26
    v_rcp_f32 v20, v20
    v_rcp_f32 v21, v21
    v_mfma_f32_32x32x16_bf16 v[192:207], v[228:231], a[60:63], v[192:207]
    ds_read_b64_tr_b16 v[244:245], v29 offset:2048
    ds_read_b64_tr_b16 a[134:135], v30 offset:4608
    s_waitcnt lgkmcnt(6)
    v_mfma_f32_4x4x4_16b_bf16 a[4:7], a[0:1], a[130:131], a[4:7]
    v_mul_f32 v64, v64, v20
    v_mul_f32 v65, v65, v21
    v_cvt_pk_bf16_f32 v64, v64, v65
    v_mul_f32 v22, v24, v66
    v_mul_f32 v23, v24, v67
    v_mfma_f32_32x32x16_bf16 v[208:223], v[228:231], a[188:191], v[208:223]
    ds_read_b64_tr_b16 v[246:247], v29 offset:2560
    v_exp_f32 v22, v22
    v_exp_f32 v23, v23
    v_fma_f32 v22, v22, v26, v26
    v_fma_f32 v23, v23, v26, v26
    v_mfma_f32_32x32x16_bf16 v[160:175], v[232:235], a[64:67], v[160:175]
    ds_read_b64_tr_b16 v[224:225], v28 offset:4096
    ds_read_b64_tr_b16 a[128:129], v30 offset:8192
    s_waitcnt lgkmcnt(6)
    v_mfma_f32_4x4x4_16b_bf16 a[4:7], a[0:1], a[132:133], a[4:7]
    v_rcp_f32 v22, v22
    v_rcp_f32 v23, v23
    v_mul_f32 v66, v66, v22
    v_mfma_f32_32x32x16_bf16 v[176:191], v[232:235], a[192:195], v[176:191]
    ds_read_b64_tr_b16 v[226:227], v28 offset:4608
    v_mul_f32 v67, v67, v23
    v_cvt_pk_bf16_f32 v65, v66, v67
    v_mul_f32 v20, v24, v68
    v_mul_f32 v21, v24, v69
    v_exp_f32 v20, v20
    v_mfma_f32_32x32x16_bf16 v[192:207], v[236:239], a[64:67], v[192:207]
    ds_read_b64_tr_b16 v[228:229], v29 offset:4096
    ds_read_b64_tr_b16 a[130:131], v30 offset:8704
    s_waitcnt lgkmcnt(6)
    v_mfma_f32_4x4x4_16b_bf16 a[4:7], a[0:1], a[134:135], a[4:7]
wpad3:
    s_cmp_eq_u32 s98, 1
    s_cbranch_scc1 WARMA_done
    v_exp_f32 v21, v21
    v_fma_f32 v20, v20, v26, v26
    v_fma_f32 v21, v21, v26, v26
    v_mfma_f32_32x32x16_bf16 v[208:223], v[236:239], a[192:195], v[208:223]
    ds_read_b64_tr_b16 v[230:231], v29 offset:4608
    v_rcp_f32 v20, v20
    v_rcp_f32 v21, v21
    v_mul_f32 v68, v68, v20
    v_mul_f32 v69, v69, v21
    v_mfma_f32_32x32x16_bf16 v[160:175], v[240:243], a[68:71], v[160:175]
    ds_read_b64_tr_b16 v[232:233], v28 offset:6144
    ds_read_b64_tr_b16 a[132:133], v30 offset:12288
    s_waitcnt lgkmcnt(6)
    v_mfma_f32_4x4x4_16b_bf16 a[4:7], a[0:1], a[128:129], a[4:7]
    v_cvt_pk_bf16_f32 v66, v68, v69
    v_mul_f32 v22, v24, v70
    v_mul_f32 v23, v24, v71
    v_exp_f32 v22, v22
    v_mfma_f32_32x32x16_bf16 v[176:191], v[240:243], a[196:199], v[176:191]
    ds_read_b64_tr_b16 v[234:235], v28 offset:6656
    v_exp_f32 v23, v23
    v_fma_f32 v22, v22, v26, v26
    v_fma_f32 v23, v23, v26, v26
    v_rcp_f32 v22, v22
    v_mfma_f32_32x32x16_bf16 v[192:207], v[244:247], a[68:71], v[192:207]
    ds_read_b64_tr_b16 v[236:237], v29 offset:6144
    ds_read_b64_tr_b16 a[134:135], v30 offset:12800
    s_waitcnt lgkmcnt(6)
    v_mfma_f32_4x4x4_16b_bf16 a[4:7], a[0:1], a[130:131], a[4:7]
    v_rcp_f32 v23, v23
    v_mul_f32 v70, v70, v22
    v_mul_f32 v71, v71, v23
    v_cvt_pk_bf16_f32 v67, v70, v71
    v_mfma_f32_32x32x16_bf16 v[208:223], v[244:247], a[196:199], v[208:223]
    ds_read_b64_tr_b16 v[238:239], v29 offset:6656
    s_mov_b32 s41, 0
    buffer_store_dwordx4 v[64:67], v19, s[28:31], s41 offen offset:2048 sc1
    v_mul_f32 v20, v24, v72
    v_mul_f32 v21, v24, v73
    v_mfma_f32_32x32x16_bf16 v[160:175], v[224:227], a[72:75], v[160:175]
    ds_read_b64_tr_b16 v[240:241], v28 offset:8192
    ds_read_b64_tr_b16 a[128:129], v30 offset:16384
    s_waitcnt lgkmcnt(6)
    v_mfma_f32_4x4x4_16b_bf16 a[4:7], a[0:1], a[132:133], a[4:7]
    v_exp_f32 v20, v20
    v_exp_f32 v21, v21
    v_fma_f32 v20, v20, v26, v26
    v_mfma_f32_32x32x16_bf16 v[176:191], v[224:227], a[200:203], v[176:191]
    ds_read_b64_tr_b16 v[242:243], v28 offset:8704
    v_fma_f32 v21, v21, v26, v26
    v_rcp_f32 v20, v20
    v_rcp_f32 v21, v21
    v_mul_f32 v72, v72, v20
    v_mfma_f32_32x32x16_bf16 v[192:207], v[228:231], a[72:75], v[192:207]
    ds_read_b64_tr_b16 v[244:245], v29 offset:8192
    ds_read_b64_tr_b16 a[130:131], v30 offset:16896
    s_waitcnt lgkmcnt(6)
    v_mfma_f32_4x4x4_16b_bf16 a[4:7], a[0:1], a[134:135], a[4:7]
    v_mul_f32 v73, v73, v21
    v_cvt_pk_bf16_f32 v72, v72, v73
    v_mul_f32 v22, v24, v74
    v_mul_f32 v23, v24, v75
    v_mfma_f32_32x32x16_bf16 v[208:223], v[228:231], a[200:203], v[208:223]
    ds_read_b64_tr_b16 v[246:247], v29 offset:8704
    v_exp_f32 v22, v22
    v_exp_f32 v23, v23
    v_fma_f32 v22, v22, v26, v26
    v_fma_f32 v23, v23, v26, v26
    v_mfma_f32_32x32x16_bf16 v[160:175], v[232:235], a[76:79], v[160:175]
    ds_read_b64_tr_b16 v[224:225], v28 offset:10240
    ds_read_b64_tr_b16 a[132:133], v30 offset:20480
    s_waitcnt lgkmcnt(6)
    v_mfma_f32_4x4x4_16b_bf16 a[4:7], a[0:1], a[128:129], a[4:7]
    v_rcp_f32 v22, v22
    v_rcp_f32 v23, v23
    v_mul_f32 v74, v74, v22
    v_mfma_f32_32x32x16_bf16 v[176:191], v[232:235], a[204:207], v[176:191]
    ds_read_b64_tr_b16 v[226:227], v28 offset:10752
    v_mul_f32 v75, v75, v23
    v_cvt_pk_bf16_f32 v73, v74, v75
    v_mul_f32 v20, v24, v76
    v_mul_f32 v21, v24, v77
    v_exp_f32 v20, v20
    v_mfma_f32_32x32x16_bf16 v[192:207], v[236:239], a[76:79], v[192:207]
    ds_read_b64_tr_b16 v[228:229], v29 offset:10240
    ds_read_b64_tr_b16 a[134:135], v30 offset:20992
    s_waitcnt lgkmcnt(6)
    v_mfma_f32_4x4x4_16b_bf16 a[4:7], a[0:1], a[130:131], a[4:7]
    v_exp_f32 v21, v21
    v_fma_f32 v20, v20, v26, v26
    v_fma_f32 v21, v21, v26, v26
    v_mfma_f32_32x32x16_bf16 v[208:223], v[236:239], a[204:207], v[208:223]
    ds_read_b64_tr_b16 v[230:231], v29 offset:10752
    v_rcp_f32 v20, v20
    v_rcp_f32 v21, v21
    v_mul_f32 v76, v76, v20
    v_mul_f32 v77, v77, v21
    v_mfma_f32_32x32x16_bf16 v[160:175], v[240:243], a[80:83], v[160:175]
    ds_read_b64_tr_b16 v[232:233], v28 offset:12288
    ds_read_b64_tr_b16 a[128:129], v30 offset:24576
    s_waitcnt lgkmcnt(6)
    v_mfma_f32_4x4x4_16b_bf16 a[4:7], a[0:1], a[132:133], a[4:7]
    v_cvt_pk_bf16_f32 v74, v76, v77
    v_mul_f32 v22, v24, v78
    v_mul_f32 v23, v24, v79
    v_exp_f32 v22, v22
    v_mfma_f32_32x32x16_bf16 v[176:191], v[240:243], a[208:211], v[176:191]
    ds_read_b64_tr_b16 v[234:235], v28 offset:12800
    v_exp_f32 v23, v23
    v_fma_f32 v22, v22, v26, v26
    v_fma_f32 v23, v23, v26, v26
    v_rcp_f32 v22, v22
    v_mfma_f32_32x32x16_bf16 v[192:207], v[244:247], a[80:83], v[192:207]
    ds_read_b64_tr_b16 v[236:237], v29 offset:12288
    ds_read_b64_tr_b16 a[130:131], v30 offset:25088
    s_waitcnt lgkmcnt(6)
    v_mfma_f32_4x4x4_16b_bf16 a[4:7], a[0:1], a[134:135], a[4:7]
    v_rcp_f32 v23, v23
    v_mul_f32 v78, v78, v22
    v_mul_f32 v79, v79, v23
    v_cvt_pk_bf16_f32 v75, v78, v79
    v_mfma_f32_32x32x16_bf16 v[208:223], v[244:247], a[208:211], v[208:223]
    ds_read_b64_tr_b16 v[238:239], v29 offset:12800
    s_mov_b32 s41, 0
    buffer_store_dwordx4 v[72:75], v19, s[28:31], s41 offen offset:3072 sc1
    v_mul_f32 v20, v25, v80
    v_mul_f32 v21, v25, v81
    v_mfma_f32_32x32x16_bf16 v[160:175], v[224:227], a[84:87], v[160:175]
    ds_read_b64_tr_b16 v[240:241], v28 offset:14336
    ds_read_b64_tr_b16 a[132:133], v30 offset:28672
    s_waitcnt lgkmcnt(6)
    v_mfma_f32_4x4x4_16b_bf16 a[4:7], a[0:1], a[128:129], a[4:7]
    v_exp_f32 v20, v20
    v_exp_f32 v21, v21
    v_fma_f32 v20, v20, v27, v27
    v_mfma_f32_32x32x16_bf16 v[176:191], v[224:227], a[212:215], v[176:191]
    ds_read_b64_tr_b16 v[242:243], v28 offset:14848
    v_fma_f32 v21, v21, v27, v27
    v_rcp_f32 v20, v20
    v_rcp_f32 v21, v21
    v_mul_f32 v80, v80, v20
    v_mfma_f32_32x32x16_bf16 v[192:207], v[228:231], a[84:87], v[192:207]
    ds_read_b64_tr_b16 v[244:245], v29 offset:14336
    ds_read_b64_tr_b16 a[134:135], v30 offset:29184
    s_waitcnt lgkmcnt(6)
    v_mfma_f32_4x4x4_16b_bf16 a[4:7], a[0:1], a[130:131], a[4:7]
    v_mul_f32 v81, v81, v21
    v_cvt_pk_bf16_f32 v80, v80, v81
    v_mul_f32 v22, v25, v82
    v_mul_f32 v23, v25, v83
    v_mfma_f32_32x32x16_bf16 v[208:223], v[228:231], a[212:215], v[208:223]
    ds_read_b64_tr_b16 v[246:247], v29 offset:14848
    v_exp_f32 v22, v22
    v_exp_f32 v23, v23
    v_fma_f32 v22, v22, v27, v27
    v_fma_f32 v23, v23, v27, v27
    v_mfma_f32_32x32x16_bf16 v[160:175], v[232:235], a[88:91], v[160:175]
    ds_read_b64_tr_b16 v[224:225], v28 offset:16384
    s_waitcnt lgkmcnt(5)
    v_mfma_f32_4x4x4_16b_bf16 a[4:7], a[0:1], a[132:133], a[4:7]
    v_rcp_f32 v22, v22
    v_rcp_f32 v23, v23
    v_mul_f32 v82, v82, v22
    v_mfma_f32_32x32x16_bf16 v[176:191], v[232:235], a[216:219], v[176:191]
    ds_read_b64_tr_b16 v[226:227], v28 offset:16896
    v_mul_f32 v83, v83, v23
    v_cvt_pk_bf16_f32 v81, v82, v83
    v_mul_f32 v20, v25, v84
    v_mul_f32 v21, v25, v85
    v_exp_f32 v20, v20
    v_mfma_f32_32x32x16_bf16 v[192:207], v[236:239], a[88:91], v[192:207]
    ds_read_b64_tr_b16 v[228:229], v29 offset:16384
    s_waitcnt lgkmcnt(4)
    v_mfma_f32_4x4x4_16b_bf16 a[4:7], a[0:1], a[134:135], a[4:7]
    v_exp_f32 v21, v21
    v_fma_f32 v20, v20, v27, v27
    v_fma_f32 v21, v21, v27, v27
    v_mfma_f32_32x32x16_bf16 v[208:223], v[236:239], a[216:219], v[208:223]
    ds_read_b64_tr_b16 v[230:231], v29 offset:16896
    v_rcp_f32 v20, v20
    v_rcp_f32 v21, v21
    v_mul_f32 v84, v84, v20
    v_mul_f32 v85, v85, v21
    v_mfma_f32_32x32x16_bf16 v[160:175], v[240:243], a[92:95], v[160:175]
    ds_read_b64_tr_b16 v[232:233], v28 offset:18432
    v_cvt_pk_bf16_f32 v82, v84, v85
    v_mul_f32 v22, v25, v86
    v_mul_f32 v23, v25, v87
    v_exp_f32 v22, v22
    v_mfma_f32_32x32x16_bf16 v[176:191], v[240:243], a[220:223], v[176:191]
    ds_read_b64_tr_b16 v[234:235], v28 offset:18944
    v_accvgpr_read_b32 v248, a4
    v_exp_f32 v23, v23
    v_fma_f32 v22, v22, v27, v27
    v_fma_f32 v23, v23, v27, v27
    s_waitcnt lgkmcnt(6)
    v_mfma_f32_32x32x16_bf16 v[192:207], v[244:247], a[92:95], v[192:207]
    ds_read_b64_tr_b16 v[236:237], v29 offset:18432
    v_mov_b32 v249, v248
    s_mov_b32 vcc_lo, 0
    s_mov_b32 vcc_hi, -1
    v_permlane32_swap_b32 v248, v249
    s_nop 1
    v_add_f32 v248, v248, v249
    v_cvt_pk_bf16_f32 v250, v248, v248
    v_lshlrev_b32 v249, 16, v250
    v_sub_f32 v254, v248, v249
    v_cvt_pk_bf16_f32 v251, v254, v254
    v_lshlrev_b32 v249, 16, v251
    v_sub_f32 v255, v254, v249
    v_cvt_pk_bf16_f32 v249, v248, v255
    v_cvt_pk_bf16_f32 v255, v254, v255
    v_cndmask_b32 v250, v250, v249, vcc
    v_cndmask_b32 v251, v251, v255, vcc
    v_mfma_f32_32x32x16_bf16 v[208:223], v[244:247], a[220:223], v[208:223]
    ds_read_b64_tr_b16 v[238:239], v29 offset:18944
    ds_write_b64 v252, v[250:251]
    v_rcp_f32 v22, v22
    v_rcp_f32 v23, v23
    v_mul_f32 v86, v86, v22
    s_waitcnt lgkmcnt(7)
    v_mfma_f32_32x32x16_bf16 v[160:175], v[224:227], a[96:99], v[160:175]
    ds_read_b64_tr_b16 v[240:241], v28 offset:20480
    v_mul_f32 v87, v87, v23
    v_cvt_pk_bf16_f32 v83, v86, v87
    s_mov_b32 s41, 114688
    buffer_store_dwordx4 v[80:83], v19, s[28:31], s41 offen offset:2048 sc1
    v_mul_f32 v20, v25, v88
    v_mfma_f32_32x32x16_bf16 v[176:191], v[224:227], a[224:227], v[176:191]
    ds_read_b64_tr_b16 v[242:243], v28 offset:20992
    v_mul_f32 v21, v25, v89
    v_exp_f32 v20, v20
    v_exp_f32 v21, v21
    v_fma_f32 v20, v20, v27, v27
    s_waitcnt lgkmcnt(7)
    v_mfma_f32_32x32x16_bf16 v[192:207], v[228:231], a[96:99], v[192:207]
    ds_read_b64_tr_b16 v[244:245], v29 offset:20480
    v_fma_f32 v21, v21, v27, v27
    v_rcp_f32 v20, v20
    v_rcp_f32 v21, v21
    v_mul_f32 v88, v88, v20
    v_mfma_f32_32x32x16_bf16 v[208:223], v[228:231], a[224:227], v[208:223]
    ds_read_b64_tr_b16 v[246:247], v29 offset:20992
    v_mul_f32 v89, v89, v21
    v_cvt_pk_bf16_f32 v88, v88, v89
    v_mul_f32 v22, v25, v90
    v_mul_f32 v23, v25, v91
    v_exp_f32 v22, v22
    s_waitcnt lgkmcnt(7)
    v_mfma_f32_32x32x16_bf16 v[160:175], v[232:235], a[100:103], v[160:175]
    ds_read_b64_tr_b16 v[224:225], v28 offset:22528
    v_exp_f32 v23, v23
    v_fma_f32 v22, v22, v27, v27
    v_fma_f32 v23, v23, v27, v27
    v_rcp_f32 v22, v22
    v_mfma_f32_32x32x16_bf16 v[176:191], v[232:235], a[228:231], v[176:191]
    ds_read_b64_tr_b16 v[226:227], v28 offset:23040
    v_rcp_f32 v23, v23
    v_mul_f32 v90, v90, v22
    v_mul_f32 v91, v91, v23
    v_cvt_pk_bf16_f32 v89, v90, v91
    v_mul_f32 v20, v25, v92
    s_waitcnt lgkmcnt(7)
    v_mfma_f32_32x32x16_bf16 v[192:207], v[236:239], a[100:103], v[192:207]
    ds_read_b64_tr_b16 v[228:229], v29 offset:22528
    v_mul_f32 v21, v25, v93
    v_exp_f32 v20, v20
    v_exp_f32 v21, v21
    v_fma_f32 v20, v20, v27, v27
    v_mfma_f32_32x32x16_bf16 v[208:223], v[236:239], a[228:231], v[208:223]
    ds_read_b64_tr_b16 v[230:231], v29 offset:23040
    v_fma_f32 v21, v21, v27, v27
    v_rcp_f32 v20, v20
    v_rcp_f32 v21, v21
    v_mul_f32 v92, v92, v20
    s_waitcnt lgkmcnt(8)
    s_barrier
    s_waitcnt lgkmcnt(6)
    v_mfma_f32_32x32x16_bf16 v[160:175], v[240:243], a[104:107], v[160:175]
    ds_read_b64_tr_b16 v[232:233], v28 offset:24576
    ds_read_b64 a[16:17], v253 offset:0
    v_mul_f32 v93, v93, v21
    v_cvt_pk_bf16_f32 v90, v92, v93
    v_mul_f32 v22, v25, v94
    v_mul_f32 v23, v25, v95
    v_exp_f32 v22, v22
    v_mfma_f32_32x32x16_bf16 v[176:191], v[240:243], a[232:235], v[176:191]
    ds_read_b64_tr_b16 v[234:235], v28 offset:25088
    ds_read_b64 a[18:19], v253 offset:1024
    v_exp_f32 v23, v23
    v_fma_f32 v22, v22, v27, v27
    v_fma_f32 v23, v23, v27, v27
    v_rcp_f32 v22, v22
    s_waitcnt lgkmcnt(8)
    v_mfma_f32_32x32x16_bf16 v[192:207], v[244:247], a[104:107], v[192:207]
    ds_read_b64_tr_b16 v[236:237], v29 offset:24576
    ds_read_b64 a[20:21], v253 offset:512
    v_rcp_f32 v23, v23
    v_mul_f32 v94, v94, v22
    v_mul_f32 v95, v95, v23
    v_cvt_pk_bf16_f32 v91, v94, v95
    s_mov_b32 s41, 114688
    buffer_store_dwordx4 v[88:91], v19, s[28:31], s41 offen offset:3072 sc1
    v_mfma_f32_32x32x16_bf16 v[208:223], v[244:247], a[232:235], v[208:223]
    ds_read_b64_tr_b16 v[238:239], v29 offset:25088
    ds_read_b64 a[22:23], v253 offset:1536
    v_mul_f32 v26, 0xbdb504f3, v24
    v_mul_f32 v27, 0xbdb504f3, v25
    v_mul_f32 v96, v26, v96
    v_mul_f32 v97, v26, v97
    v_cvt_pk_bf16_f32 v32, v96, v97
    v_mul_f32 v98, v26, v98
    s_waitcnt lgkmcnt(10)
    v_mfma_f32_32x32x16_bf16 v[160:175], v[224:227], a[108:111], v[160:175]
    ds_read_b64_tr_b16 v[240:241], v28 offset:26624
    v_mul_f32 v99, v26, v99
    v_cvt_pk_bf16_f32 v33, v98, v99
    v_mul_f32 v100, v26, v100
    v_mul_f32 v101, v26, v101
    v_cvt_pk_bf16_f32 v34, v100, v101
    v_mul_f32 v102, v26, v102
    v_mfma_f32_32x32x16_bf16 v[176:191], v[224:227], a[236:239], v[176:191]
    ds_read_b64_tr_b16 v[242:243], v28 offset:27136
    s_add_u32 m0, s35, 16384
    s_mov_b32 s43, 16384
    buffer_load_dwordx4 v14, s[4:7], s43 offen offset:0 lds
    v_mul_f32 v103, v26, v103
    v_cvt_pk_bf16_f32 v35, v102, v103
    v_mul_f32 v104, v26, v104
    s_waitcnt lgkmcnt(10)
    v_mfma_f32_32x32x16_bf16 v[192:207], v[228:231], a[108:111], v[192:207]
    ds_read_b64_tr_b16 v[244:245], v29 offset:26624
    v_mul_f32 v105, v26, v105
    v_cvt_pk_bf16_f32 v36, v104, v105
    v_mul_f32 v106, v26, v106
    v_mul_f32 v107, v26, v107
    v_cvt_pk_bf16_f32 v37, v106, v107
    v_mul_f32 v108, v26, v108
    v_mfma_f32_32x32x16_bf16 v[208:223], v[228:231], a[236:239], v[208:223]
    ds_read_b64_tr_b16 v[246:247], v29 offset:27136
    buffer_load_dwordx4 v15, s[4:7], s43 offen offset:1024 lds
    v_mul_f32 v109, v26, v109
    v_cvt_pk_bf16_f32 v38, v108, v109
    v_mul_f32 v110, v26, v110
    s_waitcnt lgkmcnt(9)
    v_mfma_f32_32x32x16_bf16 v[160:175], v[232:235], a[112:115], v[160:175]
    ds_read_b64_tr_b16 v[224:225], v28 offset:28672
    v_mul_f32 v111, v26, v111
    v_cvt_pk_bf16_f32 v39, v110, v111
    v_permlane16_swap_b32 v32, v36
    v_permlane16_swap_b32 v33, v37
    v_permlane16_swap_b32 v34, v38
    v_permlane16_swap_b32 v35, v39
    v_mfma_f32_32x32x16_bf16 v[176:191], v[232:235], a[240:243], v[176:191]
    ds_read_b64_tr_b16 v[226:227], v28 offset:29184
    buffer_load_dwordx4 v16, s[4:7], s43 offen offset:2048 lds
    v_mul_f32 v112, v27, v112
    v_mul_f32 v113, v27, v113
    v_cvt_pk_bf16_f32 v64, v112, v113
    s_waitcnt lgkmcnt(7)
    v_mfma_f32_32x32x16_bf16 v[192:207], v[236:239], a[112:115], v[192:207]
    ds_read_b64_tr_b16 v[228:229], v29 offset:28672
    v_mul_f32 v114, v27, v114
    v_mul_f32 v115, v27, v115
    v_cvt_pk_bf16_f32 v65, v114, v115
    v_mul_f32 v116, v27, v116
    v_mul_f32 v117, v27, v117
    v_cvt_pk_bf16_f32 v66, v116, v117
    v_mfma_f32_32x32x16_bf16 v[208:223], v[236:239], a[240:243], v[208:223]
    ds_read_b64_tr_b16 v[230:231], v29 offset:29184
    buffer_load_dwordx4 v17, s[4:7], s43 offen offset:3072 lds
    v_mul_f32 v118, v27, v118
    v_mul_f32 v119, v27, v119
    v_cvt_pk_bf16_f32 v67, v118, v119
    s_waitcnt lgkmcnt(6)
    v_mfma_f32_32x32x16_bf16 v[160:175], v[240:243], a[116:119], v[160:175]
    ds_read_b64_tr_b16 v[232:233], v28 offset:30720
    v_mul_f32 v120, v27, v120
    v_mul_f32 v121, v27, v121
    v_cvt_pk_bf16_f32 v68, v120, v121
    v_mul_f32 v122, v27, v122
    v_mul_f32 v123, v27, v123
    v_cvt_pk_bf16_f32 v69, v122, v123
    v_mfma_f32_32x32x16_bf16 v[176:191], v[240:243], a[244:247], v[176:191]
    ds_read_b64_tr_b16 v[234:235], v28 offset:31232
    s_add_u32 m0, s35, 32768
    s_mov_b32 s43, 32768
    buffer_load_dwordx4 v14, s[4:7], s43 offen offset:0 lds
    v_mul_f32 v124, v27, v124
    v_mul_f32 v125, v27, v125
    v_cvt_pk_bf16_f32 v70, v124, v125
    s_waitcnt lgkmcnt(6)
    v_mfma_f32_32x32x16_bf16 v[192:207], v[244:247], a[116:119], v[192:207]
    ds_read_b64_tr_b16 v[236:237], v29 offset:30720
    v_mul_f32 v126, v27, v126
    v_mul_f32 v127, v27, v127
    v_cvt_pk_bf16_f32 v71, v126, v127
    v_permlane16_swap_b32 v64, v68
    v_permlane16_swap_b32 v65, v69
    v_permlane16_swap_b32 v66, v70
    v_mfma_f32_32x32x16_bf16 v[208:223], v[244:247], a[244:247], v[208:223]
    ds_read_b64_tr_b16 v[238:239], v29 offset:31232
    buffer_load_dwordx4 v15, s[4:7], s43 offen offset:1024 lds
    v_permlane16_swap_b32 v67, v71
    v_mul_f32 v128, v26, v128
    v_mul_f32 v129, v26, v129
    s_waitcnt lgkmcnt(6)
    v_mfma_f32_32x32x16_bf16 v[160:175], v[224:227], a[120:123], v[160:175]
    v_cvt_pk_bf16_f32 v40, v128, v129
    v_mul_f32 v130, v26, v130
    v_mul_f32 v131, v26, v131
    v_cvt_pk_bf16_f32 v41, v130, v131
    v_mul_f32 v132, v26, v132
    v_mul_f32 v133, v26, v133
    v_mfma_f32_32x32x16_bf16 v[176:191], v[224:227], a[248:251], v[176:191]
    buffer_load_dwordx4 v16, s[4:7], s43 offen offset:2048 lds
    v_cvt_pk_bf16_f32 v42, v132, v133
    v_mul_f32 v134, v26, v134
    v_mul_f32 v135, v26, v135
    s_waitcnt lgkmcnt(4)
    v_mfma_f32_32x32x16_bf16 v[192:207], v[228:231], a[120:123], v[192:207]
    v_cvt_pk_bf16_f32 v43, v134, v135
    v_mul_f32 v136, v26, v136
    v_mul_f32 v137, v26, v137
    v_cvt_pk_bf16_f32 v44, v136, v137
    v_mul_f32 v138, v26, v138
    v_mul_f32 v139, v26, v139
    v_mfma_f32_32x32x16_bf16 v[208:223], v[228:231], a[248:251], v[208:223]
    buffer_load_dwordx4 v17, s[4:7], s43 offen offset:3072 lds
    v_cvt_pk_bf16_f32 v45, v138, v139
    v_mul_f32 v140, v26, v140
    v_mul_f32 v141, v26, v141
    s_waitcnt lgkmcnt(2)
    v_mfma_f32_32x32x16_bf16 v[160:175], v[232:235], a[124:127], v[160:175]
    v_cvt_pk_bf16_f32 v46, v140, v141
    v_mul_f32 v142, v26, v142
    v_mul_f32 v143, v26, v143
    v_cvt_pk_bf16_f32 v47, v142, v143
    v_permlane16_swap_b32 v40, v44
    v_permlane16_swap_b32 v41, v45
    v_mfma_f32_32x32x16_bf16 v[176:191], v[232:235], a[252:255], v[176:191]
    v_permlane16_swap_b32 v42, v46
    v_permlane16_swap_b32 v43, v47
    v_mul_f32 v144, v27, v144
    v_mul_f32 v145, v27, v145
    v_cvt_pk_bf16_f32 v72, v144, v145
    v_mul_f32 v146, v27, v146
    s_waitcnt lgkmcnt(0)
    v_mfma_f32_32x32x16_bf16 v[192:207], v[236:239], a[124:127], v[192:207]
    v_mul_f32 v147, v27, v147
    v_cvt_pk_bf16_f32 v73, v146, v147
    v_mul_f32 v148, v27, v148
    v_mul_f32 v149, v27, v149
    v_cvt_pk_bf16_f32 v74, v148, v149
    v_mul_f32 v150, v27, v150
    v_mfma_f32_32x32x16_bf16 v[208:223], v[236:239], a[252:255], v[208:223]
    v_mul_f32 v151, v27, v151
    v_cvt_pk_bf16_f32 v75, v150, v151
    v_mul_f32 v152, v27, v152
    v_mul_f32 v153, v27, v153
    v_cvt_pk_bf16_f32 v76, v152, v153
    v_mul_f32 v154, v27, v154
    v_mfma_f32_32x32x16_bf16 v[160:175], a[16:19], a[8:11], v[160:175]
    v_mfma_f32_32x32x16_bf16 v[176:191], a[16:19], a[12:15], v[176:191]
    v_mfma_f32_32x32x16_bf16 v[192:207], a[20:23], a[8:11], v[192:207]
    v_mfma_f32_32x32x16_bf16 v[208:223], a[20:23], a[12:15], v[208:223]
    v_mul_f32 v155, v27, v155
    v_cvt_pk_bf16_f32 v77, v154, v155
    v_mul_f32 v156, v27, v156
    v_mul_f32 v157, v27, v157
    v_cvt_pk_bf16_f32 v78, v156, v157
    v_mul_f32 v158, v27, v158
    v_mul_f32 v159, v27, v159
    v_cvt_pk_bf16_f32 v79, v158, v159
    v_permlane16_swap_b32 v72, v76
    v_permlane16_swap_b32 v73, v77
    v_permlane16_swap_b32 v74, v78
    v_permlane16_swap_b32 v75, v79
    s_nop 11
    v_mul_f32 v160, v26, v160
    v_mul_f32 v161, v26, v161
    v_cvt_pk_bf16_f32 v48, v160, v161
    v_mul_f32 v162, v26, v162
    v_mul_f32 v163, v26, v163
    v_cvt_pk_bf16_f32 v49, v162, v163
    v_mul_f32 v164, v26, v164
    v_mul_f32 v165, v26, v165
    v_cvt_pk_bf16_f32 v50, v164, v165
    v_mul_f32 v166, v26, v166
    v_mul_f32 v167, v26, v167
    v_cvt_pk_bf16_f32 v51, v166, v167
    v_mul_f32 v168, v26, v168
    v_mul_f32 v169, v26, v169
    v_cvt_pk_bf16_f32 v52, v168, v169
    v_mul_f32 v170, v26, v170
    v_mul_f32 v171, v26, v171
    v_cvt_pk_bf16_f32 v53, v170, v171
    v_mul_f32 v172, v26, v172
    v_mul_f32 v173, v26, v173
    v_cvt_pk_bf16_f32 v54, v172, v173
    v_mul_f32 v174, v26, v174
    v_mul_f32 v175, v26, v175
    v_cvt_pk_bf16_f32 v55, v174, v175
    v_permlane16_swap_b32 v48, v52
    v_permlane16_swap_b32 v49, v53
    v_permlane16_swap_b32 v50, v54
    v_permlane16_swap_b32 v51, v55
    v_mul_f32 v176, v27, v176
    v_mul_f32 v177, v27, v177
    v_cvt_pk_bf16_f32 v80, v176, v177
    v_mul_f32 v178, v27, v178
    v_mul_f32 v179, v27, v179
    v_cvt_pk_bf16_f32 v81, v178, v179
    v_mul_f32 v180, v27, v180
    v_mul_f32 v181, v27, v181
    v_cvt_pk_bf16_f32 v82, v180, v181
    v_mul_f32 v182, v27, v182
    v_mul_f32 v183, v27, v183
    v_cvt_pk_bf16_f32 v83, v182, v183
    v_mul_f32 v184, v27, v184
    v_mul_f32 v185, v27, v185
    v_cvt_pk_bf16_f32 v84, v184, v185
    v_mul_f32 v186, v27, v186
    v_mul_f32 v187, v27, v187
    v_cvt_pk_bf16_f32 v85, v186, v187
    v_mul_f32 v188, v27, v188
    v_mul_f32 v189, v27, v189
    v_cvt_pk_bf16_f32 v86, v188, v189
    v_mul_f32 v190, v27, v190
    v_mul_f32 v191, v27, v191
    v_cvt_pk_bf16_f32 v87, v190, v191
    v_permlane16_swap_b32 v80, v84
    v_permlane16_swap_b32 v81, v85
    v_permlane16_swap_b32 v82, v86
    v_permlane16_swap_b32 v83, v87
    v_mul_f32 v192, v26, v192
    v_mul_f32 v193, v26, v193
    v_cvt_pk_bf16_f32 v56, v192, v193
    v_mul_f32 v194, v26, v194
    v_mul_f32 v195, v26, v195
    v_cvt_pk_bf16_f32 v57, v194, v195
    v_mul_f32 v196, v26, v196
    v_mul_f32 v197, v26, v197
    v_cvt_pk_bf16_f32 v58, v196, v197
    v_mul_f32 v198, v26, v198
    v_mul_f32 v199, v26, v199
    v_cvt_pk_bf16_f32 v59, v198, v199
    v_mul_f32 v200, v26, v200
    v_mul_f32 v201, v26, v201
    v_cvt_pk_bf16_f32 v60, v200, v201
    v_mul_f32 v202, v26, v202
    v_mul_f32 v203, v26, v203
    v_cvt_pk_bf16_f32 v61, v202, v203
    v_mul_f32 v204, v26, v204
    v_mul_f32 v205, v26, v205
    v_cvt_pk_bf16_f32 v62, v204, v205
    v_mul_f32 v206, v26, v206
    v_mul_f32 v207, v26, v207
    v_cvt_pk_bf16_f32 v63, v206, v207
    v_permlane16_swap_b32 v56, v60
    v_permlane16_swap_b32 v57, v61
    v_permlane16_swap_b32 v58, v62
    v_permlane16_swap_b32 v59, v63
    v_mul_f32 v208, v27, v208
    v_mul_f32 v209, v27, v209
    v_cvt_pk_bf16_f32 v88, v208, v209
    v_mul_f32 v210, v27, v210
    v_mul_f32 v211, v27, v211
    v_cvt_pk_bf16_f32 v89, v210, v211
    v_mul_f32 v212, v27, v212
    v_mul_f32 v213, v27, v213
    v_cvt_pk_bf16_f32 v90, v212, v213
    v_mul_f32 v214, v27, v214
    v_mul_f32 v215, v27, v215
    v_cvt_pk_bf16_f32 v91, v214, v215
    v_mul_f32 v216, v27, v216
    v_mul_f32 v217, v27, v217
    v_cvt_pk_bf16_f32 v92, v216, v217
    v_mul_f32 v218, v27, v218
    v_mul_f32 v219, v27, v219
    v_cvt_pk_bf16_f32 v93, v218, v219
    v_mul_f32 v220, v27, v220
    v_mul_f32 v221, v27, v221
    v_cvt_pk_bf16_f32 v94, v220, v221
    v_mul_f32 v222, v27, v222
    v_mul_f32 v223, v27, v223
    v_cvt_pk_bf16_f32 v95, v222, v223
    v_permlane16_swap_b32 v88, v92
    v_permlane16_swap_b32 v89, v93
    v_permlane16_swap_b32 v90, v94
    v_permlane16_swap_b32 v91, v95
attn_go:
    s_waitcnt vmcnt(15)
    s_barrier
    s_mov_b32 s37, 32768
    s_mov_b32 s38, 16384
    ds_read_b128 a[128:131], v2 offset:0
    ds_read_b128 a[132:135], v3 offset:0
    s_waitcnt lgkmcnt(1)
    v_mfma_f32_16x16x32_bf16 v[96:99], a[128:131], v[32:35], 0
    ds_read_b128 a[136:139], v4 offset:0
    v_and_b32 v245, 0x70, v19
    v_mul_u32_u24 v245, 65, v245
    v_mfma_f32_16x16x32_bf16 v[100:103], a[128:131], v[36:39], 0
    s_lshl_b32 s74, s34, 10
    v_lshrrev_b32 v245, 4, v245
    v_and_b32 v245, 0xc4, v245
    v_mfma_f32_16x16x32_bf16 v[104:107], a[128:131], v[64:67], 0
    s_and_b32 s58, s72, 1
    v_lshrrev_b32 v252, 7, v19
    v_mul_u32_u24 v252, 2944, v252
    v_mfma_f32_16x16x32_bf16 v[108:111], a[128:131], v[68:71], 0
    s_and_b32 s59, s73, 1
    v_lshlrev_b32 v252, 8, v252
    v_and_b32 v253, 0x70, v19
    s_waitcnt lgkmcnt(1)
    v_mfma_f32_16x16x32_bf16 v[96:99], a[132:135], v[40:43], v[96:99]
    ds_read_b128 a[140:143], v5 offset:0
    v_or_b32 v252, v252, v253
    v_and_b32 v248, 0xf0, v19
    v_mfma_f32_16x16x32_bf16 v[100:103], a[132:135], v[44:47], v[100:103]
    s_lshl_b32 s59, s59, 1
    v_and_b32 v29, 0x300, v19
    v_lshl_add_u32 v248, v29, 1, v248
    v_mfma_f32_16x16x32_bf16 v[104:107], a[132:135], v[72:75], v[104:107]
    s_add_u32 s58, s58, s59
    v_mov_b32 v20, 0x3f803f80
    v_mov_b32 v21, 0x3f803f80
    v_mfma_f32_16x16x32_bf16 v[108:111], a[132:135], v[76:79], v[108:111]
    s_lshr_b32 s59, s72, 1
    v_mov_b32 v22, 0x3f803f80
    v_mov_b32 v23, 0x3f803f80
    s_waitcnt lgkmcnt(1)
    v_mfma_f32_16x16x32_bf16 v[96:99], a[136:139], v[48:51], v[96:99]
    ds_read_b128 a[128:131], v2 offset:4096
    v_mov_b32 v176, 0
    v_mov_b32 v177, 0
    v_mfma_f32_16x16x32_bf16 v[100:103], a[136:139], v[52:55], v[100:103]
    s_lshl_b32 s59, s59, 1
    v_mov_b32 v178, 0
    v_mov_b32 v179, 0
    v_mfma_f32_16x16x32_bf16 v[104:107], a[136:139], v[80:83], v[104:107]
    s_lshr_b32 s3, s34, 1
    v_mov_b32 v180, 0
    v_mov_b32 v181, 0
    v_mfma_f32_16x16x32_bf16 v[108:111], a[136:139], v[84:87], v[108:111]
    s_add_u32 s59, s59, s3
    v_mov_b32 v182, 0
    v_mov_b32 v183, 0
    s_waitcnt lgkmcnt(1)
    v_mfma_f32_16x16x32_bf16 v[96:99], a[140:143], v[56:59], v[96:99]
    ds_read_b128 a[132:135], v3 offset:4096
    v_mov_b32 v184, 0
    v_mov_b32 v185, 0
    v_mfma_f32_16x16x32_bf16 v[100:103], a[140:143], v[60:63], v[100:103]
    s_lshl_b32 s59, s59, 2
    v_mov_b32 v186, 0
    v_mov_b32 v187, 0
    v_mfma_f32_16x16x32_bf16 v[104:107], a[140:143], v[88:91], v[104:107]
    s_add_u32 s59, s59, s58
    v_mov_b32 v188, 0
    v_mov_b32 v189, 0
    v_mfma_f32_16x16x32_bf16 v[108:111], a[140:143], v[92:95], v[108:111]
    s_mul_i32 s59, s59, 4352
    v_mov_b32 v190, 0
    v_mov_b32 v191, 0
    s_waitcnt lgkmcnt(1)
    v_mfma_f32_16x16x32_bf16 v[112:115], a[128:131], v[32:35], 0
    ds_read_b128 a[136:139], v4 offset:4096
    v_lshrrev_b32 v24, 4, v19
    v_lshrrev_b32 v25, 5, v24
    v_mfma_f32_16x16x32_bf16 v[116:119], a[128:131], v[36:39], 0
    s_add_u32 s59, s59, 29360128
    v_bfe_u32 v26, v24, 4, 1
    v_bfe_u32 v27, v24, 2, 2
    v_mfma_f32_16x16x32_bf16 v[120:123], a[128:131], v[64:67], 0
    s_lshl_b32 s60, s33, 2
    v_and_b32 v28, 3, v24
    v_lshl_add_u32 v29, v25, 2, v27
    v_mfma_f32_16x16x32_bf16 v[124:127], a[128:131], v[68:71], 0
    s_add_u32 s60, s60, s34
    v_lshlrev_b32 v29, 7, v29
    v_lshl_add_u32 v29, v26, 5, v29
    s_waitcnt lgkmcnt(1)
    v_mfma_f32_16x16x32_bf16 v[112:115], a[132:135], v[40:43], v[112:115]
    ds_read_b128 a[140:143], v5 offset:4096
    s_lshl_b32 s60, s60, 2
    s_lshr_b32 s3, s32, 3
    v_mfma_f32_16x16x32_bf16 v[116:119], a[132:135], v[44:47], v[116:119]
    s_add_u32 s60, s60, s3
    s_mul_i32 s60, s60, 4352
    s_and_b32 s3, s32, 7
    v_mfma_f32_16x16x32_bf16 v[120:123], a[132:135], v[72:75], v[120:123]
    s_lshl_b32 s3, s3, 2
    s_add_u32 s60, s60, s3
wpad4:
    s_cmp_eq_u32 s98, 1
    s_cbranch_scc1 WARMA_done
    s_add_u32 s60, s60, 29360128
    v_mfma_f32_16x16x32_bf16 v[124:127], a[132:135], v[76:79], v[124:127]
    s_lshr_b32 s3, s72, 1
    v_and_b32 v30, 1, v28
    v_lshlrev_b32 v30, 1, v30
    s_waitcnt lgkmcnt(1)
    v_mfma_f32_16x16x32_bf16 v[112:115], a[136:139], v[48:51], v[112:115]
    ds_read_b128 a[128:131], v2 offset:8192
    v_lshrrev_b32 v31, 1, v28
    v_or_b32 v30, v30, v31
    v_mfma_f32_16x16x32_bf16 v[116:119], a[136:139], v[52:55], v[116:119]
    s_lshl_b32 s3, s3, 2
    v_lshl_add_u32 v29, v30, 3, v29
    v_lshrrev_b32 v30, 1, v27
    v_mfma_f32_16x16x32_bf16 v[120:123], a[136:139], v[80:83], v[120:123]
    s_lshr_b32 s61, s73, 1
    v_lshl_add_u32 v240, v30, 6, v29
    v_xor_b32 v30, 1, v30
    v_mfma_f32_16x16x32_bf16 v[124:127], a[136:139], v[84:87], v[124:127]
    s_add_u32 s3, s3, s61
    v_lshl_add_u32 v241, v30, 6, v29
    v_add_u32 v242, 0x10000, v240
    s_waitcnt lgkmcnt(1)
    v_mfma_f32_16x16x32_bf16 v[112:115], a[140:143], v[56:59], v[112:115]
    ds_read_b128 a[132:135], v3 offset:8192
    v_add_u32 v243, 0x10000, v241
    v_add_u32 v249, 0x20000, v240
    v_mfma_f32_16x16x32_bf16 v[116:119], a[140:143], v[60:63], v[116:119]
    s_lshl_b32 s3, s3, 2
    v_add_u32 v250, 0x20000, v241
    v_bfe_u32 v30, v19, 4, 3
    v_mfma_f32_16x16x32_bf16 v[120:123], a[140:143], v[88:91], v[120:123]
    s_add_u32 s3, s3, s58
    v_lshl_add_u32 v246, v30, 2, s59
    v_mov_b32 v247, s60
    v_mfma_f32_16x16x32_bf16 v[124:127], a[140:143], v[92:95], v[124:127]
    s_lshl_b32 s3, s3, 16
    v_accvgpr_write_b32 a252, -1
    v_accvgpr_write_b32 a253, -1
    s_add_u32 s3, s3, 50331648
    s_add_u32 s12, s56, s3
    s_addc_u32 s13, s57, 0
    s_mov_b32 s14, 65536
    s_mov_b32 s15, 0x20000
    s_lshl_b32 s3, s34, 14
    s_add_u32 s64, s12, s3
    s_addc_u32 s65, s13, 0
    s_mov_b32 s66, 16384
    s_mov_b32 s67, 0x20000
    s_lshl_b32 s68, s42, 14
    s_or_b32 s3, s34, s42
    s_cmp_eq_u32 s3, 0
    s_cselect_b32 s95, 3, 99
    s_and_b32 s3, s73, 6
    s_lshr_b32 s41, s34, 1
    s_add_u32 s3, s3, s41
    s_lshl_b32 s3, s3, 2
    s_add_u32 s3, s3, s58
    s_mul_i32 s3, s3, 188416
    s_and_b32 s41, s34, 1
    s_lshl_b32 s41, s41, 10
    s_add_u32 s3, s3, s41
    s_add_u32 s3, s3, 33554432
    s_add_u32 s16, s56, s3
    s_addc_u32 s17, s57, 0
    s_mov_b32 s18, 187392
    s_mov_b32 s19, 0x20000
    s_and_b32 s41, s72, 30
    s_lshl_b32 s41, s41, 1
    s_add_u32 s41, s41, s34
    s_mul_i32 s3, s41, 114688
    s_mul_i32 s61, s58, 28672
    s_add_u32 s3, s3, s61
    s_add_u32 s3, s3, 2097152
    s_add_u32 s24, s56, s3
    s_addc_u32 s25, s57, 0
    s_mov_b32 s26, 28672
    s_mov_b32 s27, 0x20000
    s_lshl_b32 s3, s41, 18
    s_lshl_b32 s61, s58, 16
    s_add_u32 s3, s3, s61
    s_add_u32 s3, s3, 10485760
    s_add_u32 s28, s56, s3
    s_addc_u32 s29, s57, 0
    s_mov_b32 s30, 65536
    s_mov_b32 s31, 0x20000
    v_accvgpr_write_b32 a254, -1
    v_accvgpr_write_b32 a255, -1
    s_nop 11
    s_cmp_lg_u32 s42, 0
    s_cbranch_scc1 attn_have_max
    v_max3_f32 v24, v96, v97, v98
    v_max3_f32 v24, v24, v99, v112
    v_max3_f32 v24, v24, v113, v114
    v_max_f32 v24, v24, v115
    v_max3_f32 v25, v100, v101, v102
    v_max3_f32 v25, v25, v103, v116
    v_max3_f32 v25, v25, v117, v118
    v_max_f32 v25, v25, v119
    v_max3_f32 v26, v104, v105, v106
    v_max3_f32 v26, v26, v107, v120
    v_max3_f32 v26, v26, v121, v122
    v_max_f32 v26, v26, v123
    v_max3_f32 v27, v108, v109, v110
    v_max3_f32 v27, v27, v111, v124
    v_max3_f32 v27, v27, v125, v126
    v_max_f32 v27, v27, v127
    v_mov_b32 v28, v24
    v_mov_b32 v29, v25
    v_mov_b32 v30, v26
    v_mov_b32 v31, v27
    s_nop 0
    v_permlane16_swap_b32 v24, v28
    v_permlane16_swap_b32 v25, v29
    v_permlane16_swap_b32 v26, v30
    v_permlane16_swap_b32 v27, v31
    s_nop 0
    v_max_f32 v24, v24, v28
    v_max_f32 v25, v25, v29
    v_max_f32 v26, v26, v30
    v_max_f32 v27, v27, v31
    v_mov_b32 v28, v24
    v_mov_b32 v29, v25
    v_mov_b32 v30, v26
    v_mov_b32 v31, v27
    s_nop 0
    v_permlane32_swap_b32 v24, v28
    v_permlane32_swap_b32 v25, v29
    v_permlane32_swap_b32 v26, v30
    v_permlane32_swap_b32 v27, v31
    s_nop 0
    v_max_f32 v24, v24, v28
    v_max_f32 v25, v25, v29
    v_max_f32 v26, v26, v30
    v_max_f32 v27, v27, v31
    v_add_f32 v24, 0x42c00000, v24
    v_add_f32 v25, 0x42c00000, v25
    v_add_f32 v26, 0x42c00000, v26
    v_add_f32 v27, 0x42c00000, v27
    v_sub_f32 v160, 0, v24
    v_sub_f32 v161, 0, v24
    v_sub_f32 v162, 0, v24
    v_sub_f32 v163, 0, v24
    v_sub_f32 v164, 0, v25
    v_sub_f32 v165, 0, v25
    v_sub_f32 v166, 0, v25
    v_sub_f32 v167, 0, v25
    v_sub_f32 v168, 0, v26
    v_sub_f32 v169, 0, v26
    v_sub_f32 v170, 0, v26
    v_sub_f32 v171, 0, v26
    v_sub_f32 v172, 0, v27
    v_sub_f32 v173, 0, v27
    v_sub_f32 v174, 0, v27
    v_sub_f32 v175, 0, v27
attn_have_max:
    v_bfe_u32 v31, v19, 4, 1
    v_mul_u32_u24 v31, 0xaaaa, v31
    v_add_u32 v31, 0x4444, v31
    v_add_f32 v96, v96, v160
    v_add_f32 v97, v97, v161
    v_add_f32 v98, v98, v162
    v_add_f32 v99, v99, v163
    v_add_f32 v100, v100, v164
    v_add_f32 v101, v101, v165
    v_add_f32 v102, v102, v166
    v_add_f32 v103, v103, v167
    v_add_f32 v104, v104, v168
    v_add_f32 v105, v105, v169
    v_add_f32 v106, v106, v170
    v_add_f32 v107, v107, v171
    v_add_f32 v108, v108, v172
    v_add_f32 v109, v109, v173
    v_add_f32 v110, v110, v174
    v_add_f32 v111, v111, v175
    v_add_f32 v112, v112, v160
    v_add_f32 v113, v113, v161
    v_add_f32 v114, v114, v162
    v_add_f32 v115, v115, v163
    v_add_f32 v116, v116, v164
    v_add_f32 v117, v117, v165
    v_add_f32 v118, v118, v166
    v_add_f32 v119, v119, v167
    v_add_f32 v120, v120, v168
    v_add_f32 v121, v121, v169
    v_add_f32 v122, v122, v170
    v_add_f32 v123, v123, v171
    v_add_f32 v124, v124, v172
    v_add_f32 v125, v125, v173
    v_add_f32 v126, v126, v174
    v_add_f32 v127, v127, v175
    s_nop 1
    s_waitcnt lgkmcnt(1)
    v_mfma_f32_16x16x32_bf16 v[128:131], a[128:131], v[32:35], v[160:163]
    v_exp_f32 v96, v96
    ds_read_b128 a[136:139], v4 offset:8192
    v_mfma_f32_16x16x32_bf16 v[132:135], a[128:131], v[36:39], v[164:167]
    v_exp_f32 v97, v97
    v_exp_f32 v98, v98
    v_mfma_f32_16x16x32_bf16 v[136:139], a[128:131], v[64:67], v[168:171]
    v_cvt_pk_bf16_f32 v192, v96, v97
    v_exp_f32 v99, v99
    v_mfma_f32_16x16x32_bf16 v[140:143], a[128:131], v[68:71], v[172:175]
    s_waitcnt lgkmcnt(1)
    v_mfma_f32_16x16x32_bf16 v[128:131], a[132:135], v[40:43], v[128:131]
    v_exp_f32 v100, v100
    ds_read_b128 a[140:143], v5 offset:8192
    v_mfma_f32_16x16x32_bf16 v[132:135], a[132:135], v[44:47], v[132:135]
    v_exp_f32 v101, v101
    v_cvt_pk_bf16_f32 v193, v98, v99
    v_mfma_f32_16x16x32_bf16 v[136:139], a[132:135], v[72:75], v[136:139]
    v_exp_f32 v102, v102
    v_cvt_pk_bf16_f32 v200, v100, v101
    v_mfma_f32_16x16x32_bf16 v[140:143], a[132:135], v[76:79], v[140:143]
    v_exp_f32 v103, v103
    s_waitcnt lgkmcnt(1)
    v_mfma_f32_16x16x32_bf16 v[128:131], a[136:139], v[48:51], v[128:131]
    v_exp_f32 v104, v104
    ds_read_b128 a[128:131], v2 offset:12288
    v_mfma_f32_16x16x32_bf16 v[132:135], a[136:139], v[52:55], v[132:135]
    v_exp_f32 v105, v105
    v_cvt_pk_bf16_f32 v201, v102, v103
    v_mfma_f32_16x16x32_bf16 v[136:139], a[136:139], v[80:83], v[136:139]
    v_exp_f32 v106, v106
    v_cvt_pk_bf16_f32 v208, v104, v105
    v_mfma_f32_16x16x32_bf16 v[140:143], a[136:139], v[84:87], v[140:143]
    v_exp_f32 v107, v107
    s_waitcnt lgkmcnt(1)
    v_mfma_f32_16x16x32_bf16 v[128:131], a[140:143], v[56:59], v[128:131]
    v_exp_f32 v108, v108
    ds_read_b128 a[132:135], v3 offset:12288
    v_mfma_f32_16x16x32_bf16 v[132:135], a[140:143], v[60:63], v[132:135]
    v_exp_f32 v109, v109
    v_cvt_pk_bf16_f32 v209, v106, v107
    v_mfma_f32_16x16x32_bf16 v[136:139], a[140:143], v[88:91], v[136:139]
    v_exp_f32 v110, v110
    v_cvt_pk_bf16_f32 v216, v108, v109
    v_mfma_f32_16x16x32_bf16 v[140:143], a[140:143], v[92:95], v[140:143]
    v_exp_f32 v111, v111
    s_waitcnt lgkmcnt(1)
    v_mfma_f32_16x16x32_bf16 v[144:147], a[128:131], v[32:35], v[160:163]
    v_exp_f32 v112, v112
    ds_read_b128 a[136:139], v4 offset:12288
    v_mfma_f32_16x16x32_bf16 v[148:151], a[128:131], v[36:39], v[164:167]
    v_exp_f32 v113, v113
    v_cvt_pk_bf16_f32 v217, v110, v111
    v_mfma_f32_16x16x32_bf16 v[152:155], a[128:131], v[64:67], v[168:171]
    v_exp_f32 v114, v114
    v_cvt_pk_bf16_f32 v194, v112, v113
    v_mfma_f32_16x16x32_bf16 v[156:159], a[128:131], v[68:71], v[172:175]
    v_exp_f32 v115, v115
    s_waitcnt lgkmcnt(1)
    v_mfma_f32_16x16x32_bf16 v[144:147], a[132:135], v[40:43], v[144:147]
    v_exp_f32 v116, v116
    ds_read_b128 a[140:143], v5 offset:12288
    v_mfma_f32_16x16x32_bf16 v[148:151], a[132:135], v[44:47], v[148:151]
    v_exp_f32 v117, v117
    v_cvt_pk_bf16_f32 v195, v114, v115
    v_mfma_f32_16x16x32_bf16 v[152:155], a[132:135], v[72:75], v[152:155]
    v_exp_f32 v118, v118
    v_cvt_pk_bf16_f32 v202, v116, v117
    v_mfma_f32_16x16x32_bf16 v[156:159], a[132:135], v[76:79], v[156:159]
    v_exp_f32 v119, v119
    s_waitcnt lgkmcnt(1)
    v_mfma_f32_16x16x32_bf16 v[144:147], a[136:139], v[48:51], v[144:147]
    s_waitcnt vmcnt(4)
    s_barrier
    v_exp_f32 v120, v120
    ds_read_b128 a[128:131], v2 offset:16384
    v_exp_f32 v121, v121
    s_add_u32 s37, s37, 16384
    s_add_u32 s38, s38, 16384
    s_add_u32 m0, s35, 49152
    s_nop 0
    buffer_load_dwordx4 v14, s[4:7], s37 offen offset:0 lds
    v_mfma_f32_16x16x32_bf16 v[148:151], a[136:139], v[52:55], v[148:151]
    v_cvt_pk_bf16_f32 v203, v118, v119
    ds_read_b64_tr_b16 a[144:145], v6 offset:0
    v_exp_f32 v122, v122
    buffer_load_dwordx4 v15, s[4:7], s37 offen offset:1024 lds
    v_mfma_f32_16x16x32_bf16 v[152:155], a[136:139], v[80:83], v[152:155]
    ds_read_b64_tr_b16 a[146:147], v6 offset:4096
    v_cvt_pk_bf16_f32 v210, v120, v121
    v_exp_f32 v123, v123
    buffer_load_dwordx4 v16, s[4:7], s37 offen offset:2048 lds
    v_mfma_f32_16x16x32_bf16 v[156:159], a[136:139], v[84:87], v[156:159]
    buffer_load_dwordx4 v17, s[4:7], s37 offen offset:3072 lds
    s_waitcnt lgkmcnt(3)
    v_mfma_f32_16x16x32_bf16 v[144:147], a[140:143], v[56:59], v[144:147]
    v_exp_f32 v124, v124
    ds_read_b128 a[132:135], v3 offset:16384
    v_exp_f32 v125, v125
    s_add_u32 m0, s35, 98304
    s_nop 0
    buffer_load_dwordx4 v18, s[8:11], s38 offen offset:0 lds
    v_mfma_f32_16x16x32_bf16 v[148:151], a[140:143], v[60:63], v[148:151]
    v_cvt_pk_bf16_f32 v211, v122, v123
    ds_read_b64_tr_b16 a[148:149], v7 offset:0
    v_exp_f32 v126, v126
    buffer_load_dwordx4 v1, s[8:11], s38 offen offset:1024 lds
    v_mfma_f32_16x16x32_bf16 v[152:155], a[140:143], v[88:91], v[152:155]
    ds_read_b64_tr_b16 a[150:151], v7 offset:4096
    v_cvt_pk_bf16_f32 v218, v124, v125
    v_exp_f32 v127, v127
    buffer_load_dwordx4 v18, s[8:11], s38 offen offset:2048 lds
    v_mfma_f32_16x16x32_bf16 v[156:159], a[140:143], v[92:95], v[156:159]
    buffer_load_dwordx4 v1, s[8:11], s38 offen offset:3072 lds
    s_waitcnt lgkmcnt(3)
    v_mfma_f32_16x16x32_bf16 v[96:99], a[128:131], v[32:35], v[160:163]
    v_exp_f32 v128, v128
    v_mfma_f32_16x16x32_bf16 v[100:103], a[128:131], v[36:39], v[164:167]
    ds_read_b128 a[136:139], v4 offset:16384
    ds_read_b64_tr_b16 a[152:153], v8 offset:0
    v_mfma_f32_16x16x32_bf16 v[104:107], a[128:131], v[64:67], v[168:171]
    v_exp_f32 v129, v129
    v_mfma_f32_16x16x32_bf16 v[108:111], a[128:131], v[68:71], v[172:175]
    ds_read_b64_tr_b16 a[154:155], v8 offset:4096
    v_cvt_pk_bf16_f32 v219, v126, v127
    v_mfma_f32_16x16x32_bf16 a[0:3], a[144:147], v[192:195], 0
    v_exp_f32 v130, v130
    v_mfma_f32_16x16x32_bf16 a[4:7], a[144:147], v[200:203], 0
    v_cvt_pk_bf16_f32 v196, v128, v129
    v_mfma_f32_16x16x32_bf16 a[8:11], a[144:147], v[208:211], 0
    v_exp_f32 v131, v131
    v_mfma_f32_16x16x32_bf16 a[12:15], a[144:147], v[216:219], 0
    global_load_dword v25, v245, s[62:63] sc1
    s_waitcnt lgkmcnt(3)
    v_mfma_f32_16x16x32_bf16 v[96:99], a[132:135], v[40:43], v[96:99]
    v_exp_f32 v132, v132
    v_mfma_f32_16x16x32_bf16 v[100:103], a[132:135], v[44:47], v[100:103]
    ds_read_b128 a[140:143], v5 offset:16384
    ds_read_b64_tr_b16 a[156:157], v9 offset:0
    v_mfma_f32_16x16x32_bf16 v[104:107], a[132:135], v[72:75], v[104:107]
    v_exp_f32 v133, v133
    v_mfma_f32_16x16x32_bf16 v[108:111], a[132:135], v[76:79], v[108:111]
    ds_read_b64_tr_b16 a[158:159], v9 offset:4096
    v_cvt_pk_bf16_f32 v197, v130, v131
    v_mfma_f32_16x16x32_bf16 a[16:19], a[148:151], v[192:195], 0
    v_exp_f32 v134, v134
    v_mfma_f32_16x16x32_bf16 a[20:23], a[148:151], v[200:203], 0
    v_cvt_pk_bf16_f32 v204, v132, v133
    v_mfma_f32_16x16x32_bf16 a[24:27], a[148:151], v[208:211], 0
    v_exp_f32 v135, v135
    v_mfma_f32_16x16x32_bf16 a[28:31], a[148:151], v[216:219], 0
    global_load_dword v25, v245, s[62:63] sc1
    s_waitcnt lgkmcnt(3)
    v_mfma_f32_16x16x32_bf16 v[96:99], a[136:139], v[48:51], v[96:99]
    v_exp_f32 v136, v136
    v_mfma_f32_16x16x32_bf16 v[100:103], a[136:139], v[52:55], v[100:103]
    ds_read_b128 a[128:131], v2 offset:20480
    ds_read_b64_tr_b16 a[144:145], v10 offset:0
    v_mfma_f32_16x16x32_bf16 v[104:107], a[136:139], v[80:83], v[104:107]
    v_exp_f32 v137, v137
    v_mfma_f32_16x16x32_bf16 v[108:111], a[136:139], v[84:87], v[108:111]
    ds_read_b64_tr_b16 a[146:147], v10 offset:4096
    v_cvt_pk_bf16_f32 v205, v134, v135
    v_mfma_f32_16x16x32_bf16 a[32:35], a[152:155], v[192:195], 0
    v_exp_f32 v138, v138
    v_mfma_f32_16x16x32_bf16 a[36:39], a[152:155], v[200:203], 0
    v_cvt_pk_bf16_f32 v212, v136, v137
    v_mfma_f32_16x16x32_bf16 a[40:43], a[152:155], v[208:211], 0
    v_exp_f32 v139, v139
    v_mfma_f32_16x16x32_bf16 a[44:47], a[152:155], v[216:219], 0
    s_waitcnt lgkmcnt(3)
    v_mfma_f32_16x16x32_bf16 v[96:99], a[140:143], v[56:59], v[96:99]
    v_exp_f32 v140, v140
    v_mfma_f32_16x16x32_bf16 v[100:103], a[140:143], v[60:63], v[100:103]
    ds_read_b128 a[132:135], v3 offset:20480
    ds_read_b64_tr_b16 a[148:149], v11 offset:0
    v_mfma_f32_16x16x32_bf16 v[104:107], a[140:143], v[88:91], v[104:107]
    v_exp_f32 v141, v141
    v_mfma_f32_16x16x32_bf16 v[108:111], a[140:143], v[92:95], v[108:111]
    ds_read_b64_tr_b16 a[150:151], v11 offset:4096
    v_cvt_pk_bf16_f32 v213, v138, v139
    v_mfma_f32_16x16x32_bf16 a[48:51], a[156:159], v[192:195], 0
    v_exp_f32 v142, v142
    v_mfma_f32_16x16x32_bf16 a[52:55], a[156:159], v[200:203], 0
    v_cvt_pk_bf16_f32 v220, v140, v141
    v_mfma_f32_16x16x32_bf16 a[56:59], a[156:159], v[208:211], 0
    v_exp_f32 v143, v143
    v_mfma_f32_16x16x32_bf16 a[60:63], a[156:159], v[216:219], 0
    s_waitcnt lgkmcnt(3)
    v_mfma_f32_16x16x32_bf16 v[112:115], a[128:131], v[32:35], v[160:163]
    v_exp_f32 v144, v144
    v_mfma_f32_16x16x32_bf16 v[116:119], a[128:131], v[36:39], v[164:167]
    ds_read_b128 a[136:139], v4 offset:20480
    ds_read_b64_tr_b16 a[152:153], v12 offset:0
    v_mfma_f32_16x16x32_bf16 v[120:123], a[128:131], v[64:67], v[168:171]
    v_exp_f32 v145, v145
    v_mfma_f32_16x16x32_bf16 v[124:127], a[128:131], v[68:71], v[172:175]
    ds_read_b64_tr_b16 a[154:155], v12 offset:4096
    v_cvt_pk_bf16_f32 v221, v142, v143
    v_mfma_f32_16x16x32_bf16 a[64:67], a[144:147], v[192:195], 0
    v_exp_f32 v146, v146
    v_mfma_f32_16x16x32_bf16 a[68:71], a[144:147], v[200:203], 0
    v_cvt_pk_bf16_f32 v198, v144, v145
    v_mfma_f32_16x16x32_bf16 a[72:75], a[144:147], v[208:211], 0
    v_exp_f32 v147, v147
    v_mfma_f32_16x16x32_bf16 a[76:79], a[144:147], v[216:219], 0
    s_waitcnt lgkmcnt(3)
    v_mfma_f32_16x16x32_bf16 v[112:115], a[132:135], v[40:43], v[112:115]
    v_exp_f32 v148, v148
    v_mfma_f32_16x16x32_bf16 v[116:119], a[132:135], v[44:47], v[116:119]
    ds_read_b128 a[140:143], v5 offset:20480
    ds_read_b64_tr_b16 a[156:157], v13 offset:0
    v_mfma_f32_16x16x32_bf16 v[120:123], a[132:135], v[72:75], v[120:123]
    v_exp_f32 v149, v149
    v_mfma_f32_16x16x32_bf16 v[124:127], a[132:135], v[76:79], v[124:127]
    ds_read_b64_tr_b16 a[158:159], v13 offset:4096
    v_cvt_pk_bf16_f32 v199, v146, v147
    v_mfma_f32_16x16x32_bf16 a[80:83], a[148:151], v[192:195], 0
    v_exp_f32 v150, v150
    v_mfma_f32_16x16x32_bf16 a[84:87], a[148:151], v[200:203], 0
    v_cvt_pk_bf16_f32 v206, v148, v149
    v_mfma_f32_16x16x32_bf16 a[88:91], a[148:151], v[208:211], 0
    v_exp_f32 v151, v151
    v_mfma_f32_16x16x32_bf16 a[92:95], a[148:151], v[216:219], 0
    s_waitcnt lgkmcnt(3)
    v_mfma_f32_16x16x32_bf16 v[112:115], a[136:139], v[48:51], v[112:115]
    v_exp_f32 v152, v152
    v_mfma_f32_16x16x32_bf16 v[116:119], a[136:139], v[52:55], v[116:119]
    ds_read_b128 a[128:131], v2 offset:24576
    ds_read_b64_tr_b16 a[144:145], v6 offset:8192
    v_mfma_f32_16x16x32_bf16 v[120:123], a[136:139], v[80:83], v[120:123]
    v_exp_f32 v153, v153
    v_mfma_f32_16x16x32_bf16 v[124:127], a[136:139], v[84:87], v[124:127]
    ds_read_b64_tr_b16 a[146:147], v6 offset:12288
    v_cvt_pk_bf16_f32 v207, v150, v151
    v_mfma_f32_16x16x32_bf16 a[96:99], a[152:155], v[192:195], 0
    v_exp_f32 v154, v154
    v_mfma_f32_16x16x32_bf16 a[100:103], a[152:155], v[200:203], 0
    v_cvt_pk_bf16_f32 v214, v152, v153
    v_mfma_f32_16x16x32_bf16 a[104:107], a[152:155], v[208:211], 0
    v_exp_f32 v155, v155
    v_mfma_f32_16x16x32_bf16 a[108:111], a[152:155], v[216:219], 0
    s_waitcnt lgkmcnt(3)
    v_mfma_f32_16x16x32_bf16 v[112:115], a[140:143], v[56:59], v[112:115]
    v_exp_f32 v156, v156
    v_mfma_f32_16x16x32_bf16 v[116:119], a[140:143], v[60:63], v[116:119]
    ds_read_b128 a[132:135], v3 offset:24576
    ds_read_b64_tr_b16 a[148:149], v7 offset:8192
    v_mfma_f32_16x16x32_bf16 v[120:123], a[140:143], v[88:91], v[120:123]
    v_exp_f32 v157, v157
    v_mfma_f32_16x16x32_bf16 v[124:127], a[140:143], v[92:95], v[124:127]
    ds_read_b64_tr_b16 a[150:151], v7 offset:12288
    v_cvt_pk_bf16_f32 v215, v154, v155
    v_mfma_f32_16x16x32_bf16 a[112:115], a[156:159], v[192:195], 0
    v_exp_f32 v158, v158
    v_mfma_f32_16x16x32_bf16 a[116:119], a[156:159], v[200:203], 0
    v_cvt_pk_bf16_f32 v222, v156, v157
    v_mfma_f32_16x16x32_bf16 a[120:123], a[156:159], v[208:211], 0
    v_exp_f32 v159, v159
    v_mfma_f32_16x16x32_bf16 a[124:127], a[156:159], v[216:219], 0
    s_waitcnt lgkmcnt(3)
    v_mfma_f32_16x16x32_bf16 v[128:131], a[128:131], v[32:35], v[160:163]
    v_exp_f32 v96, v96
    v_mfma_f32_16x16x32_bf16 v[132:135], a[128:131], v[36:39], v[164:167]
    ds_read_b128 a[136:139], v4 offset:24576
    ds_read_b64_tr_b16 a[152:153], v8 offset:8192
    v_mfma_f32_16x16x32_bf16 v[136:139], a[128:131], v[64:67], v[168:171]
    v_exp_f32 v97, v97
    v_mfma_f32_16x16x32_bf16 v[140:143], a[128:131], v[68:71], v[172:175]
    ds_read_b64_tr_b16 a[154:155], v8 offset:12288
    v_cvt_pk_bf16_f32 v223, v158, v159
    v_smfmac_f32_16x16x64_bf16 v[176:179], v[20:23], v[192:199], v31
    v_exp_f32 v98, v98
    v_mfma_f32_16x16x32_bf16 a[0:3], a[144:147], v[196:199], a[0:3]
    v_cvt_pk_bf16_f32 v192, v96, v97
    v_mfma_f32_16x16x32_bf16 a[4:7], a[144:147], v[204:207], a[4:7]
    v_exp_f32 v99, v99
    v_mfma_f32_16x16x32_bf16 a[8:11], a[144:147], v[212:215], a[8:11]
    v_mfma_f32_16x16x32_bf16 a[12:15], a[144:147], v[220:223], a[12:15]
    s_waitcnt lgkmcnt(3)
    v_mfma_f32_16x16x32_bf16 v[128:131], a[132:135], v[40:43], v[128:131]
    v_exp_f32 v100, v100
    v_mfma_f32_16x16x32_bf16 v[132:135], a[132:135], v[44:47], v[132:135]
    ds_read_b128 a[140:143], v5 offset:24576
    ds_read_b64_tr_b16 a[156:157], v9 offset:8192
    v_mfma_f32_16x16x32_bf16 v[136:139], a[132:135], v[72:75], v[136:139]
    v_exp_f32 v101, v101
    v_mfma_f32_16x16x32_bf16 v[140:143], a[132:135], v[76:79], v[140:143]
    ds_read_b64_tr_b16 a[158:159], v9 offset:12288
    v_cvt_pk_bf16_f32 v193, v98, v99
    v_smfmac_f32_16x16x64_bf16 v[180:183], v[20:23], v[200:207], v31
    v_exp_f32 v102, v102
    v_mfma_f32_16x16x32_bf16 a[16:19], a[148:151], v[196:199], a[16:19]
    v_cvt_pk_bf16_f32 v200, v100, v101
    v_mfma_f32_16x16x32_bf16 a[20:23], a[148:151], v[204:207], a[20:23]
    v_exp_f32 v103, v103
    v_mfma_f32_16x16x32_bf16 a[24:27], a[148:151], v[212:215], a[24:27]
    v_mfma_f32_16x16x32_bf16 a[28:31], a[148:151], v[220:223], a[28:31]
    s_waitcnt lgkmcnt(3)
    v_mfma_f32_16x16x32_bf16 v[128:131], a[136:139], v[48:51], v[128:131]
    v_exp_f32 v104, v104
    v_mfma_f32_16x16x32_bf16 v[132:135], a[136:139], v[52:55], v[132:135]
    ds_read_b128 a[128:131], v2 offset:28672
    ds_read_b64_tr_b16 a[144:145], v10 offset:8192
    v_mfma_f32_16x16x32_bf16 v[136:139], a[136:139], v[80:83], v[136:139]
    v_exp_f32 v105, v105
    v_mfma_f32_16x16x32_bf16 v[140:143], a[136:139], v[84:87], v[140:143]
    ds_read_b64_tr_b16 a[146:147], v10 offset:12288
    v_cvt_pk_bf16_f32 v201, v102, v103
    v_smfmac_f32_16x16x64_bf16 v[184:187], v[20:23], v[208:215], v31
    v_exp_f32 v106, v106
    v_mfma_f32_16x16x32_bf16 a[32:35], a[152:155], v[196:199], a[32:35]
    v_cvt_pk_bf16_f32 v208, v104, v105
    v_mfma_f32_16x16x32_bf16 a[36:39], a[152:155], v[204:207], a[36:39]
    v_exp_f32 v107, v107
    v_mfma_f32_16x16x32_bf16 a[40:43], a[152:155], v[212:215], a[40:43]
    v_mfma_f32_16x16x32_bf16 a[44:47], a[152:155], v[220:223], a[44:47]
    s_waitcnt lgkmcnt(3)
    v_mfma_f32_16x16x32_bf16 v[128:131], a[140:143], v[56:59], v[128:131]
    v_exp_f32 v108, v108
    v_mfma_f32_16x16x32_bf16 v[132:135], a[140:143], v[60:63], v[132:135]
    ds_read_b128 a[132:135], v3 offset:28672
    ds_read_b64_tr_b16 a[148:149], v11 offset:8192
    v_mfma_f32_16x16x32_bf16 v[136:139], a[140:143], v[88:91], v[136:139]
    v_exp_f32 v109, v109
    v_mfma_f32_16x16x32_bf16 v[140:143], a[140:143], v[92:95], v[140:143]
    ds_read_b64_tr_b16 a[150:151], v11 offset:12288
    v_cvt_pk_bf16_f32 v209, v106, v107
    v_smfmac_f32_16x16x64_bf16 v[188:191], v[20:23], v[216:223], v31
    v_exp_f32 v110, v110
    v_mfma_f32_16x16x32_bf16 a[48:51], a[156:159], v[196:199], a[48:51]
    v_cvt_pk_bf16_f32 v216, v108, v109
    v_mfma_f32_16x16x32_bf16 a[52:55], a[156:159], v[204:207], a[52:55]
    v_exp_f32 v111, v111
    v_mfma_f32_16x16x32_bf16 a[56:59], a[156:159], v[212:215], a[56:59]
    v_mfma_f32_16x16x32_bf16 a[60:63], a[156:159], v[220:223], a[60:63]
    s_waitcnt lgkmcnt(3)
    v_mfma_f32_16x16x32_bf16 v[144:147], a[128:131], v[32:35], v[160:163]
    v_exp_f32 v112, v112
    v_mfma_f32_16x16x32_bf16 v[148:151], a[128:131], v[36:39], v[164:167]
    ds_read_b128 a[136:139], v4 offset:28672
    ds_read_b64_tr_b16 a[152:153], v12 offset:8192
    v_mfma_f32_16x16x32_bf16 v[152:155], a[128:131], v[64:67], v[168:171]
    v_exp_f32 v113, v113
    v_mfma_f32_16x16x32_bf16 v[156:159], a[128:131], v[68:71], v[172:175]
    ds_read_b64_tr_b16 a[154:155], v12 offset:12288
    v_cvt_pk_bf16_f32 v217, v110, v111
    v_mfma_f32_16x16x32_bf16 a[64:67], a[144:147], v[196:199], a[64:67]
    v_exp_f32 v114, v114
    v_mfma_f32_16x16x32_bf16 a[68:71], a[144:147], v[204:207], a[68:71]
    v_cvt_pk_bf16_f32 v194, v112, v113
    v_mfma_f32_16x16x32_bf16 a[72:75], a[144:147], v[212:215], a[72:75]
    v_exp_f32 v115, v115
    v_mfma_f32_16x16x32_bf16 a[76:79], a[144:147], v[220:223], a[76:79]
    s_waitcnt lgkmcnt(3)
    v_mfma_f32_16x16x32_bf16 v[144:147], a[132:135], v[40:43], v[144:147]
    v_exp_f32 v116, v116
    v_mfma_f32_16x16x32_bf16 v[148:151], a[132:135], v[44:47], v[148:151]
    ds_read_b128 a[140:143], v5 offset:28672
    ds_read_b64_tr_b16 a[156:157], v13 offset:8192
    v_mfma_f32_16x16x32_bf16 v[152:155], a[132:135], v[72:75], v[152:155]
    v_exp_f32 v117, v117
    v_mfma_f32_16x16x32_bf16 v[156:159], a[132:135], v[76:79], v[156:159]
    ds_read_b64_tr_b16 a[158:159], v13 offset:12288
    v_cvt_pk_bf16_f32 v195, v114, v115
    v_mfma_f32_16x16x32_bf16 a[80:83], a[148:151], v[196:199], a[80:83]
    v_exp_f32 v118, v118
    v_mfma_f32_16x16x32_bf16 a[84:87], a[148:151], v[204:207], a[84:87]
    v_cvt_pk_bf16_f32 v202, v116, v117
    v_mfma_f32_16x16x32_bf16 a[88:91], a[148:151], v[212:215], a[88:91]
    v_exp_f32 v119, v119
    v_mfma_f32_16x16x32_bf16 a[92:95], a[148:151], v[220:223], a[92:95]
    s_waitcnt lgkmcnt(3)
    v_mfma_f32_16x16x32_bf16 v[144:147], a[136:139], v[48:51], v[144:147]
    s_waitcnt vmcnt(10)
    s_barrier
    v_exp_f32 v120, v120
    v_mfma_f32_16x16x32_bf16 v[148:151], a[136:139], v[52:55], v[148:151]
    ds_read_b128 a[128:131], v2 offset:32768
    ds_read_b64_tr_b16 a[144:145], v6 offset:16384
    v_mfma_f32_16x16x32_bf16 v[152:155], a[136:139], v[80:83], v[152:155]
    v_exp_f32 v121, v121
    v_mfma_f32_16x16x32_bf16 v[156:159], a[136:139], v[84:87], v[156:159]
    ds_read_b64_tr_b16 a[146:147], v6 offset:20480
    v_cvt_pk_bf16_f32 v203, v118, v119
    v_mfma_f32_16x16x32_bf16 a[96:99], a[152:155], v[196:199], a[96:99]
    v_exp_f32 v122, v122
    v_mfma_f32_16x16x32_bf16 a[100:103], a[152:155], v[204:207], a[100:103]
    v_cvt_pk_bf16_f32 v210, v120, v121
    v_mfma_f32_16x16x32_bf16 a[104:107], a[152:155], v[212:215], a[104:107]
    v_exp_f32 v123, v123
    v_mfma_f32_16x16x32_bf16 a[108:111], a[152:155], v[220:223], a[108:111]
    s_add_u32 s37, s37, 16384
    s_add_u32 s38, s38, 16384
    s_add_u32 m0, s35, 0
    s_nop 0
    buffer_load_dwordx4 v14, s[4:7], s37 offen offset:0 lds
    s_waitcnt lgkmcnt(3)
    v_mfma_f32_16x16x32_bf16 v[144:147], a[140:143], v[56:59], v[144:147]
    v_exp_f32 v124, v124
    v_mfma_f32_16x16x32_bf16 v[148:151], a[140:143], v[60:63], v[148:151]
    ds_read_b128 a[132:135], v3 offset:32768
    ds_read_b64_tr_b16 a[148:149], v7 offset:16384
    v_mfma_f32_16x16x32_bf16 v[152:155], a[140:143], v[88:91], v[152:155]
    v_exp_f32 v125, v125
    v_mfma_f32_16x16x32_bf16 v[156:159], a[140:143], v[92:95], v[156:159]
    ds_read_b64_tr_b16 a[150:151], v7 offset:20480
    v_cvt_pk_bf16_f32 v211, v122, v123
    v_mfma_f32_16x16x32_bf16 a[112:115], a[156:159], v[196:199], a[112:115]
    v_exp_f32 v126, v126
    v_mfma_f32_16x16x32_bf16 a[116:119], a[156:159], v[204:207], a[116:119]
    v_cvt_pk_bf16_f32 v218, v124, v125
    v_mfma_f32_16x16x32_bf16 a[120:123], a[156:159], v[212:215], a[120:123]
    v_exp_f32 v127, v127
    v_mfma_f32_16x16x32_bf16 a[124:127], a[156:159], v[220:223], a[124:127]
    buffer_load_dwordx4 v15, s[4:7], s37 offen offset:1024 lds
    s_mov_b32 s39, 7
attn_loop:
    s_waitcnt lgkmcnt(3)
    v_mfma_f32_16x16x32_bf16 v[96:99], a[128:131], v[32:35], v[160:163]
    v_exp_f32 v128, v128
    v_mfma_f32_16x16x32_bf16 v[100:103], a[128:131], v[36:39], v[164:167]
    ds_read_b128 a[136:139], v4 offset:32768
    ds_read_b64_tr_b16 a[152:153], v8 offset:16384
    v_mfma_f32_16x16x32_bf16 v[104:107], a[128:131], v[64:67], v[168:171]
    v_exp_f32 v129, v129
    v_mfma_f32_16x16x32_bf16 v[108:111], a[128:131], v[68:71], v[172:175]
    ds_read_b64_tr_b16 a[154:155], v8 offset:20480
    v_cvt_pk_bf16_f32 v219, v126, v127
    v_mfma_f32_16x16x32_bf16 a[0:3], a[144:147], v[192:195], a[0:3]
    v_exp_f32 v130, v130
    v_mfma_f32_16x16x32_bf16 a[4:7], a[144:147], v[200:203], a[4:7]
    v_cvt_pk_bf16_f32 v196, v128, v129
    v_mfma_f32_16x16x32_bf16 a[8:11], a[144:147], v[208:211], a[8:11]
    v_exp_f32 v131, v131
    v_mfma_f32_16x16x32_bf16 a[12:15], a[144:147], v[216:219], a[12:15]
    buffer_load_dwordx4 v16, s[4:7], s37 offen offset:2048 lds
    s_waitcnt lgkmcnt(3)
    v_mfma_f32_16x16x32_bf16 v[96:99], a[132:135], v[40:43], v[96:99]
    v_exp_f32 v132, v132
    v_mfma_f32_16x16x32_bf16 v[100:103], a[132:135], v[44:47], v[100:103]
    ds_read_b128 a[140:143], v5 offset:32768
    ds_read_b64_tr_b16 a[156:157], v9 offset:16384
    v_mfma_f32_16x16x32_bf16 v[104:107], a[132:135], v[72:75], v[104:107]
    v_exp_f32 v133, v133
    v_mfma_f32_16x16x32_bf16 v[108:111], a[132:135], v[76:79], v[108:111]
    ds_read_b64_tr_b16 a[158:159], v9 offset:20480
    v_cvt_pk_bf16_f32 v197, v130, v131
    v_mfma_f32_16x16x32_bf16 a[16:19], a[148:151], v[192:195], a[16:19]
    v_exp_f32 v134, v134
    v_mfma_f32_16x16x32_bf16 a[20:23], a[148:151], v[200:203], a[20:23]
    v_cvt_pk_bf16_f32 v204, v132, v133
    v_mfma_f32_16x16x32_bf16 a[24:27], a[148:151], v[208:211], a[24:27]
    v_exp_f32 v135, v135
wpad5:
    s_cmp_eq_u32 s98, 1
    s_cbranch_scc1 WARMA_done
    v_mfma_f32_16x16x32_bf16 a[28:31], a[148:151], v[216:219], a[28:31]
    buffer_load_dwordx4 v17, s[4:7], s37 offen offset:3072 lds
    s_waitcnt lgkmcnt(3)
    v_mfma_f32_16x16x32_bf16 v[96:99], a[136:139], v[48:51], v[96:99]
    v_exp_f32 v136, v136
    v_mfma_f32_16x16x32_bf16 v[100:103], a[136:139], v[52:55], v[100:103]
    ds_read_b128 a[128:131], v2 offset:36864
    ds_read_b64_tr_b16 a[144:145], v10 offset:16384
    v_mfma_f32_16x16x32_bf16 v[104:107], a[136:139], v[80:83], v[104:107]
    v_exp_f32 v137, v137
    v_mfma_f32_16x16x32_bf16 v[108:111], a[136:139], v[84:87], v[108:111]
    ds_read_b64_tr_b16 a[146:147], v10 offset:20480
    v_cvt_pk_bf16_f32 v205, v134, v135
    v_mfma_f32_16x16x32_bf16 a[32:35], a[152:155], v[192:195], a[32:35]
    v_exp_f32 v138, v138
    v_mfma_f32_16x16x32_bf16 a[36:39], a[152:155], v[200:203], a[36:39]
    v_cvt_pk_bf16_f32 v212, v136, v137
    v_mfma_f32_16x16x32_bf16 a[40:43], a[152:155], v[208:211], a[40:43]
    v_exp_f32 v139, v139
    v_mfma_f32_16x16x32_bf16 a[44:47], a[152:155], v[216:219], a[44:47]
    s_add_u32 m0, s35, 114688
    s_nop 0
    buffer_load_dwordx4 v18, s[8:11], s38 offen offset:0 lds
    s_waitcnt lgkmcnt(3)
    v_mfma_f32_16x16x32_bf16 v[96:99], a[140:143], v[56:59], v[96:99]
    v_exp_f32 v140, v140
    v_mfma_f32_16x16x32_bf16 v[100:103], a[140:143], v[60:63], v[100:103]
    ds_read_b128 a[132:135], v3 offset:36864
    ds_read_b64_tr_b16 a[148:149], v11 offset:16384
    v_mfma_f32_16x16x32_bf16 v[104:107], a[140:143], v[88:91], v[104:107]
    v_exp_f32 v141, v141
    v_mfma_f32_16x16x32_bf16 v[108:111], a[140:143], v[92:95], v[108:111]
    ds_read_b64_tr_b16 a[150:151], v11 offset:20480
    v_cvt_pk_bf16_f32 v213, v138, v139
    v_mfma_f32_16x16x32_bf16 a[48:51], a[156:159], v[192:195], a[48:51]
    v_exp_f32 v142, v142
    v_mfma_f32_16x16x32_bf16 a[52:55], a[156:159], v[200:203], a[52:55]
    v_cvt_pk_bf16_f32 v220, v140, v141
    v_mfma_f32_16x16x32_bf16 a[56:59], a[156:159], v[208:211], a[56:59]
    v_exp_f32 v143, v143
    v_mfma_f32_16x16x32_bf16 a[60:63], a[156:159], v[216:219], a[60:63]
    buffer_load_dwordx4 v1, s[8:11], s38 offen offset:1024 lds
    s_waitcnt lgkmcnt(3)
    v_mfma_f32_16x16x32_bf16 v[112:115], a[128:131], v[32:35], v[160:163]
    v_exp_f32 v144, v144
    v_mfma_f32_16x16x32_bf16 v[116:119], a[128:131], v[36:39], v[164:167]
    ds_read_b128 a[136:139], v4 offset:36864
    ds_read_b64_tr_b16 a[152:153], v12 offset:16384
    v_mfma_f32_16x16x32_bf16 v[120:123], a[128:131], v[64:67], v[168:171]
    v_exp_f32 v145, v145
    v_mfma_f32_16x16x32_bf16 v[124:127], a[128:131], v[68:71], v[172:175]
    ds_read_b64_tr_b16 a[154:155], v12 offset:20480
    v_cvt_pk_bf16_f32 v221, v142, v143
    v_mfma_f32_16x16x32_bf16 a[64:67], a[144:147], v[192:195], a[64:67]
    v_exp_f32 v146, v146
    v_mfma_f32_16x16x32_bf16 a[68:71], a[144:147], v[200:203], a[68:71]
    v_cvt_pk_bf16_f32 v198, v144, v145
    v_mfma_f32_16x16x32_bf16 a[72:75], a[144:147], v[208:211], a[72:75]
    v_exp_f32 v147, v147
    v_mfma_f32_16x16x32_bf16 a[76:79], a[144:147], v[216:219], a[76:79]
    buffer_load_dwordx4 v18, s[8:11], s38 offen offset:2048 lds
    s_waitcnt lgkmcnt(3)
    v_mfma_f32_16x16x32_bf16 v[112:115], a[132:135], v[40:43], v[112:115]
    v_exp_f32 v148, v148
    v_mfma_f32_16x16x32_bf16 v[116:119], a[132:135], v[44:47], v[116:119]
    ds_read_b128 a[140:143], v5 offset:36864
    ds_read_b64_tr_b16 a[156:157], v13 offset:16384
    v_mfma_f32_16x16x32_bf16 v[120:123], a[132:135], v[72:75], v[120:123]
    v_exp_f32 v149, v149
    v_mfma_f32_16x16x32_bf16 v[124:127], a[132:135], v[76:79], v[124:127]
    ds_read_b64_tr_b16 a[158:159], v13 offset:20480
    v_cvt_pk_bf16_f32 v199, v146, v147
    v_mfma_f32_16x16x32_bf16 a[80:83], a[148:151], v[192:195], a[80:83]
    v_exp_f32 v150, v150
    v_mfma_f32_16x16x32_bf16 a[84:87], a[148:151], v[200:203], a[84:87]
    v_cvt_pk_bf16_f32 v206, v148, v149
    v_mfma_f32_16x16x32_bf16 a[88:91], a[148:151], v[208:211], a[88:91]
    v_exp_f32 v151, v151
    v_mfma_f32_16x16x32_bf16 a[92:95], a[148:151], v[216:219], a[92:95]
    buffer_load_dwordx4 v1, s[8:11], s38 offen offset:3072 lds
    s_waitcnt lgkmcnt(3)
    v_mfma_f32_16x16x32_bf16 v[112:115], a[136:139], v[48:51], v[112:115]
    v_exp_f32 v152, v152
    v_mfma_f32_16x16x32_bf16 v[116:119], a[136:139], v[52:55], v[116:119]
    ds_read_b128 a[128:131], v2 offset:40960
    ds_read_b64_tr_b16 a[144:145], v6 offset:24576
    v_mfma_f32_16x16x32_bf16 v[120:123], a[136:139], v[80:83], v[120:123]
    v_exp_f32 v153, v153
    v_mfma_f32_16x16x32_bf16 v[124:127], a[136:139], v[84:87], v[124:127]
    ds_read_b64_tr_b16 a[146:147], v6 offset:28672
    v_cvt_pk_bf16_f32 v207, v150, v151
    v_mfma_f32_16x16x32_bf16 a[96:99], a[152:155], v[192:195], a[96:99]
    v_exp_f32 v154, v154
    v_mfma_f32_16x16x32_bf16 a[100:103], a[152:155], v[200:203], a[100:103]
    v_cvt_pk_bf16_f32 v214, v152, v153
    v_mfma_f32_16x16x32_bf16 a[104:107], a[152:155], v[208:211], a[104:107]
    v_exp_f32 v155, v155
    v_mfma_f32_16x16x32_bf16 a[108:111], a[152:155], v[216:219], a[108:111]
    buffer_load_dwordx4 a[160:163], v19, s[52:55], s48 offen
    s_waitcnt lgkmcnt(3)
    v_mfma_f32_16x16x32_bf16 v[112:115], a[140:143], v[56:59], v[112:115]
    v_exp_f32 v156, v156
    v_mfma_f32_16x16x32_bf16 v[116:119], a[140:143], v[60:63], v[116:119]
    ds_read_b128 a[132:135], v3 offset:40960
    ds_read_b64_tr_b16 a[148:149], v7 offset:24576
    v_mfma_f32_16x16x32_bf16 v[120:123], a[140:143], v[88:91], v[120:123]
    v_exp_f32 v157, v157
    v_mfma_f32_16x16x32_bf16 v[124:127], a[140:143], v[92:95], v[124:127]
    ds_read_b64_tr_b16 a[150:151], v7 offset:28672
    v_cvt_pk_bf16_f32 v215, v154, v155
    v_mfma_f32_16x16x32_bf16 a[112:115], a[156:159], v[192:195], a[112:115]
    v_exp_f32 v158, v158
    v_mfma_f32_16x16x32_bf16 a[116:119], a[156:159], v[200:203], a[116:119]
    v_cvt_pk_bf16_f32 v222, v156, v157
    v_mfma_f32_16x16x32_bf16 a[120:123], a[156:159], v[208:211], a[120:123]
    v_exp_f32 v159, v159
    v_mfma_f32_16x16x32_bf16 a[124:127], a[156:159], v[216:219], a[124:127]
    buffer_load_dwordx4 a[164:167], v19, s[52:55], s48 offen offset:1024
    s_waitcnt lgkmcnt(3)
    v_mfma_f32_16x16x32_bf16 v[128:131], a[128:131], v[32:35], v[160:163]
    v_exp_f32 v96, v96
    v_mfma_f32_16x16x32_bf16 v[132:135], a[128:131], v[36:39], v[164:167]
    ds_read_b128 a[136:139], v4 offset:40960
    ds_read_b64_tr_b16 a[152:153], v8 offset:24576
    v_mfma_f32_16x16x32_bf16 v[136:139], a[128:131], v[64:67], v[168:171]
    v_exp_f32 v97, v97
    v_mfma_f32_16x16x32_bf16 v[140:143], a[128:131], v[68:71], v[172:175]
    ds_read_b64_tr_b16 a[154:155], v8 offset:28672
    v_cvt_pk_bf16_f32 v223, v158, v159
    v_smfmac_f32_16x16x64_bf16 v[176:179], v[20:23], v[192:199], v31
    v_exp_f32 v98, v98
    v_mfma_f32_16x16x32_bf16 a[0:3], a[144:147], v[196:199], a[0:3]
    v_cvt_pk_bf16_f32 v192, v96, v97
    v_mfma_f32_16x16x32_bf16 a[4:7], a[144:147], v[204:207], a[4:7]
    v_exp_f32 v99, v99
    v_mfma_f32_16x16x32_bf16 a[8:11], a[144:147], v[212:215], a[8:11]
    v_mfma_f32_16x16x32_bf16 a[12:15], a[144:147], v[220:223], a[12:15]
    s_waitcnt lgkmcnt(3)
    v_mfma_f32_16x16x32_bf16 v[128:131], a[132:135], v[40:43], v[128:131]
    v_exp_f32 v100, v100
    v_mfma_f32_16x16x32_bf16 v[132:135], a[132:135], v[44:47], v[132:135]
    ds_read_b128 a[140:143], v5 offset:40960
    ds_read_b64_tr_b16 a[156:157], v9 offset:24576
    v_mfma_f32_16x16x32_bf16 v[136:139], a[132:135], v[72:75], v[136:139]
    v_exp_f32 v101, v101
    v_mfma_f32_16x16x32_bf16 v[140:143], a[132:135], v[76:79], v[140:143]
    ds_read_b64_tr_b16 a[158:159], v9 offset:28672
    v_cvt_pk_bf16_f32 v193, v98, v99
    v_smfmac_f32_16x16x64_bf16 v[180:183], v[20:23], v[200:207], v31
    v_exp_f32 v102, v102
    v_mfma_f32_16x16x32_bf16 a[16:19], a[148:151], v[196:199], a[16:19]
    v_cvt_pk_bf16_f32 v200, v100, v101
    v_mfma_f32_16x16x32_bf16 a[20:23], a[148:151], v[204:207], a[20:23]
    v_exp_f32 v103, v103
    v_mfma_f32_16x16x32_bf16 a[24:27], a[148:151], v[212:215], a[24:27]
    v_mfma_f32_16x16x32_bf16 a[28:31], a[148:151], v[220:223], a[28:31]
    s_waitcnt lgkmcnt(3)
    v_mfma_f32_16x16x32_bf16 v[128:131], a[136:139], v[48:51], v[128:131]
    v_exp_f32 v104, v104
    v_mfma_f32_16x16x32_bf16 v[132:135], a[136:139], v[52:55], v[132:135]
    ds_read_b128 a[128:131], v2 offset:45056
    ds_read_b64_tr_b16 a[144:145], v10 offset:24576
    v_mfma_f32_16x16x32_bf16 v[136:139], a[136:139], v[80:83], v[136:139]
    v_exp_f32 v105, v105
    v_mfma_f32_16x16x32_bf16 v[140:143], a[136:139], v[84:87], v[140:143]
    ds_read_b64_tr_b16 a[146:147], v10 offset:28672
    v_cvt_pk_bf16_f32 v201, v102, v103
    v_smfmac_f32_16x16x64_bf16 v[184:187], v[20:23], v[208:215], v31
    v_exp_f32 v106, v106
    v_mfma_f32_16x16x32_bf16 a[32:35], a[152:155], v[196:199], a[32:35]
    v_cvt_pk_bf16_f32 v208, v104, v105
    v_mfma_f32_16x16x32_bf16 a[36:39], a[152:155], v[204:207], a[36:39]
    v_exp_f32 v107, v107
    v_mfma_f32_16x16x32_bf16 a[40:43], a[152:155], v[212:215], a[40:43]
    v_mfma_f32_16x16x32_bf16 a[44:47], a[152:155], v[220:223], a[44:47]
    s_waitcnt lgkmcnt(3)
    v_mfma_f32_16x16x32_bf16 v[128:131], a[140:143], v[56:59], v[128:131]
    v_exp_f32 v108, v108
    v_mfma_f32_16x16x32_bf16 v[132:135], a[140:143], v[60:63], v[132:135]
    ds_read_b128 a[132:135], v3 offset:45056
    ds_read_b64_tr_b16 a[148:149], v11 offset:24576
    v_mfma_f32_16x16x32_bf16 v[136:139], a[140:143], v[88:91], v[136:139]
    v_exp_f32 v109, v109
    v_mfma_f32_16x16x32_bf16 v[140:143], a[140:143], v[92:95], v[140:143]
    ds_read_b64_tr_b16 a[150:151], v11 offset:28672
    v_cvt_pk_bf16_f32 v209, v106, v107
    v_smfmac_f32_16x16x64_bf16 v[188:191], v[20:23], v[216:223], v31
    v_exp_f32 v110, v110
    v_mfma_f32_16x16x32_bf16 a[48:51], a[156:159], v[196:199], a[48:51]
    v_cvt_pk_bf16_f32 v216, v108, v109
    v_mfma_f32_16x16x32_bf16 a[52:55], a[156:159], v[204:207], a[52:55]
    v_exp_f32 v111, v111
    v_mfma_f32_16x16x32_bf16 a[56:59], a[156:159], v[212:215], a[56:59]
    v_mfma_f32_16x16x32_bf16 a[60:63], a[156:159], v[220:223], a[60:63]
    s_waitcnt lgkmcnt(3)
    v_mfma_f32_16x16x32_bf16 v[144:147], a[128:131], v[32:35], v[160:163]
    v_exp_f32 v112, v112
    v_mfma_f32_16x16x32_bf16 v[148:151], a[128:131], v[36:39], v[164:167]
    ds_read_b128 a[136:139], v4 offset:45056
    ds_read_b64_tr_b16 a[152:153], v12 offset:24576
    v_mfma_f32_16x16x32_bf16 v[152:155], a[128:131], v[64:67], v[168:171]
    v_exp_f32 v113, v113
    v_mfma_f32_16x16x32_bf16 v[156:159], a[128:131], v[68:71], v[172:175]
    ds_read_b64_tr_b16 a[154:155], v12 offset:28672
    v_cvt_pk_bf16_f32 v217, v110, v111
    v_mfma_f32_16x16x32_bf16 a[64:67], a[144:147], v[196:199], a[64:67]
    v_exp_f32 v114, v114
    v_mfma_f32_16x16x32_bf16 a[68:71], a[144:147], v[204:207], a[68:71]
    v_cvt_pk_bf16_f32 v194, v112, v113
    v_mfma_f32_16x16x32_bf16 a[72:75], a[144:147], v[212:215], a[72:75]
    v_exp_f32 v115, v115
    v_mfma_f32_16x16x32_bf16 a[76:79], a[144:147], v[220:223], a[76:79]
    s_waitcnt lgkmcnt(3)
    v_mfma_f32_16x16x32_bf16 v[144:147], a[132:135], v[40:43], v[144:147]
    v_exp_f32 v116, v116
    v_mfma_f32_16x16x32_bf16 v[148:151], a[132:135], v[44:47], v[148:151]
    ds_read_b128 a[140:143], v5 offset:45056
    ds_read_b64_tr_b16 a[156:157], v13 offset:24576
    v_mfma_f32_16x16x32_bf16 v[152:155], a[132:135], v[72:75], v[152:155]
    v_exp_f32 v117, v117
    v_mfma_f32_16x16x32_bf16 v[156:159], a[132:135], v[76:79], v[156:159]
    ds_read_b64_tr_b16 a[158:159], v13 offset:28672
    v_cvt_pk_bf16_f32 v195, v114, v115
    v_mfma_f32_16x16x32_bf16 a[80:83], a[148:151], v[196:199], a[80:83]
    v_exp_f32 v118, v118
    v_mfma_f32_16x16x32_bf16 a[84:87], a[148:151], v[204:207], a[84:87]
    v_cvt_pk_bf16_f32 v202, v116, v117
    v_mfma_f32_16x16x32_bf16 a[88:91], a[148:151], v[212:215], a[88:91]
    v_exp_f32 v119, v119
    v_mfma_f32_16x16x32_bf16 a[92:95], a[148:151], v[220:223], a[92:95]
    s_waitcnt lgkmcnt(3)
    v_mfma_f32_16x16x32_bf16 v[144:147], a[136:139], v[48:51], v[144:147]
    s_waitcnt vmcnt(12)
    s_barrier
    s_add_u32 s48, s48, s49
    s_min_u32 s48, s48, s50
    v_exp_f32 v120, v120
    v_mfma_f32_16x16x32_bf16 v[148:151], a[136:139], v[52:55], v[148:151]
    ds_read_b128 a[128:131], v2 offset:49152
    ds_read_b64_tr_b16 a[144:145], v6 offset:32768
    v_mfma_f32_16x16x32_bf16 v[152:155], a[136:139], v[80:83], v[152:155]
    v_exp_f32 v121, v121
    v_mfma_f32_16x16x32_bf16 v[156:159], a[136:139], v[84:87], v[156:159]
    ds_read_b64_tr_b16 a[146:147], v6 offset:36864
    v_cvt_pk_bf16_f32 v203, v118, v119
    v_mfma_f32_16x16x32_bf16 a[96:99], a[152:155], v[196:199], a[96:99]
    v_exp_f32 v122, v122
    v_mfma_f32_16x16x32_bf16 a[100:103], a[152:155], v[204:207], a[100:103]
    v_cvt_pk_bf16_f32 v210, v120, v121
    v_mfma_f32_16x16x32_bf16 a[104:107], a[152:155], v[212:215], a[104:107]
    v_exp_f32 v123, v123
    v_mfma_f32_16x16x32_bf16 a[108:111], a[152:155], v[220:223], a[108:111]
    s_add_u32 s37, s37, 16384
    s_add_u32 s38, s38, 16384
    s_add_u32 m0, s35, 16384
    s_nop 0
    buffer_load_dwordx4 v14, s[4:7], s37 offen offset:0 lds
    s_waitcnt lgkmcnt(3)
    v_mfma_f32_16x16x32_bf16 v[144:147], a[140:143], v[56:59], v[144:147]
    v_exp_f32 v124, v124
    v_mfma_f32_16x16x32_bf16 v[148:151], a[140:143], v[60:63], v[148:151]
    ds_read_b128 a[132:135], v3 offset:49152
    ds_read_b64_tr_b16 a[148:149], v7 offset:32768
    v_mfma_f32_16x16x32_bf16 v[152:155], a[140:143], v[88:91], v[152:155]
    v_exp_f32 v125, v125
    v_mfma_f32_16x16x32_bf16 v[156:159], a[140:143], v[92:95], v[156:159]
    ds_read_b64_tr_b16 a[150:151], v7 offset:36864
    v_cvt_pk_bf16_f32 v211, v122, v123
    v_mfma_f32_16x16x32_bf16 a[112:115], a[156:159], v[196:199], a[112:115]
    v_exp_f32 v126, v126
    v_mfma_f32_16x16x32_bf16 a[116:119], a[156:159], v[204:207], a[116:119]
    v_cvt_pk_bf16_f32 v218, v124, v125
    v_mfma_f32_16x16x32_bf16 a[120:123], a[156:159], v[212:215], a[120:123]
    v_exp_f32 v127, v127
    v_mfma_f32_16x16x32_bf16 a[124:127], a[156:159], v[220:223], a[124:127]
    buffer_load_dwordx4 v15, s[4:7], s37 offen offset:1024 lds
    s_waitcnt lgkmcnt(3)
    v_mfma_f32_16x16x32_bf16 v[96:99], a[128:131], v[32:35], v[160:163]
    v_exp_f32 v128, v128
    v_mfma_f32_16x16x32_bf16 v[100:103], a[128:131], v[36:39], v[164:167]
    ds_read_b128 a[136:139], v4 offset:49152
    ds_read_b64_tr_b16 a[152:153], v8 offset:32768
    v_mfma_f32_16x16x32_bf16 v[104:107], a[128:131], v[64:67], v[168:171]
    v_exp_f32 v129, v129
    v_mfma_f32_16x16x32_bf16 v[108:111], a[128:131], v[68:71], v[172:175]
    ds_read_b64_tr_b16 a[154:155], v8 offset:36864
    v_cvt_pk_bf16_f32 v219, v126, v127
    v_mfma_f32_16x16x32_bf16 a[0:3], a[144:147], v[192:195], a[0:3]
    v_exp_f32 v130, v130
    v_mfma_f32_16x16x32_bf16 a[4:7], a[144:147], v[200:203], a[4:7]
    v_cvt_pk_bf16_f32 v196, v128, v129
    v_mfma_f32_16x16x32_bf16 a[8:11], a[144:147], v[208:211], a[8:11]
    v_exp_f32 v131, v131
    v_mfma_f32_16x16x32_bf16 a[12:15], a[144:147], v[216:219], a[12:15]
    buffer_load_dwordx4 v16, s[4:7], s37 offen offset:2048 lds
    s_waitcnt lgkmcnt(3)
    v_mfma_f32_16x16x32_bf16 v[96:99], a[132:135], v[40:43], v[96:99]
    v_exp_f32 v132, v132
    v_mfma_f32_16x16x32_bf16 v[100:103], a[132:135], v[44:47], v[100:103]
    ds_read_b128 a[140:143], v5 offset:49152
    ds_read_b64_tr_b16 a[156:157], v9 offset:32768
    v_mfma_f32_16x16x32_bf16 v[104:107], a[132:135], v[72:75], v[104:107]
    v_exp_f32 v133, v133
    v_mfma_f32_16x16x32_bf16 v[108:111], a[132:135], v[76:79], v[108:111]
    ds_read_b64_tr_b16 a[158:159], v9 offset:36864
    v_cvt_pk_bf16_f32 v197, v130, v131
    v_mfma_f32_16x16x32_bf16 a[16:19], a[148:151], v[192:195], a[16:19]
    v_exp_f32 v134, v134
    v_mfma_f32_16x16x32_bf16 a[20:23], a[148:151], v[200:203], a[20:23]
    v_cvt_pk_bf16_f32 v204, v132, v133
    v_mfma_f32_16x16x32_bf16 a[24:27], a[148:151], v[208:211], a[24:27]
    v_exp_f32 v135, v135
    v_mfma_f32_16x16x32_bf16 a[28:31], a[148:151], v[216:219], a[28:31]
    buffer_load_dwordx4 v17, s[4:7], s37 offen offset:3072 lds
    s_waitcnt lgkmcnt(3)
    v_mfma_f32_16x16x32_bf16 v[96:99], a[136:139], v[48:51], v[96:99]
    v_exp_f32 v136, v136
    v_mfma_f32_16x16x32_bf16 v[100:103], a[136:139], v[52:55], v[100:103]
    ds_read_b128 a[128:131], v2 offset:53248
    ds_read_b64_tr_b16 a[144:145], v10 offset:32768
    v_mfma_f32_16x16x32_bf16 v[104:107], a[136:139], v[80:83], v[104:107]
    v_exp_f32 v137, v137
    v_mfma_f32_16x16x32_bf16 v[108:111], a[136:139], v[84:87], v[108:111]
    ds_read_b64_tr_b16 a[146:147], v10 offset:36864
    v_cvt_pk_bf16_f32 v205, v134, v135
    v_mfma_f32_16x16x32_bf16 a[32:35], a[152:155], v[192:195], a[32:35]
    v_exp_f32 v138, v138
    v_mfma_f32_16x16x32_bf16 a[36:39], a[152:155], v[200:203], a[36:39]
    v_cvt_pk_bf16_f32 v212, v136, v137
    v_mfma_f32_16x16x32_bf16 a[40:43], a[152:155], v[208:211], a[40:43]
    v_exp_f32 v139, v139
    v_mfma_f32_16x16x32_bf16 a[44:47], a[152:155], v[216:219], a[44:47]
    s_add_u32 m0, s35, 65536
    s_nop 0
    buffer_load_dwordx4 v18, s[8:11], s38 offen offset:0 lds
    s_waitcnt lgkmcnt(3)
    v_mfma_f32_16x16x32_bf16 v[96:99], a[140:143], v[56:59], v[96:99]
    v_exp_f32 v140, v140
    v_mfma_f32_16x16x32_bf16 v[100:103], a[140:143], v[60:63], v[100:103]
    ds_read_b128 a[132:135], v3 offset:53248
    ds_read_b64_tr_b16 a[148:149], v11 offset:32768
    v_mfma_f32_16x16x32_bf16 v[104:107], a[140:143], v[88:91], v[104:107]
    v_exp_f32 v141, v141
    v_mfma_f32_16x16x32_bf16 v[108:111], a[140:143], v[92:95], v[108:111]
    ds_read_b64_tr_b16 a[150:151], v11 offset:36864
    v_cvt_pk_bf16_f32 v213, v138, v139
    v_mfma_f32_16x16x32_bf16 a[48:51], a[156:159], v[192:195], a[48:51]
    v_exp_f32 v142, v142
    v_mfma_f32_16x16x32_bf16 a[52:55], a[156:159], v[200:203], a[52:55]
    v_cvt_pk_bf16_f32 v220, v140, v141
    v_mfma_f32_16x16x32_bf16 a[56:59], a[156:159], v[208:211], a[56:59]
    v_exp_f32 v143, v143
    v_mfma_f32_16x16x32_bf16 a[60:63], a[156:159], v[216:219], a[60:63]
    buffer_load_dwordx4 v1, s[8:11], s38 offen offset:1024 lds
    s_waitcnt lgkmcnt(3)
    v_mfma_f32_16x16x32_bf16 v[112:115], a[128:131], v[32:35], v[160:163]
    v_exp_f32 v144, v144
    v_mfma_f32_16x16x32_bf16 v[116:119], a[128:131], v[36:39], v[164:167]
    ds_read_b128 a[136:139], v4 offset:53248
    ds_read_b64_tr_b16 a[152:153], v12 offset:32768
    v_mfma_f32_16x16x32_bf16 v[120:123], a[128:131], v[64:67], v[168:171]
    v_exp_f32 v145, v145
    v_mfma_f32_16x16x32_bf16 v[124:127], a[128:131], v[68:71], v[172:175]
    ds_read_b64_tr_b16 a[154:155], v12 offset:36864
    v_cvt_pk_bf16_f32 v221, v142, v143
    v_mfma_f32_16x16x32_bf16 a[64:67], a[144:147], v[192:195], a[64:67]
    v_exp_f32 v146, v146
    v_mfma_f32_16x16x32_bf16 a[68:71], a[144:147], v[200:203], a[68:71]
    v_cvt_pk_bf16_f32 v198, v144, v145
    v_mfma_f32_16x16x32_bf16 a[72:75], a[144:147], v[208:211], a[72:75]
    v_exp_f32 v147, v147
    v_mfma_f32_16x16x32_bf16 a[76:79], a[144:147], v[216:219], a[76:79]
    buffer_load_dwordx4 v18, s[8:11], s38 offen offset:2048 lds
    s_waitcnt lgkmcnt(3)
    v_mfma_f32_16x16x32_bf16 v[112:115], a[132:135], v[40:43], v[112:115]
    v_exp_f32 v148, v148
    v_mfma_f32_16x16x32_bf16 v[116:119], a[132:135], v[44:47], v[116:119]
    ds_read_b128 a[140:143], v5 offset:53248
    ds_read_b64_tr_b16 a[156:157], v13 offset:32768
    v_mfma_f32_16x16x32_bf16 v[120:123], a[132:135], v[72:75], v[120:123]
    v_exp_f32 v149, v149
    v_mfma_f32_16x16x32_bf16 v[124:127], a[132:135], v[76:79], v[124:127]
    ds_read_b64_tr_b16 a[158:159], v13 offset:36864
    v_cvt_pk_bf16_f32 v199, v146, v147
    v_mfma_f32_16x16x32_bf16 a[80:83], a[148:151], v[192:195], a[80:83]
    v_exp_f32 v150, v150
    v_mfma_f32_16x16x32_bf16 a[84:87], a[148:151], v[200:203], a[84:87]
    v_cvt_pk_bf16_f32 v206, v148, v149
    v_mfma_f32_16x16x32_bf16 a[88:91], a[148:151], v[208:211], a[88:91]
    v_exp_f32 v151, v151
    v_mfma_f32_16x16x32_bf16 a[92:95], a[148:151], v[216:219], a[92:95]
    buffer_load_dwordx4 v1, s[8:11], s38 offen offset:3072 lds
    s_waitcnt lgkmcnt(3)
    v_mfma_f32_16x16x32_bf16 v[112:115], a[136:139], v[48:51], v[112:115]
    v_exp_f32 v152, v152
    v_mfma_f32_16x16x32_bf16 v[116:119], a[136:139], v[52:55], v[116:119]
    ds_read_b128 a[128:131], v2 offset:57344
    ds_read_b64_tr_b16 a[144:145], v6 offset:40960
    v_mfma_f32_16x16x32_bf16 v[120:123], a[136:139], v[80:83], v[120:123]
    v_exp_f32 v153, v153
    v_mfma_f32_16x16x32_bf16 v[124:127], a[136:139], v[84:87], v[124:127]
    ds_read_b64_tr_b16 a[146:147], v6 offset:45056
    v_cvt_pk_bf16_f32 v207, v150, v151
    v_mfma_f32_16x16x32_bf16 a[96:99], a[152:155], v[192:195], a[96:99]
    v_exp_f32 v154, v154
    v_mfma_f32_16x16x32_bf16 a[100:103], a[152:155], v[200:203], a[100:103]
    v_cvt_pk_bf16_f32 v214, v152, v153
    v_mfma_f32_16x16x32_bf16 a[104:107], a[152:155], v[208:211], a[104:107]
    v_exp_f32 v155, v155
    v_mfma_f32_16x16x32_bf16 a[108:111], a[152:155], v[216:219], a[108:111]
    buffer_store_dwordx4 a[252:255], v19, s[64:67], s68 offen offset:0 sc1
    s_waitcnt lgkmcnt(3)
    v_mfma_f32_16x16x32_bf16 v[112:115], a[140:143], v[56:59], v[112:115]
    v_exp_f32 v156, v156
    v_mfma_f32_16x16x32_bf16 v[116:119], a[140:143], v[60:63], v[116:119]
    ds_read_b128 a[132:135], v3 offset:57344
    ds_read_b64_tr_b16 a[148:149], v7 offset:40960
    v_mfma_f32_16x16x32_bf16 v[120:123], a[140:143], v[88:91], v[120:123]
    v_exp_f32 v157, v157
    v_mfma_f32_16x16x32_bf16 v[124:127], a[140:143], v[92:95], v[124:127]
    ds_read_b64_tr_b16 a[150:151], v7 offset:45056
    v_cvt_pk_bf16_f32 v215, v154, v155
    v_mfma_f32_16x16x32_bf16 a[112:115], a[156:159], v[192:195], a[112:115]
    v_exp_f32 v158, v158
    v_mfma_f32_16x16x32_bf16 a[116:119], a[156:159], v[200:203], a[116:119]
    v_cvt_pk_bf16_f32 v222, v156, v157
    v_mfma_f32_16x16x32_bf16 a[120:123], a[156:159], v[208:211], a[120:123]
    v_exp_f32 v159, v159
    v_mfma_f32_16x16x32_bf16 a[124:127], a[156:159], v[216:219], a[124:127]
    buffer_store_dwordx4 a[252:255], v19, s[64:67], s68 offen offset:1024 sc1
    s_waitcnt lgkmcnt(3)
    v_mfma_f32_16x16x32_bf16 v[128:131], a[128:131], v[32:35], v[160:163]
    v_exp_f32 v96, v96
    v_mfma_f32_16x16x32_bf16 v[132:135], a[128:131], v[36:39], v[164:167]
    ds_read_b128 a[136:139], v4 offset:57344
    ds_read_b64_tr_b16 a[152:153], v8 offset:40960
    v_mfma_f32_16x16x32_bf16 v[136:139], a[128:131], v[64:67], v[168:171]
    v_exp_f32 v97, v97
    v_mfma_f32_16x16x32_bf16 v[140:143], a[128:131], v[68:71], v[172:175]
    ds_read_b64_tr_b16 a[154:155], v8 offset:45056
    v_cvt_pk_bf16_f32 v223, v158, v159
    v_smfmac_f32_16x16x64_bf16 v[176:179], v[20:23], v[192:199], v31
    v_exp_f32 v98, v98
    v_mfma_f32_16x16x32_bf16 a[0:3], a[144:147], v[196:199], a[0:3]
    v_cvt_pk_bf16_f32 v192, v96, v97
    v_mfma_f32_16x16x32_bf16 a[4:7], a[144:147], v[204:207], a[4:7]
    v_exp_f32 v99, v99
    v_mfma_f32_16x16x32_bf16 a[8:11], a[144:147], v[212:215], a[8:11]
    buffer_store_dwordx4 a[252:255], v19, s[64:67], s68 offen offset:2048 sc1
    v_mfma_f32_16x16x32_bf16 a[12:15], a[144:147], v[220:223], a[12:15]
    s_waitcnt lgkmcnt(3)
    v_mfma_f32_16x16x32_bf16 v[128:131], a[132:135], v[40:43], v[128:131]
    v_exp_f32 v100, v100
    v_mfma_f32_16x16x32_bf16 v[132:135], a[132:135], v[44:47], v[132:135]
    ds_read_b128 a[140:143], v5 offset:57344
    ds_read_b64_tr_b16 a[156:157], v9 offset:40960
    v_mfma_f32_16x16x32_bf16 v[136:139], a[132:135], v[72:75], v[136:139]
    v_exp_f32 v101, v101
    v_mfma_f32_16x16x32_bf16 v[140:143], a[132:135], v[76:79], v[140:143]
    ds_read_b64_tr_b16 a[158:159], v9 offset:45056
    v_cvt_pk_bf16_f32 v193, v98, v99
    v_smfmac_f32_16x16x64_bf16 v[180:183], v[20:23], v[200:207], v31
    v_exp_f32 v102, v102
    v_mfma_f32_16x16x32_bf16 a[16:19], a[148:151], v[196:199], a[16:19]
    v_cvt_pk_bf16_f32 v200, v100, v101
    v_mfma_f32_16x16x32_bf16 a[20:23], a[148:151], v[204:207], a[20:23]
    v_exp_f32 v103, v103
    v_mfma_f32_16x16x32_bf16 a[24:27], a[148:151], v[212:215], a[24:27]
    buffer_store_dwordx4 a[252:255], v19, s[64:67], s68 offen offset:3072 sc1
    v_mfma_f32_16x16x32_bf16 a[28:31], a[148:151], v[220:223], a[28:31]
    s_waitcnt lgkmcnt(3)
    v_mfma_f32_16x16x32_bf16 v[128:131], a[136:139], v[48:51], v[128:131]
    v_exp_f32 v104, v104
    v_mfma_f32_16x16x32_bf16 v[132:135], a[136:139], v[52:55], v[132:135]
    ds_read_b128 a[128:131], v2 offset:61440
    ds_read_b64_tr_b16 a[144:145], v10 offset:40960
    v_mfma_f32_16x16x32_bf16 v[136:139], a[136:139], v[80:83], v[136:139]
    v_exp_f32 v105, v105
    v_mfma_f32_16x16x32_bf16 v[140:143], a[136:139], v[84:87], v[140:143]
    ds_read_b64_tr_b16 a[146:147], v10 offset:45056
    v_cvt_pk_bf16_f32 v201, v102, v103
    v_smfmac_f32_16x16x64_bf16 v[184:187], v[20:23], v[208:215], v31
    v_exp_f32 v106, v106
    v_mfma_f32_16x16x32_bf16 a[32:35], a[152:155], v[196:199], a[32:35]
    v_cvt_pk_bf16_f32 v208, v104, v105
    v_mfma_f32_16x16x32_bf16 a[36:39], a[152:155], v[204:207], a[36:39]
    v_exp_f32 v107, v107
    v_mfma_f32_16x16x32_bf16 a[40:43], a[152:155], v[212:215], a[40:43]
    v_mfma_f32_16x16x32_bf16 a[44:47], a[152:155], v[220:223], a[44:47]
    s_waitcnt lgkmcnt(3)
    v_mfma_f32_16x16x32_bf16 v[128:131], a[140:143], v[56:59], v[128:131]
    v_exp_f32 v108, v108
    v_mfma_f32_16x16x32_bf16 v[132:135], a[140:143], v[60:63], v[132:135]
    ds_read_b128 a[132:135], v3 offset:61440
    ds_read_b64_tr_b16 a[148:149], v11 offset:40960
    v_mfma_f32_16x16x32_bf16 v[136:139], a[140:143], v[88:91], v[136:139]
    v_exp_f32 v109, v109
    v_mfma_f32_16x16x32_bf16 v[140:143], a[140:143], v[92:95], v[140:143]
    ds_read_b64_tr_b16 a[150:151], v11 offset:45056
    v_cvt_pk_bf16_f32 v209, v106, v107
    v_smfmac_f32_16x16x64_bf16 v[188:191], v[20:23], v[216:223], v31
    v_exp_f32 v110, v110
    v_mfma_f32_16x16x32_bf16 a[48:51], a[156:159], v[196:199], a[48:51]
    v_cvt_pk_bf16_f32 v216, v108, v109
    v_mfma_f32_16x16x32_bf16 a[52:55], a[156:159], v[204:207], a[52:55]
    v_exp_f32 v111, v111
    v_mfma_f32_16x16x32_bf16 a[56:59], a[156:159], v[212:215], a[56:59]
    v_mfma_f32_16x16x32_bf16 a[60:63], a[156:159], v[220:223], a[60:63]
    s_waitcnt lgkmcnt(3)
    v_mfma_f32_16x16x32_bf16 v[144:147], a[128:131], v[32:35], v[160:163]
    v_exp_f32 v112, v112
    v_mfma_f32_16x16x32_bf16 v[148:151], a[128:131], v[36:39], v[164:167]
    ds_read_b128 a[136:139], v4 offset:61440
    ds_read_b64_tr_b16 a[152:153], v12 offset:40960
    v_mfma_f32_16x16x32_bf16 v[152:155], a[128:131], v[64:67], v[168:171]
    v_exp_f32 v113, v113
    v_mfma_f32_16x16x32_bf16 v[156:159], a[128:131], v[68:71], v[172:175]
    ds_read_b64_tr_b16 a[154:155], v12 offset:45056
    v_cvt_pk_bf16_f32 v217, v110, v111
    v_mfma_f32_16x16x32_bf16 a[64:67], a[144:147], v[196:199], a[64:67]
    v_exp_f32 v114, v114
    v_mfma_f32_16x16x32_bf16 a[68:71], a[144:147], v[204:207], a[68:71]
    v_cvt_pk_bf16_f32 v194, v112, v113
    v_mfma_f32_16x16x32_bf16 a[72:75], a[144:147], v[212:215], a[72:75]
    v_exp_f32 v115, v115
    v_mfma_f32_16x16x32_bf16 a[76:79], a[144:147], v[220:223], a[76:79]
    s_waitcnt lgkmcnt(3)
    v_mfma_f32_16x16x32_bf16 v[144:147], a[132:135], v[40:43], v[144:147]
    v_exp_f32 v116, v116
    v_mfma_f32_16x16x32_bf16 v[148:151], a[132:135], v[44:47], v[148:151]
    ds_read_b128 a[140:143], v5 offset:61440
    ds_read_b64_tr_b16 a[156:157], v13 offset:40960
    v_mfma_f32_16x16x32_bf16 v[152:155], a[132:135], v[72:75], v[152:155]
    v_exp_f32 v117, v117
    v_mfma_f32_16x16x32_bf16 v[156:159], a[132:135], v[76:79], v[156:159]
    ds_read_b64_tr_b16 a[158:159], v13 offset:45056
    v_cvt_pk_bf16_f32 v195, v114, v115
    v_mfma_f32_16x16x32_bf16 a[80:83], a[148:151], v[196:199], a[80:83]
    v_exp_f32 v118, v118
    v_mfma_f32_16x16x32_bf16 a[84:87], a[148:151], v[204:207], a[84:87]
    v_cvt_pk_bf16_f32 v202, v116, v117
    v_mfma_f32_16x16x32_bf16 a[88:91], a[148:151], v[212:215], a[88:91]
    v_exp_f32 v119, v119
    v_mfma_f32_16x16x32_bf16 a[92:95], a[148:151], v[220:223], a[92:95]
    s_waitcnt lgkmcnt(3)
    v_mfma_f32_16x16x32_bf16 v[144:147], a[136:139], v[48:51], v[144:147]
    s_waitcnt vmcnt(14)
    s_cmp_lg_u32 s39, 3
    s_cbranch_scc1 drain_skip1
    s_waitcnt vmcnt(0)
drain_skip1:
    s_barrier
    s_cmp_lg_u32 s39, s95
    s_cbranch_scc1 pub_skip2
    s_and_b32 s3, s33, 3
    s_lshl_b32 s3, s3, 6
    v_mov_b32 v24, s3
    v_and_or_b32 v24, s33, 4, v24
    v_mov_b32 v25, 1
    s_mov_b64 exec, 1
    global_atomic_add v24, v25, s[62:63]
    s_mov_b64 exec, -1
pub_skip2:
    s_add_u32 s68, s68, 4096
    v_exp_f32 v120, v120
    v_mfma_f32_16x16x32_bf16 v[148:151], a[136:139], v[52:55], v[148:151]
    ds_read_b128 a[128:131], v2 offset:0
    ds_read_b64_tr_b16 a[144:145], v6 offset:49152
    v_mfma_f32_16x16x32_bf16 v[152:155], a[136:139], v[80:83], v[152:155]
    v_exp_f32 v121, v121
    v_mfma_f32_16x16x32_bf16 v[156:159], a[136:139], v[84:87], v[156:159]
    ds_read_b64_tr_b16 a[146:147], v6 offset:53248
    v_cvt_pk_bf16_f32 v203, v118, v119
    v_mfma_f32_16x16x32_bf16 a[96:99], a[152:155], v[196:199], a[96:99]
    v_exp_f32 v122, v122
    v_mfma_f32_16x16x32_bf16 a[100:103], a[152:155], v[204:207], a[100:103]
    v_cvt_pk_bf16_f32 v210, v120, v121
    v_mfma_f32_16x16x32_bf16 a[104:107], a[152:155], v[212:215], a[104:107]
    v_exp_f32 v123, v123
    v_mfma_f32_16x16x32_bf16 a[108:111], a[152:155], v[220:223], a[108:111]
    s_add_u32 s37, s37, 16384
    s_add_u32 s38, s38, 16384
    s_add_u32 m0, s35, 32768
    s_nop 0
    buffer_load_dwordx4 v14, s[4:7], s37 offen offset:0 lds
    s_waitcnt lgkmcnt(3)
    v_mfma_f32_16x16x32_bf16 v[144:147], a[140:143], v[56:59], v[144:147]
    v_exp_f32 v124, v124
    v_mfma_f32_16x16x32_bf16 v[148:151], a[140:143], v[60:63], v[148:151]
    ds_read_b128 a[132:135], v3 offset:0
    ds_read_b64_tr_b16 a[148:149], v7 offset:49152
    v_mfma_f32_16x16x32_bf16 v[152:155], a[140:143], v[88:91], v[152:155]
    v_exp_f32 v125, v125
    v_mfma_f32_16x16x32_bf16 v[156:159], a[140:143], v[92:95], v[156:159]
    ds_read_b64_tr_b16 a[150:151], v7 offset:53248
    v_cvt_pk_bf16_f32 v211, v122, v123
    v_mfma_f32_16x16x32_bf16 a[112:115], a[156:159], v[196:199], a[112:115]
    v_exp_f32 v126, v126
wpad6:
    s_cmp_eq_u32 s98, 1
    s_cbranch_scc1 WARMA_done
    v_mfma_f32_16x16x32_bf16 a[116:119], a[156:159], v[204:207], a[116:119]
    v_cvt_pk_bf16_f32 v218, v124, v125
    v_mfma_f32_16x16x32_bf16 a[120:123], a[156:159], v[212:215], a[120:123]
    v_exp_f32 v127, v127
    v_mfma_f32_16x16x32_bf16 a[124:127], a[156:159], v[220:223], a[124:127]
    buffer_load_dwordx4 v15, s[4:7], s37 offen offset:1024 lds
    s_waitcnt lgkmcnt(3)
    v_mfma_f32_16x16x32_bf16 v[96:99], a[128:131], v[32:35], v[160:163]
    v_exp_f32 v128, v128
    v_mfma_f32_16x16x32_bf16 v[100:103], a[128:131], v[36:39], v[164:167]
    ds_read_b128 a[136:139], v4 offset:0
    ds_read_b64_tr_b16 a[152:153], v8 offset:49152
    v_mfma_f32_16x16x32_bf16 v[104:107], a[128:131], v[64:67], v[168:171]
    v_exp_f32 v129, v129
    v_mfma_f32_16x16x32_bf16 v[108:111], a[128:131], v[68:71], v[172:175]
    ds_read_b64_tr_b16 a[154:155], v8 offset:53248
    v_cvt_pk_bf16_f32 v219, v126, v127
    v_mfma_f32_16x16x32_bf16 a[0:3], a[144:147], v[192:195], a[0:3]
    v_exp_f32 v130, v130
    v_mfma_f32_16x16x32_bf16 a[4:7], a[144:147], v[200:203], a[4:7]
    v_cvt_pk_bf16_f32 v196, v128, v129
    v_mfma_f32_16x16x32_bf16 a[8:11], a[144:147], v[208:211], a[8:11]
    v_exp_f32 v131, v131
    v_mfma_f32_16x16x32_bf16 a[12:15], a[144:147], v[216:219], a[12:15]
    buffer_load_dwordx4 v16, s[4:7], s37 offen offset:2048 lds
    s_waitcnt lgkmcnt(3)
    v_mfma_f32_16x16x32_bf16 v[96:99], a[132:135], v[40:43], v[96:99]
    v_exp_f32 v132, v132
    v_mfma_f32_16x16x32_bf16 v[100:103], a[132:135], v[44:47], v[100:103]
    ds_read_b128 a[140:143], v5 offset:0
    ds_read_b64_tr_b16 a[156:157], v9 offset:49152
    v_mfma_f32_16x16x32_bf16 v[104:107], a[132:135], v[72:75], v[104:107]
    v_exp_f32 v133, v133
    v_mfma_f32_16x16x32_bf16 v[108:111], a[132:135], v[76:79], v[108:111]
    ds_read_b64_tr_b16 a[158:159], v9 offset:53248
    v_cvt_pk_bf16_f32 v197, v130, v131
    v_mfma_f32_16x16x32_bf16 a[16:19], a[148:151], v[192:195], a[16:19]
    v_exp_f32 v134, v134
    v_mfma_f32_16x16x32_bf16 a[20:23], a[148:151], v[200:203], a[20:23]
    v_cvt_pk_bf16_f32 v204, v132, v133
    v_mfma_f32_16x16x32_bf16 a[24:27], a[148:151], v[208:211], a[24:27]
    v_exp_f32 v135, v135
    v_mfma_f32_16x16x32_bf16 a[28:31], a[148:151], v[216:219], a[28:31]
    buffer_load_dwordx4 v17, s[4:7], s37 offen offset:3072 lds
    s_waitcnt lgkmcnt(3)
    v_mfma_f32_16x16x32_bf16 v[96:99], a[136:139], v[48:51], v[96:99]
    v_exp_f32 v136, v136
    v_mfma_f32_16x16x32_bf16 v[100:103], a[136:139], v[52:55], v[100:103]
    ds_read_b128 a[128:131], v2 offset:4096
    ds_read_b64_tr_b16 a[144:145], v10 offset:49152
    v_mfma_f32_16x16x32_bf16 v[104:107], a[136:139], v[80:83], v[104:107]
    v_exp_f32 v137, v137
    v_mfma_f32_16x16x32_bf16 v[108:111], a[136:139], v[84:87], v[108:111]
    ds_read_b64_tr_b16 a[146:147], v10 offset:53248
    v_cvt_pk_bf16_f32 v205, v134, v135
    v_mfma_f32_16x16x32_bf16 a[32:35], a[152:155], v[192:195], a[32:35]
    v_exp_f32 v138, v138
    v_mfma_f32_16x16x32_bf16 a[36:39], a[152:155], v[200:203], a[36:39]
    v_cvt_pk_bf16_f32 v212, v136, v137
    v_mfma_f32_16x16x32_bf16 a[40:43], a[152:155], v[208:211], a[40:43]
    v_exp_f32 v139, v139
    v_mfma_f32_16x16x32_bf16 a[44:47], a[152:155], v[216:219], a[44:47]
    s_add_u32 m0, s35, 81920
    s_nop 0
    buffer_load_dwordx4 v18, s[8:11], s38 offen offset:0 lds
    s_waitcnt lgkmcnt(3)
    v_mfma_f32_16x16x32_bf16 v[96:99], a[140:143], v[56:59], v[96:99]
    v_exp_f32 v140, v140
    v_mfma_f32_16x16x32_bf16 v[100:103], a[140:143], v[60:63], v[100:103]
    ds_read_b128 a[132:135], v3 offset:4096
    ds_read_b64_tr_b16 a[148:149], v11 offset:49152
    v_mfma_f32_16x16x32_bf16 v[104:107], a[140:143], v[88:91], v[104:107]
    v_exp_f32 v141, v141
    v_mfma_f32_16x16x32_bf16 v[108:111], a[140:143], v[92:95], v[108:111]
    ds_read_b64_tr_b16 a[150:151], v11 offset:53248
    v_cvt_pk_bf16_f32 v213, v138, v139
    v_mfma_f32_16x16x32_bf16 a[48:51], a[156:159], v[192:195], a[48:51]
    v_exp_f32 v142, v142
    v_mfma_f32_16x16x32_bf16 a[52:55], a[156:159], v[200:203], a[52:55]
    v_cvt_pk_bf16_f32 v220, v140, v141
    v_mfma_f32_16x16x32_bf16 a[56:59], a[156:159], v[208:211], a[56:59]
    v_exp_f32 v143, v143
    v_mfma_f32_16x16x32_bf16 a[60:63], a[156:159], v[216:219], a[60:63]
    buffer_load_dwordx4 v1, s[8:11], s38 offen offset:1024 lds
    s_waitcnt lgkmcnt(3)
    v_mfma_f32_16x16x32_bf16 v[112:115], a[128:131], v[32:35], v[160:163]
    v_exp_f32 v144, v144
    v_mfma_f32_16x16x32_bf16 v[116:119], a[128:131], v[36:39], v[164:167]
    ds_read_b128 a[136:139], v4 offset:4096
    ds_read_b64_tr_b16 a[152:153], v12 offset:49152
    v_mfma_f32_16x16x32_bf16 v[120:123], a[128:131], v[64:67], v[168:171]
    v_exp_f32 v145, v145
    v_mfma_f32_16x16x32_bf16 v[124:127], a[128:131], v[68:71], v[172:175]
    ds_read_b64_tr_b16 a[154:155], v12 offset:53248
    v_cvt_pk_bf16_f32 v221, v142, v143
    v_mfma_f32_16x16x32_bf16 a[64:67], a[144:147], v[192:195], a[64:67]
    v_exp_f32 v146, v146
    v_mfma_f32_16x16x32_bf16 a[68:71], a[144:147], v[200:203], a[68:71]
    v_cvt_pk_bf16_f32 v198, v144, v145
    v_mfma_f32_16x16x32_bf16 a[72:75], a[144:147], v[208:211], a[72:75]
    v_exp_f32 v147, v147
    v_mfma_f32_16x16x32_bf16 a[76:79], a[144:147], v[216:219], a[76:79]
    buffer_load_dwordx4 v18, s[8:11], s38 offen offset:2048 lds
    s_waitcnt lgkmcnt(3)
    v_mfma_f32_16x16x32_bf16 v[112:115], a[132:135], v[40:43], v[112:115]
    v_exp_f32 v148, v148
    v_mfma_f32_16x16x32_bf16 v[116:119], a[132:135], v[44:47], v[116:119]
    ds_read_b128 a[140:143], v5 offset:4096
    ds_read_b64_tr_b16 a[156:157], v13 offset:49152
    v_mfma_f32_16x16x32_bf16 v[120:123], a[132:135], v[72:75], v[120:123]
    v_exp_f32 v149, v149
    v_mfma_f32_16x16x32_bf16 v[124:127], a[132:135], v[76:79], v[124:127]
    ds_read_b64_tr_b16 a[158:159], v13 offset:53248
    v_cvt_pk_bf16_f32 v199, v146, v147
    v_mfma_f32_16x16x32_bf16 a[80:83], a[148:151], v[192:195], a[80:83]
    v_exp_f32 v150, v150
    v_mfma_f32_16x16x32_bf16 a[84:87], a[148:151], v[200:203], a[84:87]
    v_cvt_pk_bf16_f32 v206, v148, v149
    v_mfma_f32_16x16x32_bf16 a[88:91], a[148:151], v[208:211], a[88:91]
    v_exp_f32 v151, v151
    v_mfma_f32_16x16x32_bf16 a[92:95], a[148:151], v[216:219], a[92:95]
    buffer_load_dwordx4 v1, s[8:11], s38 offen offset:3072 lds
    s_waitcnt lgkmcnt(3)
    v_mfma_f32_16x16x32_bf16 v[112:115], a[136:139], v[48:51], v[112:115]
    v_exp_f32 v152, v152
    v_mfma_f32_16x16x32_bf16 v[116:119], a[136:139], v[52:55], v[116:119]
    ds_read_b128 a[128:131], v2 offset:8192
    ds_read_b64_tr_b16 a[144:145], v6 offset:57344
    v_mfma_f32_16x16x32_bf16 v[120:123], a[136:139], v[80:83], v[120:123]
    v_exp_f32 v153, v153
    v_mfma_f32_16x16x32_bf16 v[124:127], a[136:139], v[84:87], v[124:127]
    ds_read_b64_tr_b16 a[146:147], v6 offset:61440
    v_cvt_pk_bf16_f32 v207, v150, v151
    v_mfma_f32_16x16x32_bf16 a[96:99], a[152:155], v[192:195], a[96:99]
    v_exp_f32 v154, v154
    v_mfma_f32_16x16x32_bf16 a[100:103], a[152:155], v[200:203], a[100:103]
    v_cvt_pk_bf16_f32 v214, v152, v153
    v_mfma_f32_16x16x32_bf16 a[104:107], a[152:155], v[208:211], a[104:107]
    v_exp_f32 v155, v155
    v_mfma_f32_16x16x32_bf16 a[108:111], a[152:155], v[216:219], a[108:111]
    s_waitcnt lgkmcnt(3)
    v_mfma_f32_16x16x32_bf16 v[112:115], a[140:143], v[56:59], v[112:115]
    v_exp_f32 v156, v156
    v_mfma_f32_16x16x32_bf16 v[116:119], a[140:143], v[60:63], v[116:119]
    ds_read_b128 a[132:135], v3 offset:8192
    ds_read_b64_tr_b16 a[148:149], v7 offset:57344
    v_mfma_f32_16x16x32_bf16 v[120:123], a[140:143], v[88:91], v[120:123]
    v_exp_f32 v157, v157
    v_mfma_f32_16x16x32_bf16 v[124:127], a[140:143], v[92:95], v[124:127]
    ds_read_b64_tr_b16 a[150:151], v7 offset:61440
    v_cvt_pk_bf16_f32 v215, v154, v155
    v_mfma_f32_16x16x32_bf16 a[112:115], a[156:159], v[192:195], a[112:115]
    v_exp_f32 v158, v158
    v_mfma_f32_16x16x32_bf16 a[116:119], a[156:159], v[200:203], a[116:119]
    v_cvt_pk_bf16_f32 v222, v156, v157
    v_mfma_f32_16x16x32_bf16 a[120:123], a[156:159], v[208:211], a[120:123]
    v_exp_f32 v159, v159
    v_mfma_f32_16x16x32_bf16 a[124:127], a[156:159], v[216:219], a[124:127]
    s_waitcnt lgkmcnt(3)
    v_mfma_f32_16x16x32_bf16 v[128:131], a[128:131], v[32:35], v[160:163]
    v_exp_f32 v96, v96
    v_mfma_f32_16x16x32_bf16 v[132:135], a[128:131], v[36:39], v[164:167]
    ds_read_b128 a[136:139], v4 offset:8192
    ds_read_b64_tr_b16 a[152:153], v8 offset:57344
    v_mfma_f32_16x16x32_bf16 v[136:139], a[128:131], v[64:67], v[168:171]
    v_exp_f32 v97, v97
    v_mfma_f32_16x16x32_bf16 v[140:143], a[128:131], v[68:71], v[172:175]
    ds_read_b64_tr_b16 a[154:155], v8 offset:61440
    v_cvt_pk_bf16_f32 v223, v158, v159
    v_smfmac_f32_16x16x64_bf16 v[176:179], v[20:23], v[192:199], v31
    v_exp_f32 v98, v98
    v_mfma_f32_16x16x32_bf16 a[0:3], a[144:147], v[196:199], a[0:3]
    v_cvt_pk_bf16_f32 v192, v96, v97
    v_mfma_f32_16x16x32_bf16 a[4:7], a[144:147], v[204:207], a[4:7]
    v_exp_f32 v99, v99
    v_mfma_f32_16x16x32_bf16 a[8:11], a[144:147], v[212:215], a[8:11]
    v_mfma_f32_16x16x32_bf16 a[12:15], a[144:147], v[220:223], a[12:15]
    s_waitcnt lgkmcnt(3)
    v_mfma_f32_16x16x32_bf16 v[128:131], a[132:135], v[40:43], v[128:131]
    v_exp_f32 v100, v100
    v_mfma_f32_16x16x32_bf16 v[132:135], a[132:135], v[44:47], v[132:135]
    ds_read_b128 a[140:143], v5 offset:8192
    ds_read_b64_tr_b16 a[156:157], v9 offset:57344
    v_mfma_f32_16x16x32_bf16 v[136:139], a[132:135], v[72:75], v[136:139]
    v_exp_f32 v101, v101
    v_mfma_f32_16x16x32_bf16 v[140:143], a[132:135], v[76:79], v[140:143]
    ds_read_b64_tr_b16 a[158:159], v9 offset:61440
    v_cvt_pk_bf16_f32 v193, v98, v99
    v_smfmac_f32_16x16x64_bf16 v[180:183], v[20:23], v[200:207], v31
    v_exp_f32 v102, v102
    v_mfma_f32_16x16x32_bf16 a[16:19], a[148:151], v[196:199], a[16:19]
    v_cvt_pk_bf16_f32 v200, v100, v101
    v_mfma_f32_16x16x32_bf16 a[20:23], a[148:151], v[204:207], a[20:23]
    v_exp_f32 v103, v103
    v_mfma_f32_16x16x32_bf16 a[24:27], a[148:151], v[212:215], a[24:27]
    v_mfma_f32_16x16x32_bf16 a[28:31], a[148:151], v[220:223], a[28:31]
    s_waitcnt lgkmcnt(3)
    v_mfma_f32_16x16x32_bf16 v[128:131], a[136:139], v[48:51], v[128:131]
    v_exp_f32 v104, v104
    v_mfma_f32_16x16x32_bf16 v[132:135], a[136:139], v[52:55], v[132:135]
    ds_read_b128 a[128:131], v2 offset:12288
    ds_read_b64_tr_b16 a[144:145], v10 offset:57344
    v_mfma_f32_16x16x32_bf16 v[136:139], a[136:139], v[80:83], v[136:139]
    v_exp_f32 v105, v105
    v_mfma_f32_16x16x32_bf16 v[140:143], a[136:139], v[84:87], v[140:143]
    ds_read_b64_tr_b16 a[146:147], v10 offset:61440
    v_cvt_pk_bf16_f32 v201, v102, v103
    v_smfmac_f32_16x16x64_bf16 v[184:187], v[20:23], v[208:215], v31
    v_exp_f32 v106, v106
    v_mfma_f32_16x16x32_bf16 a[32:35], a[152:155], v[196:199], a[32:35]
    v_cvt_pk_bf16_f32 v208, v104, v105
    v_mfma_f32_16x16x32_bf16 a[36:39], a[152:155], v[204:207], a[36:39]
    v_exp_f32 v107, v107
    v_mfma_f32_16x16x32_bf16 a[40:43], a[152:155], v[212:215], a[40:43]
    v_mfma_f32_16x16x32_bf16 a[44:47], a[152:155], v[220:223], a[44:47]
    s_waitcnt lgkmcnt(3)
    v_mfma_f32_16x16x32_bf16 v[128:131], a[140:143], v[56:59], v[128:131]
    v_exp_f32 v108, v108
    v_mfma_f32_16x16x32_bf16 v[132:135], a[140:143], v[60:63], v[132:135]
    ds_read_b128 a[132:135], v3 offset:12288
    ds_read_b64_tr_b16 a[148:149], v11 offset:57344
    v_mfma_f32_16x16x32_bf16 v[136:139], a[140:143], v[88:91], v[136:139]
    v_exp_f32 v109, v109
    v_mfma_f32_16x16x32_bf16 v[140:143], a[140:143], v[92:95], v[140:143]
    ds_read_b64_tr_b16 a[150:151], v11 offset:61440
    v_cvt_pk_bf16_f32 v209, v106, v107
    v_smfmac_f32_16x16x64_bf16 v[188:191], v[20:23], v[216:223], v31
    v_exp_f32 v110, v110
    v_mfma_f32_16x16x32_bf16 a[48:51], a[156:159], v[196:199], a[48:51]
    v_cvt_pk_bf16_f32 v216, v108, v109
    v_mfma_f32_16x16x32_bf16 a[52:55], a[156:159], v[204:207], a[52:55]
    v_exp_f32 v111, v111
    v_mfma_f32_16x16x32_bf16 a[56:59], a[156:159], v[212:215], a[56:59]
    v_mfma_f32_16x16x32_bf16 a[60:63], a[156:159], v[220:223], a[60:63]
    s_waitcnt lgkmcnt(3)
    v_mfma_f32_16x16x32_bf16 v[144:147], a[128:131], v[32:35], v[160:163]
    v_exp_f32 v112, v112
    v_mfma_f32_16x16x32_bf16 v[148:151], a[128:131], v[36:39], v[164:167]
    ds_read_b128 a[136:139], v4 offset:12288
    ds_read_b64_tr_b16 a[152:153], v12 offset:57344
    v_mfma_f32_16x16x32_bf16 v[152:155], a[128:131], v[64:67], v[168:171]
    v_exp_f32 v113, v113
    v_mfma_f32_16x16x32_bf16 v[156:159], a[128:131], v[68:71], v[172:175]
    ds_read_b64_tr_b16 a[154:155], v12 offset:61440
    v_cvt_pk_bf16_f32 v217, v110, v111
    v_mfma_f32_16x16x32_bf16 a[64:67], a[144:147], v[196:199], a[64:67]
    v_exp_f32 v114, v114
    v_mfma_f32_16x16x32_bf16 a[68:71], a[144:147], v[204:207], a[68:71]
    v_cvt_pk_bf16_f32 v194, v112, v113
    v_mfma_f32_16x16x32_bf16 a[72:75], a[144:147], v[212:215], a[72:75]
    v_exp_f32 v115, v115
    v_mfma_f32_16x16x32_bf16 a[76:79], a[144:147], v[220:223], a[76:79]
    s_waitcnt lgkmcnt(3)
    v_mfma_f32_16x16x32_bf16 v[144:147], a[132:135], v[40:43], v[144:147]
    v_exp_f32 v116, v116
    v_mfma_f32_16x16x32_bf16 v[148:151], a[132:135], v[44:47], v[148:151]
    ds_read_b128 a[140:143], v5 offset:12288
    ds_read_b64_tr_b16 a[156:157], v13 offset:57344
    v_mfma_f32_16x16x32_bf16 v[152:155], a[132:135], v[72:75], v[152:155]
    v_exp_f32 v117, v117
    v_mfma_f32_16x16x32_bf16 v[156:159], a[132:135], v[76:79], v[156:159]
    ds_read_b64_tr_b16 a[158:159], v13 offset:61440
    v_cvt_pk_bf16_f32 v195, v114, v115
    v_mfma_f32_16x16x32_bf16 a[80:83], a[148:151], v[196:199], a[80:83]
    v_exp_f32 v118, v118
    v_mfma_f32_16x16x32_bf16 a[84:87], a[148:151], v[204:207], a[84:87]
    v_cvt_pk_bf16_f32 v202, v116, v117
    v_mfma_f32_16x16x32_bf16 a[88:91], a[148:151], v[212:215], a[88:91]
    v_exp_f32 v119, v119
    v_mfma_f32_16x16x32_bf16 a[92:95], a[148:151], v[220:223], a[92:95]
    s_waitcnt lgkmcnt(3)
    v_mfma_f32_16x16x32_bf16 v[144:147], a[136:139], v[48:51], v[144:147]
    s_waitcnt vmcnt(12)
    s_barrier
    global_load_dword v24, v245, s[62:63] sc1
    v_exp_f32 v120, v120
    v_mfma_f32_16x16x32_bf16 v[148:151], a[136:139], v[52:55], v[148:151]
    ds_read_b128 a[128:131], v2 offset:16384
    ds_read_b64_tr_b16 a[144:145], v6 offset:0
    v_mfma_f32_16x16x32_bf16 v[152:155], a[136:139], v[80:83], v[152:155]
    v_exp_f32 v121, v121
    v_mfma_f32_16x16x32_bf16 v[156:159], a[136:139], v[84:87], v[156:159]
    ds_read_b64_tr_b16 a[146:147], v6 offset:4096
    v_cvt_pk_bf16_f32 v203, v118, v119
    v_mfma_f32_16x16x32_bf16 a[96:99], a[152:155], v[196:199], a[96:99]
    v_exp_f32 v122, v122
    v_mfma_f32_16x16x32_bf16 a[100:103], a[152:155], v[204:207], a[100:103]
    v_cvt_pk_bf16_f32 v210, v120, v121
    v_mfma_f32_16x16x32_bf16 a[104:107], a[152:155], v[212:215], a[104:107]
    v_exp_f32 v123, v123
    v_mfma_f32_16x16x32_bf16 a[108:111], a[152:155], v[220:223], a[108:111]
    s_add_u32 s37, s37, 16384
    s_add_u32 s38, s38, 16384
    s_add_u32 m0, s35, 49152
    s_nop 0
    buffer_load_dwordx4 v14, s[4:7], s37 offen offset:0 lds
    s_waitcnt lgkmcnt(3)
    v_mfma_f32_16x16x32_bf16 v[144:147], a[140:143], v[56:59], v[144:147]
    v_exp_f32 v124, v124
    v_mfma_f32_16x16x32_bf16 v[148:151], a[140:143], v[60:63], v[148:151]
    ds_read_b128 a[132:135], v3 offset:16384
    ds_read_b64_tr_b16 a[148:149], v7 offset:0
    v_mfma_f32_16x16x32_bf16 v[152:155], a[140:143], v[88:91], v[152:155]
    v_exp_f32 v125, v125
    v_mfma_f32_16x16x32_bf16 v[156:159], a[140:143], v[92:95], v[156:159]
    ds_read_b64_tr_b16 a[150:151], v7 offset:4096
    v_cvt_pk_bf16_f32 v211, v122, v123
    v_mfma_f32_16x16x32_bf16 a[112:115], a[156:159], v[196:199], a[112:115]
    v_exp_f32 v126, v126
    v_mfma_f32_16x16x32_bf16 a[116:119], a[156:159], v[204:207], a[116:119]
    v_cvt_pk_bf16_f32 v218, v124, v125
    v_mfma_f32_16x16x32_bf16 a[120:123], a[156:159], v[212:215], a[120:123]
    v_exp_f32 v127, v127
    v_mfma_f32_16x16x32_bf16 a[124:127], a[156:159], v[220:223], a[124:127]
    buffer_load_dwordx4 v15, s[4:7], s37 offen offset:1024 lds
    s_waitcnt lgkmcnt(3)
    v_mfma_f32_16x16x32_bf16 v[96:99], a[128:131], v[32:35], v[160:163]
    v_exp_f32 v128, v128
    v_mfma_f32_16x16x32_bf16 v[100:103], a[128:131], v[36:39], v[164:167]
    ds_read_b128 a[136:139], v4 offset:16384
    ds_read_b64_tr_b16 a[152:153], v8 offset:0
    v_mfma_f32_16x16x32_bf16 v[104:107], a[128:131], v[64:67], v[168:171]
    v_exp_f32 v129, v129
    v_mfma_f32_16x16x32_bf16 v[108:111], a[128:131], v[68:71], v[172:175]
    ds_read_b64_tr_b16 a[154:155], v8 offset:4096
    v_cvt_pk_bf16_f32 v219, v126, v127
    v_mfma_f32_16x16x32_bf16 a[0:3], a[144:147], v[192:195], a[0:3]
    v_exp_f32 v130, v130
    v_mfma_f32_16x16x32_bf16 a[4:7], a[144:147], v[200:203], a[4:7]
    v_cvt_pk_bf16_f32 v196, v128, v129
    v_mfma_f32_16x16x32_bf16 a[8:11], a[144:147], v[208:211], a[8:11]
    v_exp_f32 v131, v131
    v_mfma_f32_16x16x32_bf16 a[12:15], a[144:147], v[216:219], a[12:15]
    buffer_load_dwordx4 v16, s[4:7], s37 offen offset:2048 lds
    s_waitcnt lgkmcnt(3)
    v_mfma_f32_16x16x32_bf16 v[96:99], a[132:135], v[40:43], v[96:99]
    v_exp_f32 v132, v132
    v_mfma_f32_16x16x32_bf16 v[100:103], a[132:135], v[44:47], v[100:103]
    ds_read_b128 a[140:143], v5 offset:16384
    ds_read_b64_tr_b16 a[156:157], v9 offset:0
    v_mfma_f32_16x16x32_bf16 v[104:107], a[132:135], v[72:75], v[104:107]
    v_exp_f32 v133, v133
    v_mfma_f32_16x16x32_bf16 v[108:111], a[132:135], v[76:79], v[108:111]
    ds_read_b64_tr_b16 a[158:159], v9 offset:4096
    v_cvt_pk_bf16_f32 v197, v130, v131
    v_mfma_f32_16x16x32_bf16 a[16:19], a[148:151], v[192:195], a[16:19]
    v_exp_f32 v134, v134
    v_mfma_f32_16x16x32_bf16 a[20:23], a[148:151], v[200:203], a[20:23]
    v_cvt_pk_bf16_f32 v204, v132, v133
    v_mfma_f32_16x16x32_bf16 a[24:27], a[148:151], v[208:211], a[24:27]
    v_exp_f32 v135, v135
    v_mfma_f32_16x16x32_bf16 a[28:31], a[148:151], v[216:219], a[28:31]
    buffer_load_dwordx4 v17, s[4:7], s37 offen offset:3072 lds
    s_waitcnt lgkmcnt(3)
    v_mfma_f32_16x16x32_bf16 v[96:99], a[136:139], v[48:51], v[96:99]
    v_exp_f32 v136, v136
    v_mfma_f32_16x16x32_bf16 v[100:103], a[136:139], v[52:55], v[100:103]
    ds_read_b128 a[128:131], v2 offset:20480
    ds_read_b64_tr_b16 a[144:145], v10 offset:0
    v_mfma_f32_16x16x32_bf16 v[104:107], a[136:139], v[80:83], v[104:107]
    v_exp_f32 v137, v137
    v_mfma_f32_16x16x32_bf16 v[108:111], a[136:139], v[84:87], v[108:111]
    ds_read_b64_tr_b16 a[146:147], v10 offset:4096
    v_cvt_pk_bf16_f32 v205, v134, v135
    v_mfma_f32_16x16x32_bf16 a[32:35], a[152:155], v[192:195], a[32:35]
    v_exp_f32 v138, v138
    v_mfma_f32_16x16x32_bf16 a[36:39], a[152:155], v[200:203], a[36:39]
    v_cvt_pk_bf16_f32 v212, v136, v137
    v_mfma_f32_16x16x32_bf16 a[40:43], a[152:155], v[208:211], a[40:43]
    v_exp_f32 v139, v139
    v_mfma_f32_16x16x32_bf16 a[44:47], a[152:155], v[216:219], a[44:47]
    s_add_u32 m0, s35, 98304
    s_nop 0
    buffer_load_dwordx4 v18, s[8:11], s38 offen offset:0 lds
    s_waitcnt lgkmcnt(3)
    v_mfma_f32_16x16x32_bf16 v[96:99], a[140:143], v[56:59], v[96:99]
    v_exp_f32 v140, v140
    v_mfma_f32_16x16x32_bf16 v[100:103], a[140:143], v[60:63], v[100:103]
    ds_read_b128 a[132:135], v3 offset:20480
    ds_read_b64_tr_b16 a[148:149], v11 offset:0
    v_mfma_f32_16x16x32_bf16 v[104:107], a[140:143], v[88:91], v[104:107]
    v_exp_f32 v141, v141
    v_mfma_f32_16x16x32_bf16 v[108:111], a[140:143], v[92:95], v[108:111]
    ds_read_b64_tr_b16 a[150:151], v11 offset:4096
    v_cvt_pk_bf16_f32 v213, v138, v139
    v_mfma_f32_16x16x32_bf16 a[48:51], a[156:159], v[192:195], a[48:51]
    v_exp_f32 v142, v142
    v_mfma_f32_16x16x32_bf16 a[52:55], a[156:159], v[200:203], a[52:55]
    v_cvt_pk_bf16_f32 v220, v140, v141
    v_mfma_f32_16x16x32_bf16 a[56:59], a[156:159], v[208:211], a[56:59]
    v_exp_f32 v143, v143
    v_mfma_f32_16x16x32_bf16 a[60:63], a[156:159], v[216:219], a[60:63]
    buffer_load_dwordx4 v1, s[8:11], s38 offen offset:1024 lds
    s_waitcnt lgkmcnt(3)
    v_mfma_f32_16x16x32_bf16 v[112:115], a[128:131], v[32:35], v[160:163]
    v_exp_f32 v144, v144
    v_mfma_f32_16x16x32_bf16 v[116:119], a[128:131], v[36:39], v[164:167]
    ds_read_b128 a[136:139], v4 offset:20480
    ds_read_b64_tr_b16 a[152:153], v12 offset:0
    v_mfma_f32_16x16x32_bf16 v[120:123], a[128:131], v[64:67], v[168:171]
    v_exp_f32 v145, v145
    v_mfma_f32_16x16x32_bf16 v[124:127], a[128:131], v[68:71], v[172:175]
    ds_read_b64_tr_b16 a[154:155], v12 offset:4096
    v_cvt_pk_bf16_f32 v221, v142, v143
    v_mfma_f32_16x16x32_bf16 a[64:67], a[144:147], v[192:195], a[64:67]
    v_exp_f32 v146, v146
    v_mfma_f32_16x16x32_bf16 a[68:71], a[144:147], v[200:203], a[68:71]
    v_cvt_pk_bf16_f32 v198, v144, v145
    v_mfma_f32_16x16x32_bf16 a[72:75], a[144:147], v[208:211], a[72:75]
    v_exp_f32 v147, v147
    v_mfma_f32_16x16x32_bf16 a[76:79], a[144:147], v[216:219], a[76:79]
    buffer_load_dwordx4 v18, s[8:11], s38 offen offset:2048 lds
    s_waitcnt lgkmcnt(3)
    v_mfma_f32_16x16x32_bf16 v[112:115], a[132:135], v[40:43], v[112:115]
    v_exp_f32 v148, v148
    v_mfma_f32_16x16x32_bf16 v[116:119], a[132:135], v[44:47], v[116:119]
    ds_read_b128 a[140:143], v5 offset:20480
    ds_read_b64_tr_b16 a[156:157], v13 offset:0
    v_mfma_f32_16x16x32_bf16 v[120:123], a[132:135], v[72:75], v[120:123]
    v_exp_f32 v149, v149
    v_mfma_f32_16x16x32_bf16 v[124:127], a[132:135], v[76:79], v[124:127]
    ds_read_b64_tr_b16 a[158:159], v13 offset:4096
    v_cvt_pk_bf16_f32 v199, v146, v147
    v_mfma_f32_16x16x32_bf16 a[80:83], a[148:151], v[192:195], a[80:83]
    v_exp_f32 v150, v150
    v_mfma_f32_16x16x32_bf16 a[84:87], a[148:151], v[200:203], a[84:87]
    v_cvt_pk_bf16_f32 v206, v148, v149
    v_mfma_f32_16x16x32_bf16 a[88:91], a[148:151], v[208:211], a[88:91]
    v_exp_f32 v151, v151
    v_mfma_f32_16x16x32_bf16 a[92:95], a[148:151], v[216:219], a[92:95]
    buffer_load_dwordx4 v1, s[8:11], s38 offen offset:3072 lds
    s_waitcnt lgkmcnt(3)
    v_mfma_f32_16x16x32_bf16 v[112:115], a[136:139], v[48:51], v[112:115]
    v_exp_f32 v152, v152
    v_mfma_f32_16x16x32_bf16 v[116:119], a[136:139], v[52:55], v[116:119]
    ds_read_b128 a[128:131], v2 offset:24576
    ds_read_b64_tr_b16 a[144:145], v6 offset:8192
    v_mfma_f32_16x16x32_bf16 v[120:123], a[136:139], v[80:83], v[120:123]
    v_exp_f32 v153, v153
    v_mfma_f32_16x16x32_bf16 v[124:127], a[136:139], v[84:87], v[124:127]
    ds_read_b64_tr_b16 a[146:147], v6 offset:12288
    v_cvt_pk_bf16_f32 v207, v150, v151
    v_mfma_f32_16x16x32_bf16 a[96:99], a[152:155], v[192:195], a[96:99]
    v_exp_f32 v154, v154
    v_mfma_f32_16x16x32_bf16 a[100:103], a[152:155], v[200:203], a[100:103]
    v_cvt_pk_bf16_f32 v214, v152, v153
    v_mfma_f32_16x16x32_bf16 a[104:107], a[152:155], v[208:211], a[104:107]
    v_exp_f32 v155, v155
    v_mfma_f32_16x16x32_bf16 a[108:111], a[152:155], v[216:219], a[108:111]
    s_lshr_b32 s94, s51, 2
    s_and_b32 s94, s94, 64
    v_xor_b32 v253, s94, v252
    buffer_store_dwordx4 a[160:163], v253, s[80:83], s51 offen sc1
    s_waitcnt lgkmcnt(3)
    v_mfma_f32_16x16x32_bf16 v[112:115], a[140:143], v[56:59], v[112:115]
    v_exp_f32 v156, v156
    v_mfma_f32_16x16x32_bf16 v[116:119], a[140:143], v[60:63], v[116:119]
    ds_read_b128 a[132:135], v3 offset:24576
    ds_read_b64_tr_b16 a[148:149], v7 offset:8192
    v_mfma_f32_16x16x32_bf16 v[120:123], a[140:143], v[88:91], v[120:123]
    v_exp_f32 v157, v157
    v_mfma_f32_16x16x32_bf16 v[124:127], a[140:143], v[92:95], v[124:127]
    ds_read_b64_tr_b16 a[150:151], v7 offset:12288
    v_cvt_pk_bf16_f32 v215, v154, v155
    v_mfma_f32_16x16x32_bf16 a[112:115], a[156:159], v[192:195], a[112:115]
    v_exp_f32 v158, v158
    v_mfma_f32_16x16x32_bf16 a[116:119], a[156:159], v[200:203], a[116:119]
    v_cvt_pk_bf16_f32 v222, v156, v157
    v_mfma_f32_16x16x32_bf16 a[120:123], a[156:159], v[208:211], a[120:123]
    v_exp_f32 v159, v159
    v_mfma_f32_16x16x32_bf16 a[124:127], a[156:159], v[216:219], a[124:127]
    buffer_store_dwordx4 a[164:167], v253, s[80:83], s51 offen offset:128 sc1
    s_waitcnt lgkmcnt(3)
    v_mfma_f32_16x16x32_bf16 v[128:131], a[128:131], v[32:35], v[160:163]
    v_exp_f32 v96, v96
    v_mfma_f32_16x16x32_bf16 v[132:135], a[128:131], v[36:39], v[164:167]
    ds_read_b128 a[136:139], v4 offset:24576
    ds_read_b64_tr_b16 a[152:153], v8 offset:8192
    v_mfma_f32_16x16x32_bf16 v[136:139], a[128:131], v[64:67], v[168:171]
    v_exp_f32 v97, v97
    v_mfma_f32_16x16x32_bf16 v[140:143], a[128:131], v[68:71], v[172:175]
    ds_read_b64_tr_b16 a[154:155], v8 offset:12288
    v_cvt_pk_bf16_f32 v223, v158, v159
    v_smfmac_f32_16x16x64_bf16 v[176:179], v[20:23], v[192:199], v31
    v_exp_f32 v98, v98
    v_mfma_f32_16x16x32_bf16 a[0:3], a[144:147], v[196:199], a[0:3]
    v_cvt_pk_bf16_f32 v192, v96, v97
    v_mfma_f32_16x16x32_bf16 a[4:7], a[144:147], v[204:207], a[4:7]
    v_exp_f32 v99, v99
    v_mfma_f32_16x16x32_bf16 a[8:11], a[144:147], v[212:215], a[8:11]
    v_mfma_f32_16x16x32_bf16 a[12:15], a[144:147], v[220:223], a[12:15]
    s_waitcnt lgkmcnt(3)
    v_mfma_f32_16x16x32_bf16 v[128:131], a[132:135], v[40:43], v[128:131]
    v_exp_f32 v100, v100
    v_mfma_f32_16x16x32_bf16 v[132:135], a[132:135], v[44:47], v[132:135]
    ds_read_b128 a[140:143], v5 offset:24576
    ds_read_b64_tr_b16 a[156:157], v9 offset:8192
    v_mfma_f32_16x16x32_bf16 v[136:139], a[132:135], v[72:75], v[136:139]
    v_exp_f32 v101, v101
    v_mfma_f32_16x16x32_bf16 v[140:143], a[132:135], v[76:79], v[140:143]
    ds_read_b64_tr_b16 a[158:159], v9 offset:12288
    v_cvt_pk_bf16_f32 v193, v98, v99
    v_smfmac_f32_16x16x64_bf16 v[180:183], v[20:23], v[200:207], v31
    v_exp_f32 v102, v102
    v_mfma_f32_16x16x32_bf16 a[16:19], a[148:151], v[196:199], a[16:19]
    v_cvt_pk_bf16_f32 v200, v100, v101
    v_mfma_f32_16x16x32_bf16 a[20:23], a[148:151], v[204:207], a[20:23]
    v_exp_f32 v103, v103
    v_mfma_f32_16x16x32_bf16 a[24:27], a[148:151], v[212:215], a[24:27]
    v_mfma_f32_16x16x32_bf16 a[28:31], a[148:151], v[220:223], a[28:31]
    s_waitcnt lgkmcnt(3)
    v_mfma_f32_16x16x32_bf16 v[128:131], a[136:139], v[48:51], v[128:131]
    v_exp_f32 v104, v104
    v_mfma_f32_16x16x32_bf16 v[132:135], a[136:139], v[52:55], v[132:135]
    ds_read_b128 a[128:131], v2 offset:28672
    ds_read_b64_tr_b16 a[144:145], v10 offset:8192
    v_mfma_f32_16x16x32_bf16 v[136:139], a[136:139], v[80:83], v[136:139]
    v_exp_f32 v105, v105
    v_mfma_f32_16x16x32_bf16 v[140:143], a[136:139], v[84:87], v[140:143]
    ds_read_b64_tr_b16 a[146:147], v10 offset:12288
    v_cvt_pk_bf16_f32 v201, v102, v103
    v_smfmac_f32_16x16x64_bf16 v[184:187], v[20:23], v[208:215], v31
    v_exp_f32 v106, v106
    v_mfma_f32_16x16x32_bf16 a[32:35], a[152:155], v[196:199], a[32:35]
    v_cvt_pk_bf16_f32 v208, v104, v105
    v_mfma_f32_16x16x32_bf16 a[36:39], a[152:155], v[204:207], a[36:39]
    v_exp_f32 v107, v107
    v_mfma_f32_16x16x32_bf16 a[40:43], a[152:155], v[212:215], a[40:43]
    v_mfma_f32_16x16x32_bf16 a[44:47], a[152:155], v[220:223], a[44:47]
    s_waitcnt lgkmcnt(3)
    v_mfma_f32_16x16x32_bf16 v[128:131], a[140:143], v[56:59], v[128:131]
    v_exp_f32 v108, v108
    v_mfma_f32_16x16x32_bf16 v[132:135], a[140:143], v[60:63], v[132:135]
    ds_read_b128 a[132:135], v3 offset:28672
    ds_read_b64_tr_b16 a[148:149], v11 offset:8192
    v_mfma_f32_16x16x32_bf16 v[136:139], a[140:143], v[88:91], v[136:139]
    v_exp_f32 v109, v109
    v_mfma_f32_16x16x32_bf16 v[140:143], a[140:143], v[92:95], v[140:143]
    ds_read_b64_tr_b16 a[150:151], v11 offset:12288
    v_cvt_pk_bf16_f32 v209, v106, v107
    v_smfmac_f32_16x16x64_bf16 v[188:191], v[20:23], v[216:223], v31
    v_exp_f32 v110, v110
    v_mfma_f32_16x16x32_bf16 a[48:51], a[156:159], v[196:199], a[48:51]
    v_cvt_pk_bf16_f32 v216, v108, v109
    v_mfma_f32_16x16x32_bf16 a[52:55], a[156:159], v[204:207], a[52:55]
    v_exp_f32 v111, v111
    v_mfma_f32_16x16x32_bf16 a[56:59], a[156:159], v[212:215], a[56:59]
    v_mfma_f32_16x16x32_bf16 a[60:63], a[156:159], v[220:223], a[60:63]
    s_waitcnt lgkmcnt(3)
    v_mfma_f32_16x16x32_bf16 v[144:147], a[128:131], v[32:35], v[160:163]
    v_exp_f32 v112, v112
    v_mfma_f32_16x16x32_bf16 v[148:151], a[128:131], v[36:39], v[164:167]
    ds_read_b128 a[136:139], v4 offset:28672
    ds_read_b64_tr_b16 a[152:153], v12 offset:8192
    v_mfma_f32_16x16x32_bf16 v[152:155], a[128:131], v[64:67], v[168:171]
    v_exp_f32 v113, v113
    v_mfma_f32_16x16x32_bf16 v[156:159], a[128:131], v[68:71], v[172:175]
    ds_read_b64_tr_b16 a[154:155], v12 offset:12288
    v_cvt_pk_bf16_f32 v217, v110, v111
    v_mfma_f32_16x16x32_bf16 a[64:67], a[144:147], v[196:199], a[64:67]
    v_exp_f32 v114, v114
    v_mfma_f32_16x16x32_bf16 a[68:71], a[144:147], v[204:207], a[68:71]
    v_cvt_pk_bf16_f32 v194, v112, v113
    v_mfma_f32_16x16x32_bf16 a[72:75], a[144:147], v[212:215], a[72:75]
    v_exp_f32 v115, v115
    v_mfma_f32_16x16x32_bf16 a[76:79], a[144:147], v[220:223], a[76:79]
    s_waitcnt lgkmcnt(3)
    v_mfma_f32_16x16x32_bf16 v[144:147], a[132:135], v[40:43], v[144:147]
    v_exp_f32 v116, v116
    v_mfma_f32_16x16x32_bf16 v[148:151], a[132:135], v[44:47], v[148:151]
    ds_read_b128 a[140:143], v5 offset:28672
    ds_read_b64_tr_b16 a[156:157], v13 offset:8192
    v_mfma_f32_16x16x32_bf16 v[152:155], a[132:135], v[72:75], v[152:155]
    v_exp_f32 v117, v117
    v_mfma_f32_16x16x32_bf16 v[156:159], a[132:135], v[76:79], v[156:159]
    ds_read_b64_tr_b16 a[158:159], v13 offset:12288
    v_cvt_pk_bf16_f32 v195, v114, v115
    v_mfma_f32_16x16x32_bf16 a[80:83], a[148:151], v[196:199], a[80:83]
    v_exp_f32 v118, v118
    v_mfma_f32_16x16x32_bf16 a[84:87], a[148:151], v[204:207], a[84:87]
    v_cvt_pk_bf16_f32 v202, v116, v117
    v_mfma_f32_16x16x32_bf16 a[88:91], a[148:151], v[212:215], a[88:91]
    v_exp_f32 v119, v119
    v_mfma_f32_16x16x32_bf16 a[92:95], a[148:151], v[220:223], a[92:95]
    s_waitcnt lgkmcnt(3)
    v_mfma_f32_16x16x32_bf16 v[144:147], a[136:139], v[48:51], v[144:147]
    s_waitcnt vmcnt(10)
    s_barrier
    s_add_u32 s51, s51, s92
    s_min_u32 s51, s51, s93
    v_exp_f32 v120, v120
    v_mfma_f32_16x16x32_bf16 v[148:151], a[136:139], v[52:55], v[148:151]
    ds_read_b128 a[128:131], v2 offset:32768
    ds_read_b64_tr_b16 a[144:145], v6 offset:16384
wpad7:
    s_cmp_eq_u32 s98, 1
    s_cbranch_scc1 WARMA_done
    v_mfma_f32_16x16x32_bf16 v[152:155], a[136:139], v[80:83], v[152:155]
    v_exp_f32 v121, v121
    v_mfma_f32_16x16x32_bf16 v[156:159], a[136:139], v[84:87], v[156:159]
    ds_read_b64_tr_b16 a[146:147], v6 offset:20480
    v_cvt_pk_bf16_f32 v203, v118, v119
    v_mfma_f32_16x16x32_bf16 a[96:99], a[152:155], v[196:199], a[96:99]
    v_exp_f32 v122, v122
    v_mfma_f32_16x16x32_bf16 a[100:103], a[152:155], v[204:207], a[100:103]
    v_cvt_pk_bf16_f32 v210, v120, v121
    v_mfma_f32_16x16x32_bf16 a[104:107], a[152:155], v[212:215], a[104:107]
    v_exp_f32 v123, v123
    v_mfma_f32_16x16x32_bf16 a[108:111], a[152:155], v[220:223], a[108:111]
    s_add_u32 s37, s37, 16384
    s_add_u32 s38, s38, 16384
    s_add_u32 m0, s35, 0
    s_nop 0
    buffer_load_dwordx4 v14, s[4:7], s37 offen offset:0 lds
    s_waitcnt lgkmcnt(3)
    v_mfma_f32_16x16x32_bf16 v[144:147], a[140:143], v[56:59], v[144:147]
    v_exp_f32 v124, v124
    v_mfma_f32_16x16x32_bf16 v[148:151], a[140:143], v[60:63], v[148:151]
    ds_read_b128 a[132:135], v3 offset:32768
    ds_read_b64_tr_b16 a[148:149], v7 offset:16384
    v_mfma_f32_16x16x32_bf16 v[152:155], a[140:143], v[88:91], v[152:155]
    v_exp_f32 v125, v125
    v_mfma_f32_16x16x32_bf16 v[156:159], a[140:143], v[92:95], v[156:159]
    ds_read_b64_tr_b16 a[150:151], v7 offset:20480
    v_cvt_pk_bf16_f32 v211, v122, v123
    v_mfma_f32_16x16x32_bf16 a[112:115], a[156:159], v[196:199], a[112:115]
    v_exp_f32 v126, v126
    v_mfma_f32_16x16x32_bf16 a[116:119], a[156:159], v[204:207], a[116:119]
    v_cvt_pk_bf16_f32 v218, v124, v125
    v_mfma_f32_16x16x32_bf16 a[120:123], a[156:159], v[212:215], a[120:123]
    v_exp_f32 v127, v127
    v_mfma_f32_16x16x32_bf16 a[124:127], a[156:159], v[220:223], a[124:127]
    buffer_load_dwordx4 v15, s[4:7], s37 offen offset:1024 lds
    s_sub_u32 s39, s39, 1
    s_cmp_lg_u32 s39, 0
    s_cbranch_scc1 attn_loop
attn_loop_done:
    s_mov_b32 s79, 0x10000
    v_cmp_gt_u32 vcc, 32, v24
    s_nop 3
    s_cmp_eq_u64 vcc, 0
    s_cbranch_scc1 hwait_ok
hwait_loop:
    global_load_dword v24, v245, s[62:63] sc1
    s_waitcnt vmcnt(0)
    v_cmp_gt_u32 vcc, 32, v24
    s_nop 3
    s_cmp_eq_u64 vcc, 0
    s_cbranch_scc1 hwait_ok
    s_sub_u32 s79, s79, 1
    s_cbranch_scc1 hwait_ok
    s_sleep 2
    s_branch hwait_loop
hwait_ok:
    s_waitcnt lgkmcnt(3)
    v_mfma_f32_16x16x32_bf16 v[96:99], a[128:131], v[32:35], v[160:163]
    v_exp_f32 v128, v128
    v_mfma_f32_16x16x32_bf16 v[100:103], a[128:131], v[36:39], v[164:167]
    ds_read_b128 a[136:139], v4 offset:32768
    ds_read_b64_tr_b16 a[152:153], v8 offset:16384
    v_mfma_f32_16x16x32_bf16 v[104:107], a[128:131], v[64:67], v[168:171]
    v_exp_f32 v129, v129
    v_mfma_f32_16x16x32_bf16 v[108:111], a[128:131], v[68:71], v[172:175]
    ds_read_b64_tr_b16 a[154:155], v8 offset:20480
    v_cvt_pk_bf16_f32 v219, v126, v127
    v_mfma_f32_16x16x32_bf16 a[0:3], a[144:147], v[192:195], a[0:3]
    v_exp_f32 v130, v130
    v_mfma_f32_16x16x32_bf16 a[4:7], a[144:147], v[200:203], a[4:7]
    v_cvt_pk_bf16_f32 v196, v128, v129
    v_mfma_f32_16x16x32_bf16 a[8:11], a[144:147], v[208:211], a[8:11]
    v_exp_f32 v131, v131
    v_mfma_f32_16x16x32_bf16 a[12:15], a[144:147], v[216:219], a[12:15]
    buffer_load_dwordx4 v16, s[4:7], s37 offen offset:2048 lds
    s_waitcnt lgkmcnt(3)
    v_mfma_f32_16x16x32_bf16 v[96:99], a[132:135], v[40:43], v[96:99]
    v_exp_f32 v132, v132
    v_mfma_f32_16x16x32_bf16 v[100:103], a[132:135], v[44:47], v[100:103]
    ds_read_b128 a[140:143], v5 offset:32768
    ds_read_b64_tr_b16 a[156:157], v9 offset:16384
    v_mfma_f32_16x16x32_bf16 v[104:107], a[132:135], v[72:75], v[104:107]
    v_exp_f32 v133, v133
    v_mfma_f32_16x16x32_bf16 v[108:111], a[132:135], v[76:79], v[108:111]
    ds_read_b64_tr_b16 a[158:159], v9 offset:20480
    v_cvt_pk_bf16_f32 v197, v130, v131
    v_mfma_f32_16x16x32_bf16 a[16:19], a[148:151], v[192:195], a[16:19]
    v_exp_f32 v134, v134
    v_mfma_f32_16x16x32_bf16 a[20:23], a[148:151], v[200:203], a[20:23]
    v_cvt_pk_bf16_f32 v204, v132, v133
    v_mfma_f32_16x16x32_bf16 a[24:27], a[148:151], v[208:211], a[24:27]
    v_exp_f32 v135, v135
    v_mfma_f32_16x16x32_bf16 a[28:31], a[148:151], v[216:219], a[28:31]
    buffer_load_dwordx4 v17, s[4:7], s37 offen offset:3072 lds
    s_waitcnt lgkmcnt(3)
    v_mfma_f32_16x16x32_bf16 v[96:99], a[136:139], v[48:51], v[96:99]
    v_exp_f32 v136, v136
    v_mfma_f32_16x16x32_bf16 v[100:103], a[136:139], v[52:55], v[100:103]
    ds_read_b128 a[128:131], v2 offset:36864
    ds_read_b64_tr_b16 a[144:145], v10 offset:16384
    v_mfma_f32_16x16x32_bf16 v[104:107], a[136:139], v[80:83], v[104:107]
    v_exp_f32 v137, v137
    v_mfma_f32_16x16x32_bf16 v[108:111], a[136:139], v[84:87], v[108:111]
    ds_read_b64_tr_b16 a[146:147], v10 offset:20480
    v_cvt_pk_bf16_f32 v205, v134, v135
    v_mfma_f32_16x16x32_bf16 a[32:35], a[152:155], v[192:195], a[32:35]
    v_exp_f32 v138, v138
    v_mfma_f32_16x16x32_bf16 a[36:39], a[152:155], v[200:203], a[36:39]
    v_cvt_pk_bf16_f32 v212, v136, v137
    v_mfma_f32_16x16x32_bf16 a[40:43], a[152:155], v[208:211], a[40:43]
    v_exp_f32 v139, v139
    v_mfma_f32_16x16x32_bf16 a[44:47], a[152:155], v[216:219], a[44:47]
    s_add_u32 m0, s35, 114688
    s_nop 0
    buffer_load_dwordx4 v18, s[8:11], s38 offen offset:0 lds
    s_waitcnt lgkmcnt(3)
    v_mfma_f32_16x16x32_bf16 v[96:99], a[140:143], v[56:59], v[96:99]
    v_exp_f32 v140, v140
    v_mfma_f32_16x16x32_bf16 v[100:103], a[140:143], v[60:63], v[100:103]
    ds_read_b128 a[132:135], v3 offset:36864
    ds_read_b64_tr_b16 a[148:149], v11 offset:16384
    v_mfma_f32_16x16x32_bf16 v[104:107], a[140:143], v[88:91], v[104:107]
    v_exp_f32 v141, v141
    v_mfma_f32_16x16x32_bf16 v[108:111], a[140:143], v[92:95], v[108:111]
    ds_read_b64_tr_b16 a[150:151], v11 offset:20480
    v_cvt_pk_bf16_f32 v213, v138, v139
    v_mfma_f32_16x16x32_bf16 a[48:51], a[156:159], v[192:195], a[48:51]
    v_exp_f32 v142, v142
    v_mfma_f32_16x16x32_bf16 a[52:55], a[156:159], v[200:203], a[52:55]
    v_cvt_pk_bf16_f32 v220, v140, v141
    buffer_load_dwordx4 v1, s[8:11], s38 offen offset:1024 lds
    v_mfma_f32_16x16x32_bf16 a[56:59], a[156:159], v[208:211], a[56:59]
    v_exp_f32 v143, v143
    v_mfma_f32_16x16x32_bf16 a[60:63], a[156:159], v[216:219], a[60:63]
    buffer_load_dwordx4 v18, s[8:11], s38 offen offset:2048 lds
    s_waitcnt lgkmcnt(3)
    v_mfma_f32_16x16x32_bf16 v[112:115], a[128:131], v[32:35], v[160:163]
    v_exp_f32 v144, v144
    v_mfma_f32_16x16x32_bf16 v[116:119], a[128:131], v[36:39], v[164:167]
    ds_read_b128 a[136:139], v4 offset:36864
    ds_read_b64_tr_b16 a[152:153], v12 offset:16384
    v_mfma_f32_16x16x32_bf16 v[120:123], a[128:131], v[64:67], v[168:171]
    v_exp_f32 v145, v145
    v_mfma_f32_16x16x32_bf16 v[124:127], a[128:131], v[68:71], v[172:175]
    ds_read_b64_tr_b16 a[154:155], v12 offset:20480
    v_cvt_pk_bf16_f32 v221, v142, v143
    v_mfma_f32_16x16x32_bf16 a[64:67], a[144:147], v[192:195], a[64:67]
    v_exp_f32 v146, v146
    v_mfma_f32_16x16x32_bf16 a[68:71], a[144:147], v[200:203], a[68:71]
    v_cvt_pk_bf16_f32 v198, v144, v145
    v_mfma_f32_16x16x32_bf16 a[72:75], a[144:147], v[208:211], a[72:75]
    v_exp_f32 v147, v147
    v_mfma_f32_16x16x32_bf16 a[76:79], a[144:147], v[216:219], a[76:79]
    buffer_load_dwordx4 v1, s[8:11], s38 offen offset:3072 lds
    s_waitcnt lgkmcnt(3)
    v_mfma_f32_16x16x32_bf16 v[112:115], a[132:135], v[40:43], v[112:115]
    v_exp_f32 v148, v148
    v_mfma_f32_16x16x32_bf16 v[116:119], a[132:135], v[44:47], v[116:119]
    ds_read_b128 a[140:143], v5 offset:36864
    ds_read_b64_tr_b16 a[156:157], v13 offset:16384
    v_mfma_f32_16x16x32_bf16 v[120:123], a[132:135], v[72:75], v[120:123]
    v_exp_f32 v149, v149
    v_mfma_f32_16x16x32_bf16 v[124:127], a[132:135], v[76:79], v[124:127]
    ds_read_b64_tr_b16 a[158:159], v13 offset:20480
    v_cvt_pk_bf16_f32 v199, v146, v147
    v_mfma_f32_16x16x32_bf16 a[80:83], a[148:151], v[192:195], a[80:83]
    v_exp_f32 v150, v150
    v_mfma_f32_16x16x32_bf16 a[84:87], a[148:151], v[200:203], a[84:87]
    v_cvt_pk_bf16_f32 v206, v148, v149
    v_mfma_f32_16x16x32_bf16 a[88:91], a[148:151], v[208:211], a[88:91]
    v_exp_f32 v151, v151
    v_mfma_f32_16x16x32_bf16 a[92:95], a[148:151], v[216:219], a[92:95]
    s_add_u32 m0, s74, 131072
    s_mov_b32 s40, 0
    buffer_load_dwordx4 v19, s[16:19], s40 offen sc1 lds
    s_waitcnt lgkmcnt(3)
    v_mfma_f32_16x16x32_bf16 v[112:115], a[136:139], v[48:51], v[112:115]
    v_exp_f32 v152, v152
    v_mfma_f32_16x16x32_bf16 v[116:119], a[136:139], v[52:55], v[116:119]
    ds_read_b128 a[128:131], v2 offset:40960
    ds_read_b64_tr_b16 a[144:145], v6 offset:24576
    v_mfma_f32_16x16x32_bf16 v[120:123], a[136:139], v[80:83], v[120:123]
    v_exp_f32 v153, v153
    v_mfma_f32_16x16x32_bf16 v[124:127], a[136:139], v[84:87], v[124:127]
    ds_read_b64_tr_b16 a[146:147], v6 offset:28672
    v_cvt_pk_bf16_f32 v207, v150, v151
    v_mfma_f32_16x16x32_bf16 a[96:99], a[152:155], v[192:195], a[96:99]
    v_exp_f32 v154, v154
    v_mfma_f32_16x16x32_bf16 a[100:103], a[152:155], v[200:203], a[100:103]
    v_cvt_pk_bf16_f32 v214, v152, v153
    s_add_u32 m0, s74, 135168
    s_mov_b32 s40, 2048
    buffer_load_dwordx4 v19, s[16:19], s40 offen sc1 lds
    v_mfma_f32_16x16x32_bf16 a[104:107], a[152:155], v[208:211], a[104:107]
    v_exp_f32 v155, v155
    v_mfma_f32_16x16x32_bf16 a[108:111], a[152:155], v[216:219], a[108:111]
    s_add_u32 m0, s74, 139264
    s_mov_b32 s40, 4096
    buffer_load_dwordx4 v19, s[16:19], s40 offen sc1 lds
    s_waitcnt lgkmcnt(3)
    v_mfma_f32_16x16x32_bf16 v[112:115], a[140:143], v[56:59], v[112:115]
    v_exp_f32 v156, v156
    v_mfma_f32_16x16x32_bf16 v[116:119], a[140:143], v[60:63], v[116:119]
    ds_read_b128 a[132:135], v3 offset:40960
    ds_read_b64_tr_b16 a[148:149], v7 offset:24576
    v_mfma_f32_16x16x32_bf16 v[120:123], a[140:143], v[88:91], v[120:123]
    v_exp_f32 v157, v157
    v_mfma_f32_16x16x32_bf16 v[124:127], a[140:143], v[92:95], v[124:127]
    ds_read_b64_tr_b16 a[150:151], v7 offset:28672
    v_cvt_pk_bf16_f32 v215, v154, v155
    v_mfma_f32_16x16x32_bf16 a[112:115], a[156:159], v[192:195], a[112:115]
    v_exp_f32 v158, v158
    v_mfma_f32_16x16x32_bf16 a[116:119], a[156:159], v[200:203], a[116:119]
    v_cvt_pk_bf16_f32 v222, v156, v157
    v_mfma_f32_16x16x32_bf16 a[120:123], a[156:159], v[208:211], a[120:123]
    v_exp_f32 v159, v159
    v_mfma_f32_16x16x32_bf16 a[124:127], a[156:159], v[216:219], a[124:127]
    s_add_u32 m0, s74, 143360
    s_mov_b32 s40, 6144
    buffer_load_dwordx4 v19, s[16:19], s40 offen sc1 lds
    s_waitcnt lgkmcnt(3)
    v_mfma_f32_16x16x32_bf16 v[128:131], a[128:131], v[32:35], v[160:163]
    v_exp_f32 v96, v96
    v_mfma_f32_16x16x32_bf16 v[132:135], a[128:131], v[36:39], v[164:167]
    ds_read_b128 a[136:139], v4 offset:40960
    ds_read_b64_tr_b16 a[152:153], v8 offset:24576
    v_mfma_f32_16x16x32_bf16 v[136:139], a[128:131], v[64:67], v[168:171]
    v_exp_f32 v97, v97
    v_mfma_f32_16x16x32_bf16 v[140:143], a[128:131], v[68:71], v[172:175]
    ds_read_b64_tr_b16 a[154:155], v8 offset:28672
    v_cvt_pk_bf16_f32 v223, v158, v159
    v_smfmac_f32_16x16x64_bf16 v[176:179], v[20:23], v[192:199], v31
    v_exp_f32 v98, v98
    v_mfma_f32_16x16x32_bf16 a[0:3], a[144:147], v[196:199], a[0:3]
    v_cvt_pk_bf16_f32 v192, v96, v97
    v_mfma_f32_16x16x32_bf16 a[4:7], a[144:147], v[204:207], a[4:7]
    v_exp_f32 v99, v99
    v_mfma_f32_16x16x32_bf16 a[8:11], a[144:147], v[212:215], a[8:11]
    s_add_u32 m0, s74, 147456
    s_mov_b32 s40, 8192
    buffer_load_dwordx4 v19, s[16:19], s40 offen sc1 lds
    v_mfma_f32_16x16x32_bf16 a[12:15], a[144:147], v[220:223], a[12:15]
    s_waitcnt lgkmcnt(3)
    v_mfma_f32_16x16x32_bf16 v[128:131], a[132:135], v[40:43], v[128:131]
    v_exp_f32 v100, v100
    v_mfma_f32_16x16x32_bf16 v[132:135], a[132:135], v[44:47], v[132:135]
    ds_read_b128 a[140:143], v5 offset:40960
    ds_read_b64_tr_b16 a[156:157], v9 offset:24576
    v_mfma_f32_16x16x32_bf16 v[136:139], a[132:135], v[72:75], v[136:139]
    v_exp_f32 v101, v101
    v_mfma_f32_16x16x32_bf16 v[140:143], a[132:135], v[76:79], v[140:143]
    ds_read_b64_tr_b16 a[158:159], v9 offset:28672
    v_cvt_pk_bf16_f32 v193, v98, v99
    v_smfmac_f32_16x16x64_bf16 v[180:183], v[20:23], v[200:207], v31
    v_exp_f32 v102, v102
    v_mfma_f32_16x16x32_bf16 a[16:19], a[148:151], v[196:199], a[16:19]
    v_cvt_pk_bf16_f32 v200, v100, v101
    s_add_u32 m0, s74, 151552
    s_mov_b32 s40, 10240
    buffer_load_dwordx4 v19, s[16:19], s40 offen sc1 lds
    v_mfma_f32_16x16x32_bf16 a[20:23], a[148:151], v[204:207], a[20:23]
    v_exp_f32 v103, v103
    v_mfma_f32_16x16x32_bf16 a[24:27], a[148:151], v[212:215], a[24:27]
    s_add_u32 m0, s74, 155648
    s_mov_b32 s40, 12288
    buffer_load_dwordx4 v19, s[16:19], s40 offen sc1 lds
    v_mfma_f32_16x16x32_bf16 a[28:31], a[148:151], v[220:223], a[28:31]
    s_waitcnt lgkmcnt(3)
    v_mfma_f32_16x16x32_bf16 v[128:131], a[136:139], v[48:51], v[128:131]
    v_exp_f32 v104, v104
    v_mfma_f32_16x16x32_bf16 v[132:135], a[136:139], v[52:55], v[132:135]
    ds_read_b128 a[128:131], v2 offset:45056
    ds_read_b64_tr_b16 a[144:145], v10 offset:24576
    v_mfma_f32_16x16x32_bf16 v[136:139], a[136:139], v[80:83], v[136:139]
    v_exp_f32 v105, v105
    v_mfma_f32_16x16x32_bf16 v[140:143], a[136:139], v[84:87], v[140:143]
    ds_read_b64_tr_b16 a[146:147], v10 offset:28672
    v_cvt_pk_bf16_f32 v201, v102, v103
    v_smfmac_f32_16x16x64_bf16 v[184:187], v[20:23], v[208:215], v31
    v_exp_f32 v106, v106
    v_mfma_f32_16x16x32_bf16 a[32:35], a[152:155], v[196:199], a[32:35]
    v_cvt_pk_bf16_f32 v208, v104, v105
    v_mfma_f32_16x16x32_bf16 a[36:39], a[152:155], v[204:207], a[36:39]
    v_exp_f32 v107, v107
    v_mfma_f32_16x16x32_bf16 a[40:43], a[152:155], v[212:215], a[40:43]
    s_add_u32 m0, s74, 159744
    s_mov_b32 s40, 14336
    buffer_load_dwordx4 v19, s[16:19], s40 offen sc1 lds
    v_mfma_f32_16x16x32_bf16 a[44:47], a[152:155], v[220:223], a[44:47]
    s_waitcnt lgkmcnt(3)
    v_mfma_f32_16x16x32_bf16 v[128:131], a[140:143], v[56:59], v[128:131]
    v_exp_f32 v108, v108
    v_mfma_f32_16x16x32_bf16 v[132:135], a[140:143], v[60:63], v[132:135]
    ds_read_b128 a[132:135], v3 offset:45056
    ds_read_b64_tr_b16 a[148:149], v11 offset:24576
    v_mfma_f32_16x16x32_bf16 v[136:139], a[140:143], v[88:91], v[136:139]
    v_exp_f32 v109, v109
    v_mfma_f32_16x16x32_bf16 v[140:143], a[140:143], v[92:95], v[140:143]
    ds_read_b64_tr_b16 a[150:151], v11 offset:28672
    v_cvt_pk_bf16_f32 v209, v106, v107
    v_smfmac_f32_16x16x64_bf16 v[188:191], v[20:23], v[216:223], v31
    v_exp_f32 v110, v110
    v_mfma_f32_16x16x32_bf16 a[48:51], a[156:159], v[196:199], a[48:51]
    v_cvt_pk_bf16_f32 v216, v108, v109
    v_mfma_f32_16x16x32_bf16 a[52:55], a[156:159], v[204:207], a[52:55]
    v_exp_f32 v111, v111
    v_mfma_f32_16x16x32_bf16 a[56:59], a[156:159], v[212:215], a[56:59]
    s_mov_b32 s41, 0
    buffer_load_dwordx4 a[160:163], v19, s[24:27], s41 offen sc1
    v_mfma_f32_16x16x32_bf16 a[60:63], a[156:159], v[220:223], a[60:63]
    s_waitcnt lgkmcnt(3)
    v_mfma_f32_16x16x32_bf16 v[144:147], a[128:131], v[32:35], v[160:163]
    v_exp_f32 v112, v112
    v_mfma_f32_16x16x32_bf16 v[148:151], a[128:131], v[36:39], v[164:167]
    ds_read_b128 a[136:139], v4 offset:45056
    ds_read_b64_tr_b16 a[152:153], v12 offset:24576
    v_mfma_f32_16x16x32_bf16 v[152:155], a[128:131], v[64:67], v[168:171]
    v_exp_f32 v113, v113
    v_mfma_f32_16x16x32_bf16 v[156:159], a[128:131], v[68:71], v[172:175]
    ds_read_b64_tr_b16 a[154:155], v12 offset:28672
    v_cvt_pk_bf16_f32 v217, v110, v111
    v_mfma_f32_16x16x32_bf16 a[64:67], a[144:147], v[196:199], a[64:67]
    v_exp_f32 v114, v114
    v_mfma_f32_16x16x32_bf16 a[68:71], a[144:147], v[204:207], a[68:71]
    v_cvt_pk_bf16_f32 v194, v112, v113
    v_mfma_f32_16x16x32_bf16 a[72:75], a[144:147], v[212:215], a[72:75]
    v_exp_f32 v115, v115
    v_mfma_f32_16x16x32_bf16 a[76:79], a[144:147], v[220:223], a[76:79]
    s_mov_b32 s41, 1024
    buffer_load_dwordx4 a[164:167], v19, s[24:27], s41 offen sc1
    s_waitcnt lgkmcnt(3)
    v_mfma_f32_16x16x32_bf16 v[144:147], a[132:135], v[40:43], v[144:147]
    v_exp_f32 v116, v116
    v_mfma_f32_16x16x32_bf16 v[148:151], a[132:135], v[44:47], v[148:151]
    ds_read_b128 a[140:143], v5 offset:45056
    ds_read_b64_tr_b16 a[156:157], v13 offset:24576
    v_mfma_f32_16x16x32_bf16 v[152:155], a[132:135], v[72:75], v[152:155]
    v_exp_f32 v117, v117
    v_mfma_f32_16x16x32_bf16 v[156:159], a[132:135], v[76:79], v[156:159]
    ds_read_b64_tr_b16 a[158:159], v13 offset:28672
    v_cvt_pk_bf16_f32 v195, v114, v115
    v_mfma_f32_16x16x32_bf16 a[80:83], a[148:151], v[196:199], a[80:83]
    v_exp_f32 v118, v118
    v_mfma_f32_16x16x32_bf16 a[84:87], a[148:151], v[204:207], a[84:87]
    v_cvt_pk_bf16_f32 v202, v116, v117
    s_mov_b32 s41, 2048
    buffer_load_dwordx4 a[168:171], v19, s[24:27], s41 offen sc1
    v_mfma_f32_16x16x32_bf16 a[88:91], a[148:151], v[212:215], a[88:91]
    v_exp_f32 v119, v119
    v_mfma_f32_16x16x32_bf16 a[92:95], a[148:151], v[220:223], a[92:95]
    s_mov_b32 s41, 3072
    buffer_load_dwordx4 a[172:175], v19, s[24:27], s41 offen sc1
    s_waitcnt lgkmcnt(3)
    v_mfma_f32_16x16x32_bf16 v[144:147], a[136:139], v[48:51], v[144:147]
    s_waitcnt vmcnt(16)
    s_barrier
    v_exp_f32 v120, v120
    v_mfma_f32_16x16x32_bf16 v[148:151], a[136:139], v[52:55], v[148:151]
    ds_read_b128 a[128:131], v2 offset:49152
    ds_read_b64_tr_b16 a[144:145], v6 offset:32768
    v_mfma_f32_16x16x32_bf16 v[152:155], a[136:139], v[80:83], v[152:155]
    v_exp_f32 v121, v121
    v_mfma_f32_16x16x32_bf16 v[156:159], a[136:139], v[84:87], v[156:159]
    ds_read_b64_tr_b16 a[146:147], v6 offset:36864
    v_cvt_pk_bf16_f32 v203, v118, v119
    v_mfma_f32_16x16x32_bf16 a[96:99], a[152:155], v[196:199], a[96:99]
    v_exp_f32 v122, v122
    v_mfma_f32_16x16x32_bf16 a[100:103], a[152:155], v[204:207], a[100:103]
    v_cvt_pk_bf16_f32 v210, v120, v121
    v_mfma_f32_16x16x32_bf16 a[104:107], a[152:155], v[212:215], a[104:107]
    v_exp_f32 v123, v123
    v_mfma_f32_16x16x32_bf16 a[108:111], a[152:155], v[220:223], a[108:111]
    s_add_u32 m0, s74, 0
    s_mov_b32 s40, 16384
    buffer_load_dwordx4 v19, s[16:19], s40 offen sc1 lds
    s_waitcnt lgkmcnt(3)
    v_mfma_f32_16x16x32_bf16 v[144:147], a[140:143], v[56:59], v[144:147]
    v_exp_f32 v124, v124
    v_mfma_f32_16x16x32_bf16 v[148:151], a[140:143], v[60:63], v[148:151]
    ds_read_b128 a[132:135], v3 offset:49152
    ds_read_b64_tr_b16 a[148:149], v7 offset:32768
    v_mfma_f32_16x16x32_bf16 v[152:155], a[140:143], v[88:91], v[152:155]
    v_exp_f32 v125, v125
    v_mfma_f32_16x16x32_bf16 v[156:159], a[140:143], v[92:95], v[156:159]
    ds_read_b64_tr_b16 a[150:151], v7 offset:36864
    v_cvt_pk_bf16_f32 v211, v122, v123
    v_mfma_f32_16x16x32_bf16 a[112:115], a[156:159], v[196:199], a[112:115]
    v_exp_f32 v126, v126
    v_mfma_f32_16x16x32_bf16 a[116:119], a[156:159], v[204:207], a[116:119]
    v_cvt_pk_bf16_f32 v218, v124, v125
    v_mfma_f32_16x16x32_bf16 a[120:123], a[156:159], v[212:215], a[120:123]
    v_exp_f32 v127, v127
    v_mfma_f32_16x16x32_bf16 a[124:127], a[156:159], v[220:223], a[124:127]
    s_add_u32 m0, s74, 4096
    s_mov_b32 s40, 18432
    buffer_load_dwordx4 v19, s[16:19], s40 offen sc1 lds
    s_waitcnt lgkmcnt(3)
    v_mfma_f32_16x16x32_bf16 v[96:99], a[128:131], v[32:35], v[160:163]
    v_exp_f32 v128, v128
    v_mfma_f32_16x16x32_bf16 v[100:103], a[128:131], v[36:39], v[164:167]
    ds_read_b128 a[136:139], v4 offset:49152
    ds_read_b64_tr_b16 a[152:153], v8 offset:32768
    v_mfma_f32_16x16x32_bf16 v[104:107], a[128:131], v[64:67], v[168:171]
    v_exp_f32 v129, v129
    v_mfma_f32_16x16x32_bf16 v[108:111], a[128:131], v[68:71], v[172:175]
    ds_read_b64_tr_b16 a[154:155], v8 offset:36864
    v_cvt_pk_bf16_f32 v219, v126, v127
    v_mfma_f32_16x16x32_bf16 a[0:3], a[144:147], v[192:195], a[0:3]
    v_exp_f32 v130, v130
    v_mfma_f32_16x16x32_bf16 a[4:7], a[144:147], v[200:203], a[4:7]
    v_cvt_pk_bf16_f32 v196, v128, v129
    s_add_u32 m0, s74, 8192
    s_mov_b32 s40, 20480
    buffer_load_dwordx4 v19, s[16:19], s40 offen sc1 lds
    v_mfma_f32_16x16x32_bf16 a[8:11], a[144:147], v[208:211], a[8:11]
    v_exp_f32 v131, v131
    v_mfma_f32_16x16x32_bf16 a[12:15], a[144:147], v[216:219], a[12:15]
    s_add_u32 m0, s74, 12288
    s_mov_b32 s40, 22528
    buffer_load_dwordx4 v19, s[16:19], s40 offen sc1 lds
    s_waitcnt lgkmcnt(3)
    v_mfma_f32_16x16x32_bf16 v[96:99], a[132:135], v[40:43], v[96:99]
    v_exp_f32 v132, v132
    v_mfma_f32_16x16x32_bf16 v[100:103], a[132:135], v[44:47], v[100:103]
    ds_read_b128 a[140:143], v5 offset:49152
    ds_read_b64_tr_b16 a[156:157], v9 offset:32768
    v_mfma_f32_16x16x32_bf16 v[104:107], a[132:135], v[72:75], v[104:107]
    v_exp_f32 v133, v133
    v_mfma_f32_16x16x32_bf16 v[108:111], a[132:135], v[76:79], v[108:111]
    ds_read_b64_tr_b16 a[158:159], v9 offset:36864
    v_cvt_pk_bf16_f32 v197, v130, v131
    v_mfma_f32_16x16x32_bf16 a[16:19], a[148:151], v[192:195], a[16:19]
    v_exp_f32 v134, v134
    v_mfma_f32_16x16x32_bf16 a[20:23], a[148:151], v[200:203], a[20:23]
    v_cvt_pk_bf16_f32 v204, v132, v133
    v_mfma_f32_16x16x32_bf16 a[24:27], a[148:151], v[208:211], a[24:27]
    v_exp_f32 v135, v135
    v_mfma_f32_16x16x32_bf16 a[28:31], a[148:151], v[216:219], a[28:31]
    s_add_u32 m0, s74, 16384
    s_mov_b32 s40, 24576
    buffer_load_dwordx4 v19, s[16:19], s40 offen sc1 lds
    s_waitcnt lgkmcnt(3)
    v_mfma_f32_16x16x32_bf16 v[96:99], a[136:139], v[48:51], v[96:99]
    v_exp_f32 v136, v136
    v_mfma_f32_16x16x32_bf16 v[100:103], a[136:139], v[52:55], v[100:103]
    ds_read_b128 a[128:131], v2 offset:53248
    ds_read_b64_tr_b16 a[144:145], v10 offset:32768
    v_mfma_f32_16x16x32_bf16 v[104:107], a[136:139], v[80:83], v[104:107]
    v_exp_f32 v137, v137
    v_mfma_f32_16x16x32_bf16 v[108:111], a[136:139], v[84:87], v[108:111]
    ds_read_b64_tr_b16 a[146:147], v10 offset:36864
    v_cvt_pk_bf16_f32 v205, v134, v135
    v_mfma_f32_16x16x32_bf16 a[32:35], a[152:155], v[192:195], a[32:35]
    v_exp_f32 v138, v138
    v_mfma_f32_16x16x32_bf16 a[36:39], a[152:155], v[200:203], a[36:39]
    v_cvt_pk_bf16_f32 v212, v136, v137
    v_mfma_f32_16x16x32_bf16 a[40:43], a[152:155], v[208:211], a[40:43]
    v_exp_f32 v139, v139
    v_mfma_f32_16x16x32_bf16 a[44:47], a[152:155], v[216:219], a[44:47]
    s_add_u32 m0, s74, 20480
    s_mov_b32 s40, 26624
    buffer_load_dwordx4 v19, s[16:19], s40 offen sc1 lds
    s_waitcnt lgkmcnt(3)
    v_mfma_f32_16x16x32_bf16 v[96:99], a[140:143], v[56:59], v[96:99]
    v_exp_f32 v140, v140
    v_mfma_f32_16x16x32_bf16 v[100:103], a[140:143], v[60:63], v[100:103]
    ds_read_b128 a[132:135], v3 offset:53248
    ds_read_b64_tr_b16 a[148:149], v11 offset:32768
    v_mfma_f32_16x16x32_bf16 v[104:107], a[140:143], v[88:91], v[104:107]
    v_exp_f32 v141, v141
    v_mfma_f32_16x16x32_bf16 v[108:111], a[140:143], v[92:95], v[108:111]
    ds_read_b64_tr_b16 a[150:151], v11 offset:36864
    v_cvt_pk_bf16_f32 v213, v138, v139
    v_mfma_f32_16x16x32_bf16 a[48:51], a[156:159], v[192:195], a[48:51]
    v_exp_f32 v142, v142
    v_mfma_f32_16x16x32_bf16 a[52:55], a[156:159], v[200:203], a[52:55]
    v_cvt_pk_bf16_f32 v220, v140, v141
    s_add_u32 m0, s74, 24576
    s_mov_b32 s40, 28672
    buffer_load_dwordx4 v19, s[16:19], s40 offen sc1 lds
    v_mfma_f32_16x16x32_bf16 a[56:59], a[156:159], v[208:211], a[56:59]
    v_exp_f32 v143, v143
    v_mfma_f32_16x16x32_bf16 a[60:63], a[156:159], v[216:219], a[60:63]
    s_add_u32 m0, s74, 28672
    s_mov_b32 s40, 30720
    buffer_load_dwordx4 v19, s[16:19], s40 offen sc1 lds
    s_waitcnt lgkmcnt(3)
    v_mfma_f32_16x16x32_bf16 v[112:115], a[128:131], v[32:35], v[160:163]
    v_exp_f32 v144, v144
    v_mfma_f32_16x16x32_bf16 v[116:119], a[128:131], v[36:39], v[164:167]
    ds_read_b128 a[136:139], v4 offset:53248
    ds_read_b64_tr_b16 a[152:153], v12 offset:32768
    v_mfma_f32_16x16x32_bf16 v[120:123], a[128:131], v[64:67], v[168:171]
    v_exp_f32 v145, v145
    v_mfma_f32_16x16x32_bf16 v[124:127], a[128:131], v[68:71], v[172:175]
    ds_read_b64_tr_b16 a[154:155], v12 offset:36864
    v_cvt_pk_bf16_f32 v221, v142, v143
    v_mfma_f32_16x16x32_bf16 a[64:67], a[144:147], v[192:195], a[64:67]
    v_exp_f32 v146, v146
    v_mfma_f32_16x16x32_bf16 a[68:71], a[144:147], v[200:203], a[68:71]
    v_cvt_pk_bf16_f32 v198, v144, v145
    v_mfma_f32_16x16x32_bf16 a[72:75], a[144:147], v[208:211], a[72:75]
    v_exp_f32 v147, v147
    v_mfma_f32_16x16x32_bf16 a[76:79], a[144:147], v[216:219], a[76:79]
    s_add_u32 m0, s74, 65536
    s_mov_b32 s40, 32768
    buffer_load_dwordx4 v19, s[16:19], s40 offen sc1 lds
    s_waitcnt lgkmcnt(3)
    v_mfma_f32_16x16x32_bf16 v[112:115], a[132:135], v[40:43], v[112:115]
    v_exp_f32 v148, v148
    v_mfma_f32_16x16x32_bf16 v[116:119], a[132:135], v[44:47], v[116:119]
    ds_read_b128 a[140:143], v5 offset:53248
    ds_read_b64_tr_b16 a[156:157], v13 offset:32768
    v_mfma_f32_16x16x32_bf16 v[120:123], a[132:135], v[72:75], v[120:123]
    v_exp_f32 v149, v149
    v_mfma_f32_16x16x32_bf16 v[124:127], a[132:135], v[76:79], v[124:127]
    ds_read_b64_tr_b16 a[158:159], v13 offset:36864
    v_cvt_pk_bf16_f32 v199, v146, v147
    v_mfma_f32_16x16x32_bf16 a[80:83], a[148:151], v[192:195], a[80:83]
    v_exp_f32 v150, v150
    v_mfma_f32_16x16x32_bf16 a[84:87], a[148:151], v[200:203], a[84:87]
    v_cvt_pk_bf16_f32 v206, v148, v149
    v_mfma_f32_16x16x32_bf16 a[88:91], a[148:151], v[208:211], a[88:91]
    v_exp_f32 v151, v151
    v_mfma_f32_16x16x32_bf16 a[92:95], a[148:151], v[216:219], a[92:95]
    s_add_u32 m0, s74, 69632
    s_mov_b32 s40, 34816
    buffer_load_dwordx4 v19, s[16:19], s40 offen sc1 lds
    s_waitcnt lgkmcnt(3)
    v_mfma_f32_16x16x32_bf16 v[112:115], a[136:139], v[48:51], v[112:115]
    v_exp_f32 v152, v152
    v_mfma_f32_16x16x32_bf16 v[116:119], a[136:139], v[52:55], v[116:119]
    ds_read_b128 a[128:131], v2 offset:57344
    ds_read_b64_tr_b16 a[144:145], v6 offset:40960
    v_mfma_f32_16x16x32_bf16 v[120:123], a[136:139], v[80:83], v[120:123]
    v_exp_f32 v153, v153
    v_mfma_f32_16x16x32_bf16 v[124:127], a[136:139], v[84:87], v[124:127]
    ds_read_b64_tr_b16 a[146:147], v6 offset:45056
    v_cvt_pk_bf16_f32 v207, v150, v151
    v_mfma_f32_16x16x32_bf16 a[96:99], a[152:155], v[192:195], a[96:99]
    v_exp_f32 v154, v154
    v_mfma_f32_16x16x32_bf16 a[100:103], a[152:155], v[200:203], a[100:103]
    v_cvt_pk_bf16_f32 v214, v152, v153
    v_mfma_f32_16x16x32_bf16 a[104:107], a[152:155], v[208:211], a[104:107]
    v_exp_f32 v155, v155
    v_mfma_f32_16x16x32_bf16 a[108:111], a[152:155], v[216:219], a[108:111]
    s_add_u32 m0, s74, 73728
    s_mov_b32 s40, 36864
    buffer_load_dwordx4 v19, s[16:19], s40 offen sc1 lds
    s_waitcnt lgkmcnt(3)
    v_mfma_f32_16x16x32_bf16 v[112:115], a[140:143], v[56:59], v[112:115]
    v_exp_f32 v156, v156
    v_mfma_f32_16x16x32_bf16 v[116:119], a[140:143], v[60:63], v[116:119]
    ds_read_b128 a[132:135], v3 offset:57344
    ds_read_b64_tr_b16 a[148:149], v7 offset:40960
    v_mfma_f32_16x16x32_bf16 v[120:123], a[140:143], v[88:91], v[120:123]
    v_exp_f32 v157, v157
    v_mfma_f32_16x16x32_bf16 v[124:127], a[140:143], v[92:95], v[124:127]
    ds_read_b64_tr_b16 a[150:151], v7 offset:45056
    v_cvt_pk_bf16_f32 v215, v154, v155
    v_mfma_f32_16x16x32_bf16 a[112:115], a[156:159], v[192:195], a[112:115]
    v_exp_f32 v158, v158
    v_mfma_f32_16x16x32_bf16 a[116:119], a[156:159], v[200:203], a[116:119]
    v_cvt_pk_bf16_f32 v222, v156, v157
    s_add_u32 m0, s74, 77824
    s_mov_b32 s40, 38912
    buffer_load_dwordx4 v19, s[16:19], s40 offen sc1 lds
    v_mfma_f32_16x16x32_bf16 a[120:123], a[156:159], v[208:211], a[120:123]
    v_exp_f32 v159, v159
    v_mfma_f32_16x16x32_bf16 a[124:127], a[156:159], v[216:219], a[124:127]
    s_mov_b32 s41, 4096
    buffer_load_dwordx4 a[176:179], v19, s[24:27], s41 offen sc1
    s_waitcnt lgkmcnt(3)
    v_mfma_f32_16x16x32_bf16 v[128:131], a[128:131], v[32:35], v[160:163]
    v_exp_f32 v96, v96
    v_mfma_f32_16x16x32_bf16 v[132:135], a[128:131], v[36:39], v[164:167]
    ds_read_b128 a[136:139], v4 offset:57344
    ds_read_b64_tr_b16 a[152:153], v8 offset:40960
    v_mfma_f32_16x16x32_bf16 v[136:139], a[128:131], v[64:67], v[168:171]
    v_exp_f32 v97, v97
    v_mfma_f32_16x16x32_bf16 v[140:143], a[128:131], v[68:71], v[172:175]
    ds_read_b64_tr_b16 a[154:155], v8 offset:45056
    v_cvt_pk_bf16_f32 v223, v158, v159
    v_smfmac_f32_16x16x64_bf16 v[176:179], v[20:23], v[192:199], v31
    v_exp_f32 v98, v98
    v_mfma_f32_16x16x32_bf16 a[0:3], a[144:147], v[196:199], a[0:3]
    v_cvt_pk_bf16_f32 v192, v96, v97
    v_mfma_f32_16x16x32_bf16 a[4:7], a[144:147], v[204:207], a[4:7]
    v_exp_f32 v99, v99
    v_mfma_f32_16x16x32_bf16 a[8:11], a[144:147], v[212:215], a[8:11]
    s_mov_b32 s41, 5120
wpad8:
    s_cmp_eq_u32 s98, 1
    s_cbranch_scc1 WARMA_done
    buffer_load_dwordx4 a[180:183], v19, s[24:27], s41 offen sc1
    v_mfma_f32_16x16x32_bf16 a[12:15], a[144:147], v[220:223], a[12:15]
    s_waitcnt lgkmcnt(3)
    v_mfma_f32_16x16x32_bf16 v[128:131], a[132:135], v[40:43], v[128:131]
    v_exp_f32 v100, v100
    v_mfma_f32_16x16x32_bf16 v[132:135], a[132:135], v[44:47], v[132:135]
    ds_read_b128 a[140:143], v5 offset:57344
    ds_read_b64_tr_b16 a[156:157], v9 offset:40960
    v_mfma_f32_16x16x32_bf16 v[136:139], a[132:135], v[72:75], v[136:139]
    v_exp_f32 v101, v101
    v_mfma_f32_16x16x32_bf16 v[140:143], a[132:135], v[76:79], v[140:143]
    ds_read_b64_tr_b16 a[158:159], v9 offset:45056
    v_cvt_pk_bf16_f32 v193, v98, v99
    v_smfmac_f32_16x16x64_bf16 v[180:183], v[20:23], v[200:207], v31
    v_exp_f32 v102, v102
    v_mfma_f32_16x16x32_bf16 a[16:19], a[148:151], v[196:199], a[16:19]
    v_cvt_pk_bf16_f32 v200, v100, v101
    v_mfma_f32_16x16x32_bf16 a[20:23], a[148:151], v[204:207], a[20:23]
    v_exp_f32 v103, v103
    v_mfma_f32_16x16x32_bf16 a[24:27], a[148:151], v[212:215], a[24:27]
    s_mov_b32 s41, 6144
    buffer_load_dwordx4 a[184:187], v19, s[24:27], s41 offen sc1
    v_mfma_f32_16x16x32_bf16 a[28:31], a[148:151], v[220:223], a[28:31]
    s_waitcnt lgkmcnt(3)
    v_mfma_f32_16x16x32_bf16 v[128:131], a[136:139], v[48:51], v[128:131]
    v_exp_f32 v104, v104
    v_mfma_f32_16x16x32_bf16 v[132:135], a[136:139], v[52:55], v[132:135]
    ds_read_b128 a[128:131], v2 offset:61440
    ds_read_b64_tr_b16 a[144:145], v10 offset:40960
    v_mfma_f32_16x16x32_bf16 v[136:139], a[136:139], v[80:83], v[136:139]
    v_exp_f32 v105, v105
    v_mfma_f32_16x16x32_bf16 v[140:143], a[136:139], v[84:87], v[140:143]
    ds_read_b64_tr_b16 a[146:147], v10 offset:45056
    v_cvt_pk_bf16_f32 v201, v102, v103
    v_smfmac_f32_16x16x64_bf16 v[184:187], v[20:23], v[208:215], v31
    v_exp_f32 v106, v106
    v_mfma_f32_16x16x32_bf16 a[32:35], a[152:155], v[196:199], a[32:35]
    v_cvt_pk_bf16_f32 v208, v104, v105
    s_mov_b32 s41, 7168
    buffer_load_dwordx4 a[188:191], v19, s[24:27], s41 offen sc1
    v_mfma_f32_16x16x32_bf16 a[36:39], a[152:155], v[204:207], a[36:39]
    v_exp_f32 v107, v107
    v_mfma_f32_16x16x32_bf16 a[40:43], a[152:155], v[212:215], a[40:43]
    s_mov_b32 s41, 8192
    buffer_load_dwordx4 a[192:195], v19, s[24:27], s41 offen sc1
    v_mfma_f32_16x16x32_bf16 a[44:47], a[152:155], v[220:223], a[44:47]
    s_waitcnt lgkmcnt(3)
    v_mfma_f32_16x16x32_bf16 v[128:131], a[140:143], v[56:59], v[128:131]
    v_exp_f32 v108, v108
    v_mfma_f32_16x16x32_bf16 v[132:135], a[140:143], v[60:63], v[132:135]
    ds_read_b128 a[132:135], v3 offset:61440
    ds_read_b64_tr_b16 a[148:149], v11 offset:40960
    v_mfma_f32_16x16x32_bf16 v[136:139], a[140:143], v[88:91], v[136:139]
    v_exp_f32 v109, v109
    v_mfma_f32_16x16x32_bf16 v[140:143], a[140:143], v[92:95], v[140:143]
    ds_read_b64_tr_b16 a[150:151], v11 offset:45056
    v_cvt_pk_bf16_f32 v209, v106, v107
    v_smfmac_f32_16x16x64_bf16 v[188:191], v[20:23], v[216:223], v31
    v_exp_f32 v110, v110
    v_mfma_f32_16x16x32_bf16 a[48:51], a[156:159], v[196:199], a[48:51]
    v_cvt_pk_bf16_f32 v216, v108, v109
    v_mfma_f32_16x16x32_bf16 a[52:55], a[156:159], v[204:207], a[52:55]
    v_exp_f32 v111, v111
    v_mfma_f32_16x16x32_bf16 a[56:59], a[156:159], v[212:215], a[56:59]
    s_mov_b32 s41, 9216
    buffer_load_dwordx4 a[196:199], v19, s[24:27], s41 offen sc1
    v_mfma_f32_16x16x32_bf16 a[60:63], a[156:159], v[220:223], a[60:63]
    s_waitcnt lgkmcnt(3)
    v_mfma_f32_16x16x32_bf16 v[144:147], a[128:131], v[32:35], v[160:163]
    v_exp_f32 v112, v112
    v_mfma_f32_16x16x32_bf16 v[148:151], a[128:131], v[36:39], v[164:167]
    ds_read_b128 a[136:139], v4 offset:61440
    ds_read_b64_tr_b16 a[152:153], v12 offset:40960
    v_mfma_f32_16x16x32_bf16 v[152:155], a[128:131], v[64:67], v[168:171]
    v_exp_f32 v113, v113
    v_mfma_f32_16x16x32_bf16 v[156:159], a[128:131], v[68:71], v[172:175]
    ds_read_b64_tr_b16 a[154:155], v12 offset:45056
    v_cvt_pk_bf16_f32 v217, v110, v111
    v_mfma_f32_16x16x32_bf16 a[64:67], a[144:147], v[196:199], a[64:67]
    v_exp_f32 v114, v114
    v_mfma_f32_16x16x32_bf16 a[68:71], a[144:147], v[204:207], a[68:71]
    v_cvt_pk_bf16_f32 v194, v112, v113
    v_mfma_f32_16x16x32_bf16 a[72:75], a[144:147], v[212:215], a[72:75]
    v_exp_f32 v115, v115
    v_mfma_f32_16x16x32_bf16 a[76:79], a[144:147], v[220:223], a[76:79]
    s_mov_b32 s41, 10240
    buffer_load_dwordx4 a[200:203], v19, s[24:27], s41 offen sc1
    s_waitcnt lgkmcnt(3)
    v_mfma_f32_16x16x32_bf16 v[144:147], a[132:135], v[40:43], v[144:147]
    v_exp_f32 v116, v116
    v_mfma_f32_16x16x32_bf16 v[148:151], a[132:135], v[44:47], v[148:151]
    ds_read_b128 a[140:143], v5 offset:61440
    ds_read_b64_tr_b16 a[156:157], v13 offset:40960
    v_mfma_f32_16x16x32_bf16 v[152:155], a[132:135], v[72:75], v[152:155]
    v_exp_f32 v117, v117
    v_mfma_f32_16x16x32_bf16 v[156:159], a[132:135], v[76:79], v[156:159]
    ds_read_b64_tr_b16 a[158:159], v13 offset:45056
    v_cvt_pk_bf16_f32 v195, v114, v115
    v_mfma_f32_16x16x32_bf16 a[80:83], a[148:151], v[196:199], a[80:83]
    v_exp_f32 v118, v118
    v_mfma_f32_16x16x32_bf16 a[84:87], a[148:151], v[204:207], a[84:87]
    v_cvt_pk_bf16_f32 v202, v116, v117
    s_mov_b32 s41, 11264
    buffer_load_dwordx4 a[204:207], v19, s[24:27], s41 offen sc1
    v_mfma_f32_16x16x32_bf16 a[88:91], a[148:151], v[212:215], a[88:91]
    v_exp_f32 v119, v119
    v_mfma_f32_16x16x32_bf16 a[92:95], a[148:151], v[220:223], a[92:95]
    s_mov_b32 s41, 12288
    buffer_load_dwordx4 a[208:211], v19, s[24:27], s41 offen sc1
    s_waitcnt lgkmcnt(3)
    v_mfma_f32_16x16x32_bf16 v[144:147], a[136:139], v[48:51], v[144:147]
    s_waitcnt vmcnt(30)
    s_waitcnt lgkmcnt(0)
    s_barrier
    v_exp_f32 v120, v120
    v_mfma_f32_16x16x32_bf16 v[148:151], a[136:139], v[52:55], v[148:151]
    ds_read_b64_tr_b16 a[144:145], v6 offset:49152
    ds_read_b64_tr_b16 a[146:147], v6 offset:53248
    v_mfma_f32_16x16x32_bf16 v[152:155], a[136:139], v[80:83], v[152:155]
    v_exp_f32 v121, v121
    v_mfma_f32_16x16x32_bf16 v[156:159], a[136:139], v[84:87], v[156:159]
    v_cvt_pk_bf16_f32 v203, v118, v119
    v_mfma_f32_16x16x32_bf16 a[96:99], a[152:155], v[196:199], a[96:99]
    v_exp_f32 v122, v122
    v_mfma_f32_16x16x32_bf16 a[100:103], a[152:155], v[204:207], a[100:103]
    v_cvt_pk_bf16_f32 v210, v120, v121
    v_mfma_f32_16x16x32_bf16 a[104:107], a[152:155], v[212:215], a[104:107]
    v_exp_f32 v123, v123
    v_mfma_f32_16x16x32_bf16 a[108:111], a[152:155], v[220:223], a[108:111]
    s_add_u32 m0, s74, 32768
    s_mov_b32 s40, 40960
    buffer_load_dwordx4 v19, s[16:19], s40 offen sc1 lds
    v_mfma_f32_16x16x32_bf16 v[144:147], a[140:143], v[56:59], v[144:147]
    v_exp_f32 v124, v124
    v_mfma_f32_16x16x32_bf16 v[148:151], a[140:143], v[60:63], v[148:151]
    ds_read_b64_tr_b16 a[148:149], v7 offset:49152
    ds_read_b64_tr_b16 a[150:151], v7 offset:53248
    v_mfma_f32_16x16x32_bf16 v[152:155], a[140:143], v[88:91], v[152:155]
    v_exp_f32 v125, v125
    v_mfma_f32_16x16x32_bf16 v[156:159], a[140:143], v[92:95], v[156:159]
    v_cvt_pk_bf16_f32 v211, v122, v123
    v_mfma_f32_16x16x32_bf16 a[112:115], a[156:159], v[196:199], a[112:115]
    v_exp_f32 v126, v126
    v_mfma_f32_16x16x32_bf16 a[116:119], a[156:159], v[204:207], a[116:119]
    v_cvt_pk_bf16_f32 v218, v124, v125
    v_mfma_f32_16x16x32_bf16 a[120:123], a[156:159], v[212:215], a[120:123]
    v_exp_f32 v127, v127
    v_mfma_f32_16x16x32_bf16 a[124:127], a[156:159], v[220:223], a[124:127]
    s_add_u32 m0, s74, 36864
    s_mov_b32 s40, 43008
    buffer_load_dwordx4 v19, s[16:19], s40 offen sc1 lds
    s_waitcnt lgkmcnt(2)
    v_mfma_f32_16x16x32_bf16 a[0:3], a[144:147], v[192:195], a[0:3]
    v_exp_f32 v128, v128
    ds_read_b64_tr_b16 a[152:153], v8 offset:49152
    v_mfma_f32_16x16x32_bf16 a[4:7], a[144:147], v[200:203], a[4:7]
    v_exp_f32 v129, v129
    v_cvt_pk_bf16_f32 v219, v126, v127
    v_mfma_f32_16x16x32_bf16 a[8:11], a[144:147], v[208:211], a[8:11]
    ds_read_b64_tr_b16 a[154:155], v8 offset:53248
    v_exp_f32 v130, v130
    s_add_u32 m0, s74, 40960
    s_mov_b32 s40, 45056
    buffer_load_dwordx4 v19, s[16:19], s40 offen sc1 lds
    v_mfma_f32_16x16x32_bf16 a[12:15], a[144:147], v[216:219], a[12:15]
    v_cvt_pk_bf16_f32 v196, v128, v129
    v_exp_f32 v131, v131
    s_add_u32 m0, s74, 45056
    s_mov_b32 s40, 47104
    buffer_load_dwordx4 v19, s[16:19], s40 offen sc1 lds
    s_waitcnt lgkmcnt(2)
    v_mfma_f32_16x16x32_bf16 a[16:19], a[148:151], v[192:195], a[16:19]
    v_exp_f32 v132, v132
    ds_read_b64_tr_b16 a[156:157], v9 offset:49152
    v_mfma_f32_16x16x32_bf16 a[20:23], a[148:151], v[200:203], a[20:23]
    v_exp_f32 v133, v133
    v_cvt_pk_bf16_f32 v197, v130, v131
    v_mfma_f32_16x16x32_bf16 a[24:27], a[148:151], v[208:211], a[24:27]
    ds_read_b64_tr_b16 a[158:159], v9 offset:53248
    v_exp_f32 v134, v134
    v_mfma_f32_16x16x32_bf16 a[28:31], a[148:151], v[216:219], a[28:31]
    v_cvt_pk_bf16_f32 v204, v132, v133
    v_exp_f32 v135, v135
    s_add_u32 m0, s74, 49152
    s_mov_b32 s40, 49152
    buffer_load_dwordx4 v19, s[16:19], s40 offen sc1 lds
    s_waitcnt lgkmcnt(2)
    v_mfma_f32_16x16x32_bf16 a[32:35], a[152:155], v[192:195], a[32:35]
    v_exp_f32 v136, v136
    ds_read_b64_tr_b16 a[144:145], v10 offset:49152
    v_mfma_f32_16x16x32_bf16 a[36:39], a[152:155], v[200:203], a[36:39]
    v_exp_f32 v137, v137
    v_cvt_pk_bf16_f32 v205, v134, v135
    v_mfma_f32_16x16x32_bf16 a[40:43], a[152:155], v[208:211], a[40:43]
    ds_read_b64_tr_b16 a[146:147], v10 offset:53248
    v_exp_f32 v138, v138
    s_add_u32 m0, s74, 53248
    s_mov_b32 s40, 51200
    buffer_load_dwordx4 v19, s[16:19], s40 offen sc1 lds
    v_mfma_f32_16x16x32_bf16 a[44:47], a[152:155], v[216:219], a[44:47]
    v_cvt_pk_bf16_f32 v212, v136, v137
    v_exp_f32 v139, v139
    s_add_u32 m0, s74, 57344
    s_mov_b32 s40, 53248
    buffer_load_dwordx4 v19, s[16:19], s40 offen sc1 lds
    s_waitcnt lgkmcnt(2)
    v_mfma_f32_16x16x32_bf16 a[48:51], a[156:159], v[192:195], a[48:51]
    v_exp_f32 v140, v140
    ds_read_b64_tr_b16 a[148:149], v11 offset:49152
    v_mfma_f32_16x16x32_bf16 a[52:55], a[156:159], v[200:203], a[52:55]
    v_exp_f32 v141, v141
    v_cvt_pk_bf16_f32 v213, v138, v139
    v_mfma_f32_16x16x32_bf16 a[56:59], a[156:159], v[208:211], a[56:59]
    ds_read_b64_tr_b16 a[150:151], v11 offset:53248
    v_exp_f32 v142, v142
    v_mfma_f32_16x16x32_bf16 a[60:63], a[156:159], v[216:219], a[60:63]
    v_cvt_pk_bf16_f32 v220, v140, v141
    v_exp_f32 v143, v143
    s_add_u32 m0, s74, 61440
    s_mov_b32 s40, 55296
    buffer_load_dwordx4 v19, s[16:19], s40 offen sc1 lds
    s_waitcnt lgkmcnt(2)
    v_mfma_f32_16x16x32_bf16 a[64:67], a[144:147], v[192:195], a[64:67]
    v_exp_f32 v144, v144
    ds_read_b64_tr_b16 a[152:153], v12 offset:49152
    v_mfma_f32_16x16x32_bf16 a[68:71], a[144:147], v[200:203], a[68:71]
    v_exp_f32 v145, v145
    v_cvt_pk_bf16_f32 v221, v142, v143
    v_mfma_f32_16x16x32_bf16 a[72:75], a[144:147], v[208:211], a[72:75]
    ds_read_b64_tr_b16 a[154:155], v12 offset:53248
    v_exp_f32 v146, v146
    s_mov_b32 s41, 13312
    buffer_load_dwordx4 a[212:215], v19, s[24:27], s41 offen sc1
    v_mfma_f32_16x16x32_bf16 a[76:79], a[144:147], v[216:219], a[76:79]
    v_cvt_pk_bf16_f32 v198, v144, v145
    v_exp_f32 v147, v147
    s_mov_b32 s41, 14336
    buffer_load_dwordx4 a[216:219], v19, s[24:27], s41 offen sc1
    s_waitcnt lgkmcnt(2)
    v_mfma_f32_16x16x32_bf16 a[80:83], a[148:151], v[192:195], a[80:83]
    v_exp_f32 v148, v148
    ds_read_b64_tr_b16 a[156:157], v13 offset:49152
    v_mfma_f32_16x16x32_bf16 a[84:87], a[148:151], v[200:203], a[84:87]
    v_exp_f32 v149, v149
    v_cvt_pk_bf16_f32 v199, v146, v147
    v_mfma_f32_16x16x32_bf16 a[88:91], a[148:151], v[208:211], a[88:91]
    ds_read_b64_tr_b16 a[158:159], v13 offset:53248
    v_exp_f32 v150, v150
    v_mfma_f32_16x16x32_bf16 a[92:95], a[148:151], v[216:219], a[92:95]
    v_cvt_pk_bf16_f32 v206, v148, v149
    v_exp_f32 v151, v151
    s_mov_b32 s41, 15360
    buffer_load_dwordx4 a[220:223], v19, s[24:27], s41 offen sc1
    s_waitcnt lgkmcnt(2)
    v_mfma_f32_16x16x32_bf16 a[96:99], a[152:155], v[192:195], a[96:99]
    v_exp_f32 v152, v152
    ds_read_b64_tr_b16 a[144:145], v6 offset:57344
    v_mfma_f32_16x16x32_bf16 a[100:103], a[152:155], v[200:203], a[100:103]
    v_exp_f32 v153, v153
    v_cvt_pk_bf16_f32 v207, v150, v151
    v_mfma_f32_16x16x32_bf16 a[104:107], a[152:155], v[208:211], a[104:107]
    ds_read_b64_tr_b16 a[146:147], v6 offset:61440
    v_exp_f32 v154, v154
    s_mov_b32 s41, 16384
    buffer_load_dwordx4 a[224:227], v19, s[24:27], s41 offen sc1
    v_mfma_f32_16x16x32_bf16 a[108:111], a[152:155], v[216:219], a[108:111]
    v_cvt_pk_bf16_f32 v214, v152, v153
    v_exp_f32 v155, v155
    s_mov_b32 s41, 17408
    buffer_load_dwordx4 a[228:231], v19, s[24:27], s41 offen sc1
    s_waitcnt lgkmcnt(2)
    v_mfma_f32_16x16x32_bf16 a[112:115], a[156:159], v[192:195], a[112:115]
    v_exp_f32 v156, v156
    ds_read_b64_tr_b16 a[148:149], v7 offset:57344
    v_mfma_f32_16x16x32_bf16 a[116:119], a[156:159], v[200:203], a[116:119]
    v_exp_f32 v157, v157
    v_cvt_pk_bf16_f32 v215, v154, v155
    v_mfma_f32_16x16x32_bf16 a[120:123], a[156:159], v[208:211], a[120:123]
    ds_read_b64_tr_b16 a[150:151], v7 offset:61440
    v_exp_f32 v158, v158
    v_mfma_f32_16x16x32_bf16 a[124:127], a[156:159], v[216:219], a[124:127]
    v_cvt_pk_bf16_f32 v222, v156, v157
    v_exp_f32 v159, v159
    s_mov_b32 s41, 18432
    buffer_load_dwordx4 a[232:235], v19, s[24:27], s41 offen sc1
    s_mov_b64 s[44:45], 0
    s_waitcnt lgkmcnt(2)
    v_smfmac_f32_16x16x64_bf16 v[176:179], v[20:23], v[192:199], v31
    ds_read_b64_tr_b16 a[152:153], v8 offset:57344
    v_mfma_f32_16x16x32_bf16 a[0:3], a[144:147], v[196:199], a[0:3]
    v_cvt_pk_bf16_f32 v223, v158, v159
    v_mfma_f32_16x16x32_bf16 a[4:7], a[144:147], v[204:207], a[4:7]
    ds_read_b64_tr_b16 a[154:155], v8 offset:61440
    v_mfma_f32_16x16x32_bf16 a[8:11], a[144:147], v[212:215], a[8:11]
    v_mfma_f32_16x16x32_bf16 a[12:15], a[144:147], v[220:223], a[12:15]
    s_mov_b32 s41, 19456
    buffer_load_dwordx4 a[236:239], v19, s[24:27], s41 offen sc1
    s_waitcnt lgkmcnt(2)
    v_smfmac_f32_16x16x64_bf16 v[180:183], v[20:23], v[200:207], v31
    ds_read_b64_tr_b16 a[156:157], v9 offset:57344
    v_mfma_f32_16x16x32_bf16 a[16:19], a[148:151], v[196:199], a[16:19]
    ds_read_b64_tr_b16 a[158:159], v9 offset:61440
    v_mfma_f32_16x16x32_bf16 a[20:23], a[148:151], v[204:207], a[20:23]
    ds_read_b64_tr_b16 v[224:225], v249 offset:0
    v_mfma_f32_16x16x32_bf16 a[24:27], a[148:151], v[212:215], a[24:27]
    ds_read_b64_tr_b16 v[226:227], v249 offset:1024
    v_mfma_f32_16x16x32_bf16 a[28:31], a[148:151], v[220:223], a[28:31]
    s_mov_b32 s41, 20480
    buffer_load_dwordx4 a[240:243], v19, s[24:27], s41 offen sc1
    ds_read_b64_tr_b16 v[228:229], v250 offset:0
    s_waitcnt lgkmcnt(5)
    v_smfmac_f32_16x16x64_bf16 v[184:187], v[20:23], v[208:215], v31
    ds_read_b64_tr_b16 a[144:145], v10 offset:57344
    v_mfma_f32_16x16x32_bf16 a[32:35], a[152:155], v[196:199], a[32:35]
    ds_read_b64_tr_b16 a[146:147], v10 offset:61440
    v_mfma_f32_16x16x32_bf16 a[36:39], a[152:155], v[204:207], a[36:39]
    ds_read_b64_tr_b16 v[230:231], v250 offset:1024
    v_mfma_f32_16x16x32_bf16 a[40:43], a[152:155], v[212:215], a[40:43]
    ds_read_b64_tr_b16 v[232:233], v249 offset:2048
    v_mfma_f32_16x16x32_bf16 a[44:47], a[152:155], v[220:223], a[44:47]
    s_mov_b32 s41, 21504
    buffer_load_dwordx4 a[244:247], v19, s[24:27], s41 offen sc1
    ds_read_b64_tr_b16 v[234:235], v249 offset:3072
    s_waitcnt lgkmcnt(8)
    v_smfmac_f32_16x16x64_bf16 v[188:191], v[20:23], v[216:223], v31
    ds_read_b64_tr_b16 a[148:149], v11 offset:57344
    v_mfma_f32_16x16x32_bf16 a[48:51], a[156:159], v[196:199], a[48:51]
    ds_read_b64_tr_b16 a[150:151], v11 offset:61440
    v_add_f32 v176, v176, v177
    v_rcp_f32 v24, v176
    v_cmp_ngt_f32 vcc, 0x4e800000, v176
    v_accvgpr_read_b32 v160, a0
    v_accvgpr_read_b32 v161, a1
    s_or_b64 s[44:45], s[44:45], vcc
    v_accvgpr_read_b32 v162, a2
    v_mfma_f32_16x16x32_bf16 a[52:55], a[156:159], v[204:207], a[52:55]
    ds_read_b64_tr_b16 v[236:237], v250 offset:2048
    v_accvgpr_read_b32 v163, a3
    v_accvgpr_read_b32 v164, a16
    v_accvgpr_read_b32 v165, a17
    v_accvgpr_read_b32 v166, a18
    v_accvgpr_read_b32 v167, a19
    v_max3_f32 v28, |v160|, |v161|, |v162|
    v_max3_f32 v28, |v163|, |v164|, v28
    v_max3_f32 v28, |v165|, |v166|, v28
    v_mfma_f32_16x16x32_bf16 a[56:59], a[156:159], v[212:215], a[56:59]
    ds_read_b64_tr_b16 v[238:239], v250 offset:3072
    v_max_f32_e64 v28, |v167|, v28
    v_cmp_gt_f32 vcc, 0x0d800000, v28
    v_mul_f32 v160, v160, v24
    v_mul_f32 v161, v161, v24
    s_or_b64 s[44:45], s[44:45], vcc
    v_mul_f32 v162, v162, v24
    v_mul_f32 v163, v163, v24
    v_mul_f32 v164, v164, v24
    v_mfma_f32_16x16x32_bf16 a[60:63], a[156:159], v[220:223], a[60:63]
    s_mov_b32 s41, 22528
    buffer_load_dwordx4 a[248:251], v19, s[24:27], s41 offen sc1
    v_mul_f32 v165, v165, v24
    v_mul_f32 v166, v166, v24
    v_mul_f32 v167, v167, v24
    v_cvt_pk_bf16_f32 v192, v160, v161
    v_cvt_pk_bf16_f32 v193, v162, v163
    v_cvt_pk_bf16_f32 v194, v164, v165
    v_cvt_pk_bf16_f32 v195, v166, v167
    s_mov_b32 s43, 0
    buffer_store_dwordx4 v[192:195], v248, s[20:23], s43 offen offset:0 sc1
    s_waitcnt lgkmcnt(7)
    v_mfma_f32_16x16x32_bf16 a[64:67], a[144:147], v[196:199], a[64:67]
    ds_read_b64_tr_b16 a[152:153], v12 offset:57344
    v_mfma_f32_16x16x32_bf16 a[68:71], a[144:147], v[204:207], a[68:71]
    ds_read_b64_tr_b16 a[154:155], v12 offset:61440
    v_mfma_f32_16x16x32_bf16 a[72:75], a[144:147], v[212:215], a[72:75]
    v_mfma_f32_16x16x32_bf16 a[76:79], a[144:147], v[220:223], a[76:79]
    s_mov_b32 s41, 23552
    buffer_load_dwordx4 a[252:255], v19, s[24:27], s41 offen sc1
    s_waitcnt lgkmcnt(4)
    v_mfma_f32_16x16x32_bf16 a[80:83], a[148:151], v[196:199], a[80:83]
    ds_read_b64_tr_b16 a[156:157], v13 offset:57344
    v_mfma_f32_16x16x32_bf16 a[84:87], a[148:151], v[204:207], a[84:87]
    ds_read_b64_tr_b16 a[158:159], v13 offset:61440
    v_accvgpr_read_b32 v168, a32
    v_accvgpr_read_b32 v169, a33
    v_accvgpr_read_b32 v170, a34
    v_accvgpr_read_b32 v171, a35
    v_accvgpr_read_b32 v172, a48
    v_accvgpr_read_b32 v173, a49
    v_accvgpr_read_b32 v174, a50
    v_accvgpr_read_b32 v175, a51
    v_mfma_f32_16x16x32_bf16 a[88:91], a[148:151], v[212:215], a[88:91]
    v_mul_f32 v168, v168, v24
    v_mul_f32 v169, v169, v24
    v_mul_f32 v170, v170, v24
    v_mul_f32 v171, v171, v24
    v_mul_f32 v172, v172, v24
    v_mul_f32 v173, v173, v24
    v_mul_f32 v174, v174, v24
    v_mul_f32 v175, v175, v24
    v_mfma_f32_16x16x32_bf16 a[92:95], a[148:151], v[220:223], a[92:95]
    s_mov_b32 s41, 24576
    buffer_load_dwordx4 a[128:131], v19, s[24:27], s41 offen sc1
    v_cvt_pk_bf16_f32 v200, v168, v169
    v_cvt_pk_bf16_f32 v201, v170, v171
    v_cvt_pk_bf16_f32 v202, v172, v173
    v_cvt_pk_bf16_f32 v203, v174, v175
    s_mov_b32 s43, 0
    buffer_store_dwordx4 v[200:203], v248, s[20:23], s43 offen offset:2048 sc1
    v_add_f32 v180, v180, v181
    v_rcp_f32 v25, v180
    s_waitcnt lgkmcnt(2)
    v_mfma_f32_16x16x32_bf16 a[96:99], a[152:155], v[196:199], a[96:99]
    v_cmp_ngt_f32 vcc, 0x4e800000, v180
    v_accvgpr_read_b32 v160, a4
    v_accvgpr_read_b32 v161, a5
    s_or_b64 s[44:45], s[44:45], vcc
    v_accvgpr_read_b32 v162, a6
    v_accvgpr_read_b32 v163, a7
    v_accvgpr_read_b32 v164, a20
    v_accvgpr_read_b32 v165, a21
    v_mfma_f32_16x16x32_bf16 a[100:103], a[152:155], v[204:207], a[100:103]
    v_accvgpr_read_b32 v166, a22
    v_accvgpr_read_b32 v167, a23
    v_max3_f32 v28, |v160|, |v161|, |v162|
    v_max3_f32 v28, |v163|, |v164|, v28
    v_max3_f32 v28, |v165|, |v166|, v28
    v_max_f32_e64 v28, |v167|, v28
    v_cmp_gt_f32 vcc, 0x0d800000, v28
    v_mul_f32 v160, v160, v25
    v_mfma_f32_16x16x32_bf16 a[104:107], a[152:155], v[212:215], a[104:107]
    v_mul_f32 v161, v161, v25
    s_or_b64 s[44:45], s[44:45], vcc
    v_mul_f32 v162, v162, v25
    v_mul_f32 v163, v163, v25
    v_mul_f32 v164, v164, v25
    v_mul_f32 v165, v165, v25
    v_mul_f32 v166, v166, v25
    v_mul_f32 v167, v167, v25
    v_mfma_f32_16x16x32_bf16 a[108:111], a[152:155], v[220:223], a[108:111]
    s_mov_b32 s41, 25600
    buffer_load_dwordx4 a[132:135], v19, s[24:27], s41 offen sc1
    v_cvt_pk_bf16_f32 v192, v160, v161
    v_cvt_pk_bf16_f32 v193, v162, v163
    v_cvt_pk_bf16_f32 v194, v164, v165
    v_cvt_pk_bf16_f32 v195, v166, v167
    s_mov_b32 s43, 0
    buffer_store_dwordx4 v[192:195], v248, s[20:23], s43 offen offset:256 sc1
    v_accvgpr_read_b32 v168, a36
    v_accvgpr_read_b32 v169, a37
    s_waitcnt lgkmcnt(0)
    v_mfma_f32_16x16x32_bf16 a[112:115], a[156:159], v[196:199], a[112:115]
    v_accvgpr_read_b32 v170, a38
    v_accvgpr_read_b32 v171, a39
    v_accvgpr_read_b32 v172, a52
    v_accvgpr_read_b32 v173, a53
    v_accvgpr_read_b32 v174, a54
    v_accvgpr_read_b32 v175, a55
    v_mul_f32 v168, v168, v25
    v_mul_f32 v169, v169, v25
    v_mfma_f32_16x16x32_bf16 a[116:119], a[156:159], v[204:207], a[116:119]
    v_mul_f32 v170, v170, v25
    v_mul_f32 v171, v171, v25
    v_mul_f32 v172, v172, v25
    v_mul_f32 v173, v173, v25
    v_mul_f32 v174, v174, v25
    v_mul_f32 v175, v175, v25
    v_cvt_pk_bf16_f32 v200, v168, v169
    v_cvt_pk_bf16_f32 v201, v170, v171
    v_mfma_f32_16x16x32_bf16 a[120:123], a[156:159], v[212:215], a[120:123]
    v_cvt_pk_bf16_f32 v202, v172, v173
    v_cvt_pk_bf16_f32 v203, v174, v175
    s_mov_b32 s43, 0
    buffer_store_dwordx4 v[200:203], v248, s[20:23], s43 offen offset:2304 sc1
    v_accvgpr_read_b32 v160, a64
    v_accvgpr_read_b32 v161, a65
    v_accvgpr_read_b32 v162, a66
    v_accvgpr_read_b32 v163, a67
    v_mfma_f32_16x16x32_bf16 a[124:127], a[156:159], v[220:223], a[124:127]
    s_mov_b32 s41, 26624
    buffer_load_dwordx4 a[136:139], v19, s[24:27], s41 offen sc1
    v_accvgpr_read_b32 v164, a80
    v_accvgpr_read_b32 v165, a81
    v_accvgpr_read_b32 v166, a82
    v_accvgpr_read_b32 v167, a83
    v_mul_f32 v160, v160, v24
    v_mul_f32 v161, v161, v24
    v_mul_f32 v162, v162, v24
    v_mul_f32 v163, v163, v24
    s_waitcnt vmcnt(50)
    v_mfma_f32_32x32x16_bf16 v[96:111], v[224:227], a[160:163], 0
    ds_read_b64_tr_b16 v[208:209], v249 offset:4096
    ds_read_b64_tr_b16 v[210:211], v249 offset:5120
    v_mul_f32 v164, v164, v24
    v_mul_f32 v165, v165, v24
    v_mul_f32 v166, v166, v24
    v_mul_f32 v167, v167, v24
    v_cvt_pk_bf16_f32 v192, v160, v161
    v_cvt_pk_bf16_f32 v193, v162, v163
    v_cvt_pk_bf16_f32 v194, v164, v165
    v_cvt_pk_bf16_f32 v195, v166, v167
    s_mov_b32 s43, 4096
    buffer_store_dwordx4 v[192:195], v248, s[20:23], s43 offen offset:0 sc1
    v_accvgpr_read_b32 v168, a68
    v_accvgpr_read_b32 v169, a69
    v_accvgpr_read_b32 v170, a70
    v_accvgpr_read_b32 v171, a71
    v_accvgpr_read_b32 v172, a84
    v_accvgpr_read_b32 v173, a85
    v_accvgpr_read_b32 v174, a86
    v_accvgpr_read_b32 v175, a87
    v_mul_f32 v168, v168, v25
    v_mul_f32 v169, v169, v25
    v_mul_f32 v170, v170, v25
    v_mul_f32 v171, v171, v25
    v_mul_f32 v172, v172, v25
    v_mul_f32 v173, v173, v25
    v_mul_f32 v174, v174, v25
    v_mul_f32 v175, v175, v25
    v_cvt_pk_bf16_f32 v200, v168, v169
    v_cvt_pk_bf16_f32 v201, v170, v171
    v_cvt_pk_bf16_f32 v202, v172, v173
    v_cvt_pk_bf16_f32 v203, v174, v175
    s_mov_b32 s43, 4096
    buffer_store_dwordx4 v[200:203], v248, s[20:23], s43 offen offset:256 sc1
    v_add_f32 v184, v184, v185
    v_rcp_f32 v26, v184
    v_cmp_ngt_f32 vcc, 0x4e800000, v184
    v_accvgpr_read_b32 v160, a8
    v_accvgpr_read_b32 v161, a9
    s_or_b64 s[44:45], s[44:45], vcc
    v_accvgpr_read_b32 v162, a10
    v_accvgpr_read_b32 v163, a11
    v_accvgpr_read_b32 v164, a24
    v_accvgpr_read_b32 v165, a25
    v_accvgpr_read_b32 v166, a26
    v_accvgpr_read_b32 v167, a27
    v_max3_f32 v28, |v160|, |v161|, |v162|
    v_max3_f32 v28, |v163|, |v164|, v28
    v_max3_f32 v28, |v165|, |v166|, v28
    v_max_f32_e64 v28, |v167|, v28
    v_cmp_gt_f32 vcc, 0x0d800000, v28
    v_mul_f32 v160, v160, v26
    v_mul_f32 v161, v161, v26
    s_or_b64 s[44:45], s[44:45], vcc
    v_mul_f32 v162, v162, v26
    v_mul_f32 v163, v163, v26
    v_mul_f32 v164, v164, v26
    v_mul_f32 v165, v165, v26
    v_mul_f32 v166, v166, v26
    v_mul_f32 v167, v167, v26
    v_cvt_pk_bf16_f32 v192, v160, v161
    v_cvt_pk_bf16_f32 v193, v162, v163
    v_cvt_pk_bf16_f32 v194, v164, v165
    v_cvt_pk_bf16_f32 v195, v166, v167
    s_mov_b32 s43, 262144
    buffer_store_dwordx4 v[192:195], v248, s[20:23], s43 offen offset:0 sc1
    v_accvgpr_read_b32 v168, a40
    v_accvgpr_read_b32 v169, a41
    v_accvgpr_read_b32 v170, a42
    v_accvgpr_read_b32 v171, a43
    v_accvgpr_read_b32 v172, a56
    v_accvgpr_read_b32 v173, a57
    v_accvgpr_read_b32 v174, a58
    v_accvgpr_read_b32 v175, a59
    v_mul_f32 v168, v168, v26
    v_mul_f32 v169, v169, v26
    v_mul_f32 v170, v170, v26
    v_mul_f32 v171, v171, v26
    v_mul_f32 v172, v172, v26
    v_mul_f32 v173, v173, v26
    v_mul_f32 v174, v174, v26
    v_mul_f32 v175, v175, v26
    v_cvt_pk_bf16_f32 v200, v168, v169
    v_cvt_pk_bf16_f32 v201, v170, v171
    v_cvt_pk_bf16_f32 v202, v172, v173
    v_cvt_pk_bf16_f32 v203, v174, v175
    s_mov_b32 s43, 262144
    buffer_store_dwordx4 v[200:203], v248, s[20:23], s43 offen offset:2048 sc1
    v_accvgpr_read_b32 v160, a72
    v_accvgpr_read_b32 v161, a73
    v_accvgpr_read_b32 v162, a74
    v_accvgpr_read_b32 v163, a75
    v_accvgpr_read_b32 v164, a88
    v_accvgpr_read_b32 v165, a89
    v_accvgpr_read_b32 v166, a90
    v_accvgpr_read_b32 v167, a91
    v_mul_f32 v160, v160, v26
    v_mul_f32 v161, v161, v26
    v_mul_f32 v162, v162, v26
    v_mul_f32 v163, v163, v26
    v_mul_f32 v164, v164, v26
    v_mul_f32 v165, v165, v26
    v_mul_f32 v166, v166, v26
    v_mul_f32 v167, v167, v26
    v_cvt_pk_bf16_f32 v192, v160, v161
    v_cvt_pk_bf16_f32 v193, v162, v163
    v_cvt_pk_bf16_f32 v194, v164, v165
    v_cvt_pk_bf16_f32 v195, v166, v167
    s_mov_b32 s43, 266240
    buffer_store_dwordx4 v[192:195], v248, s[20:23], s43 offen offset:0 sc1
wpad9:
    s_cmp_eq_u32 s98, 1
    s_cbranch_scc1 WARMA_done
    v_accvgpr_read_b32 v168, a96
    v_accvgpr_read_b32 v169, a97
    v_accvgpr_read_b32 v170, a98
    v_accvgpr_read_b32 v171, a99
    v_accvgpr_read_b32 v172, a112
    v_accvgpr_read_b32 v173, a113
    v_accvgpr_read_b32 v174, a114
    v_accvgpr_read_b32 v175, a115
    v_mul_f32 v168, v168, v24
    v_mul_f32 v169, v169, v24
    v_mul_f32 v170, v170, v24
    v_mul_f32 v171, v171, v24
    v_mul_f32 v172, v172, v24
    v_mul_f32 v173, v173, v24
    v_mul_f32 v174, v174, v24
    v_mul_f32 v175, v175, v24
    v_cvt_pk_bf16_f32 v200, v168, v169
    v_cvt_pk_bf16_f32 v201, v170, v171
    v_cvt_pk_bf16_f32 v202, v172, v173
    v_cvt_pk_bf16_f32 v203, v174, v175
    s_mov_b32 s43, 4096
    buffer_store_dwordx4 v[200:203], v248, s[20:23], s43 offen offset:2048 sc1
    v_accvgpr_read_b32 v160, a100
    v_accvgpr_read_b32 v161, a101
    v_accvgpr_read_b32 v162, a102
    v_accvgpr_read_b32 v163, a103
    v_accvgpr_read_b32 v164, a116
    v_accvgpr_read_b32 v165, a117
    v_accvgpr_read_b32 v166, a118
    v_accvgpr_read_b32 v167, a119
    v_mul_f32 v160, v160, v25
    v_mul_f32 v161, v161, v25
    v_mul_f32 v162, v162, v25
    v_mul_f32 v163, v163, v25
    v_mul_f32 v164, v164, v25
    v_mul_f32 v165, v165, v25
    v_mul_f32 v166, v166, v25
    v_mul_f32 v167, v167, v25
    v_cvt_pk_bf16_f32 v192, v160, v161
    v_cvt_pk_bf16_f32 v193, v162, v163
    v_cvt_pk_bf16_f32 v194, v164, v165
    v_cvt_pk_bf16_f32 v195, v166, v167
    s_mov_b32 s43, 4096
    buffer_store_dwordx4 v[192:195], v248, s[20:23], s43 offen offset:2304 sc1
    v_accvgpr_read_b32 v168, a104
    v_accvgpr_read_b32 v169, a105
    v_accvgpr_read_b32 v170, a106
    v_accvgpr_read_b32 v171, a107
    v_accvgpr_read_b32 v172, a120
    v_accvgpr_read_b32 v173, a121
    v_accvgpr_read_b32 v174, a122
    v_accvgpr_read_b32 v175, a123
    v_mul_f32 v168, v168, v26
    v_mul_f32 v169, v169, v26
    v_mul_f32 v170, v170, v26
    v_mul_f32 v171, v171, v26
    v_mul_f32 v172, v172, v26
    v_mul_f32 v173, v173, v26
    v_mul_f32 v174, v174, v26
    v_mul_f32 v175, v175, v26
    v_cvt_pk_bf16_f32 v200, v168, v169
    v_cvt_pk_bf16_f32 v201, v170, v171
    v_cvt_pk_bf16_f32 v202, v172, v173
    v_cvt_pk_bf16_f32 v203, v174, v175
    s_mov_b32 s43, 266240
    buffer_store_dwordx4 v[200:203], v248, s[20:23], s43 offen offset:2048 sc1
    v_add_f32 v188, v188, v189
    v_rcp_f32 v27, v188
    v_cmp_ngt_f32 vcc, 0x4e800000, v188
    v_accvgpr_read_b32 v160, a12
    v_accvgpr_read_b32 v161, a13
    s_or_b64 s[44:45], s[44:45], vcc
    v_accvgpr_read_b32 v162, a14
    v_accvgpr_read_b32 v163, a15
    v_accvgpr_read_b32 v164, a28
    v_accvgpr_read_b32 v165, a29
    v_accvgpr_read_b32 v166, a30
    v_accvgpr_read_b32 v167, a31
    v_max3_f32 v28, |v160|, |v161|, |v162|
    v_max3_f32 v28, |v163|, |v164|, v28
    v_max3_f32 v28, |v165|, |v166|, v28
    v_max_f32_e64 v28, |v167|, v28
    v_cmp_gt_f32 vcc, 0x0d800000, v28
    v_mul_f32 v160, v160, v27
    v_mul_f32 v161, v161, v27
    s_or_b64 s[44:45], s[44:45], vcc
    v_mul_f32 v162, v162, v27
    v_mul_f32 v163, v163, v27
    v_mul_f32 v164, v164, v27
    v_mul_f32 v165, v165, v27
    v_mul_f32 v166, v166, v27
    v_mul_f32 v167, v167, v27
    v_cvt_pk_bf16_f32 v192, v160, v161
    v_cvt_pk_bf16_f32 v193, v162, v163
    v_cvt_pk_bf16_f32 v194, v164, v165
    v_cvt_pk_bf16_f32 v195, v166, v167
    s_mov_b32 s43, 262144
    buffer_store_dwordx4 v[192:195], v248, s[20:23], s43 offen offset:256 sc1
    v_accvgpr_read_b32 v168, a44
    v_accvgpr_read_b32 v169, a45
    v_accvgpr_read_b32 v170, a46
    v_accvgpr_read_b32 v171, a47
    v_accvgpr_read_b32 v172, a60
    v_accvgpr_read_b32 v173, a61
    v_accvgpr_read_b32 v174, a62
    v_accvgpr_read_b32 v175, a63
    v_mul_f32 v168, v168, v27
    v_mul_f32 v169, v169, v27
    v_mul_f32 v170, v170, v27
    v_mul_f32 v171, v171, v27
    v_mul_f32 v172, v172, v27
    v_mul_f32 v173, v173, v27
    v_mul_f32 v174, v174, v27
    v_mul_f32 v175, v175, v27
    v_cvt_pk_bf16_f32 v200, v168, v169
    v_cvt_pk_bf16_f32 v201, v170, v171
    v_cvt_pk_bf16_f32 v202, v172, v173
    v_cvt_pk_bf16_f32 v203, v174, v175
    s_mov_b32 s43, 262144
    buffer_store_dwordx4 v[200:203], v248, s[20:23], s43 offen offset:2304 sc1
    v_accvgpr_read_b32 v160, a76
    v_accvgpr_read_b32 v161, a77
    v_accvgpr_read_b32 v162, a78
    v_accvgpr_read_b32 v163, a79
    v_accvgpr_read_b32 v164, a92
    v_accvgpr_read_b32 v165, a93
    v_accvgpr_read_b32 v166, a94
    v_accvgpr_read_b32 v167, a95
    v_mul_f32 v160, v160, v27
    v_mul_f32 v161, v161, v27
    v_mul_f32 v162, v162, v27
    v_mul_f32 v163, v163, v27
    v_mul_f32 v164, v164, v27
    v_mul_f32 v165, v165, v27
    v_mul_f32 v166, v166, v27
    v_mul_f32 v167, v167, v27
    v_cvt_pk_bf16_f32 v192, v160, v161
    v_cvt_pk_bf16_f32 v193, v162, v163
    v_cvt_pk_bf16_f32 v194, v164, v165
    v_cvt_pk_bf16_f32 v195, v166, v167
    v_mfma_f32_32x32x16_bf16 v[112:127], v[228:231], a[160:163], 0
    ds_read_b64_tr_b16 v[212:213], v250 offset:4096
    ds_read_b64_tr_b16 v[214:215], v250 offset:5120
    s_mov_b32 s43, 266240
    buffer_store_dwordx4 v[192:195], v248, s[20:23], s43 offen offset:256 sc1
    v_accvgpr_read_b32 v168, a108
    v_accvgpr_read_b32 v169, a109
    v_accvgpr_read_b32 v170, a110
    v_accvgpr_read_b32 v171, a111
    v_accvgpr_read_b32 v172, a124
    v_accvgpr_read_b32 v173, a125
    v_accvgpr_read_b32 v174, a126
    v_accvgpr_read_b32 v175, a127
    v_mul_f32 v168, v168, v27
    v_mul_f32 v169, v169, v27
    v_mul_f32 v170, v170, v27
    v_mul_f32 v171, v171, v27
    v_mul_f32 v172, v172, v27
    v_mul_f32 v173, v173, v27
    v_mul_f32 v174, v174, v27
    v_mul_f32 v175, v175, v27
    v_cvt_pk_bf16_f32 v200, v168, v169
    v_cvt_pk_bf16_f32 v201, v170, v171
    v_cvt_pk_bf16_f32 v202, v172, v173
    v_cvt_pk_bf16_f32 v203, v174, v175
    s_mov_b32 s43, 266240
    buffer_store_dwordx4 v[200:203], v248, s[20:23], s43 offen offset:2304 sc1
    s_cmp_lg_u64 s[44:45], 0
    s_cselect_b32 s3, 1, 0
    s_andn2_b32 s3, s3, s42
    v_mov_b32 v29, s3
    s_lshl_b32 s3, s34, 2
    s_add_u32 s3, s3, 110592
    v_mov_b32 v30, s3
    v_mov_b32 v25, 110592
    ds_write_b32 v30, v29
    v_mfma_f32_32x32x16_bf16 v[128:143], v[232:235], a[160:163], 0
    ds_read_b64_tr_b16 v[216:217], v249 offset:6144
    ds_read_b64_tr_b16 v[218:219], v249 offset:7168
    v_mfma_f32_32x32x16_bf16 v[144:159], v[236:239], a[160:163], 0
    ds_read_b64_tr_b16 v[220:221], v250 offset:6144
    ds_read_b64_tr_b16 v[222:223], v250 offset:7168
    s_waitcnt vmcnt(61)
    s_waitcnt lgkmcnt(7)
    v_mfma_f32_32x32x16_bf16 v[96:111], v[208:211], a[164:167], v[96:111]
    ds_read_b64_tr_b16 v[224:225], v249 offset:8192
    ds_read_b64_tr_b16 v[226:227], v249 offset:9216
    s_waitcnt lgkmcnt(7)
    v_mfma_f32_32x32x16_bf16 v[112:127], v[212:215], a[164:167], v[112:127]
    ds_read_b64_tr_b16 v[228:229], v250 offset:8192
    ds_read_b64_tr_b16 v[230:231], v250 offset:9216
    s_waitcnt lgkmcnt(6)
    v_mfma_f32_32x32x16_bf16 v[128:143], v[216:219], a[164:167], v[128:143]
    ds_read_b64_tr_b16 v[232:233], v249 offset:10240
    ds_read_b64_tr_b16 v[234:235], v249 offset:11264
    s_waitcnt lgkmcnt(6)
    v_mfma_f32_32x32x16_bf16 v[144:159], v[220:223], a[164:167], v[144:159]
    ds_read_b64_tr_b16 v[236:237], v250 offset:10240
    ds_read_b64_tr_b16 v[238:239], v250 offset:11264
    s_waitcnt vmcnt(56)
    s_barrier
    ds_read_b128 v[28:31], v25
    s_waitcnt lgkmcnt(7)
    v_mfma_f32_32x32x16_bf16 v[96:111], v[224:227], a[168:171], v[96:111]
    ds_read_b64_tr_b16 v[208:209], v249 offset:12288
    ds_read_b64_tr_b16 v[210:211], v249 offset:13312
    s_waitcnt lgkmcnt(7)
    v_mfma_f32_32x32x16_bf16 v[112:127], v[228:231], a[168:171], v[112:127]
    ds_read_b64_tr_b16 v[212:213], v250 offset:12288
    ds_read_b64_tr_b16 v[214:215], v250 offset:13312
    s_waitcnt lgkmcnt(7)
    v_mfma_f32_32x32x16_bf16 v[128:143], v[232:235], a[168:171], v[128:143]
    ds_read_b64_tr_b16 v[216:217], v249 offset:14336
    ds_read_b64_tr_b16 v[218:219], v249 offset:15360
    s_waitcnt lgkmcnt(7)
    v_mfma_f32_32x32x16_bf16 v[144:159], v[236:239], a[168:171], v[144:159]
    ds_read_b64_tr_b16 v[220:221], v250 offset:14336
    ds_read_b64_tr_b16 v[222:223], v250 offset:15360
    s_waitcnt lgkmcnt(8)
    v_or3_b32 v28, v28, v29, v30
    v_or_b32 v28, v28, v31
    s_nop 0
    v_readfirstlane_b32 s3, v28
    s_nop 3
    s_cmp_lg_u32 s3, 0
    s_cbranch_scc1 attn_fallback
    s_waitcnt lgkmcnt(6)
    v_mfma_f32_32x32x16_bf16 v[96:111], v[208:211], a[172:175], v[96:111]
    ds_read_b64_tr_b16 v[224:225], v249 offset:16384
    ds_read_b64_tr_b16 v[226:227], v249 offset:17408
    s_waitcnt lgkmcnt(6)
    v_mfma_f32_32x32x16_bf16 v[112:127], v[212:215], a[172:175], v[112:127]
    ds_read_b64_tr_b16 v[228:229], v250 offset:16384
    ds_read_b64_tr_b16 v[230:231], v250 offset:17408
    s_waitcnt lgkmcnt(6)
    v_mfma_f32_32x32x16_bf16 v[128:143], v[216:219], a[172:175], v[128:143]
    ds_read_b64_tr_b16 v[232:233], v249 offset:18432
    ds_read_b64_tr_b16 v[234:235], v249 offset:19456
    s_waitcnt lgkmcnt(6)
    v_mfma_f32_32x32x16_bf16 v[144:159], v[220:223], a[172:175], v[144:159]
    ds_read_b64_tr_b16 v[236:237], v250 offset:18432
    ds_read_b64_tr_b16 v[238:239], v250 offset:19456
    s_waitcnt vmcnt(46)
    s_waitcnt lgkmcnt(6)
    v_mfma_f32_32x32x16_bf16 v[96:111], v[224:227], a[176:179], v[96:111]
    ds_read_b64_tr_b16 v[208:209], v249 offset:20480
    ds_read_b64_tr_b16 v[210:211], v249 offset:21504
    s_waitcnt lgkmcnt(6)
    v_mfma_f32_32x32x16_bf16 v[112:127], v[228:231], a[176:179], v[112:127]
    ds_read_b64_tr_b16 v[212:213], v250 offset:20480
    ds_read_b64_tr_b16 v[214:215], v250 offset:21504
    s_waitcnt lgkmcnt(6)
    v_mfma_f32_32x32x16_bf16 v[128:143], v[232:235], a[176:179], v[128:143]
    ds_read_b64_tr_b16 v[216:217], v249 offset:22528
    ds_read_b64_tr_b16 v[218:219], v249 offset:23552
    s_waitcnt lgkmcnt(6)
    v_mfma_f32_32x32x16_bf16 v[144:159], v[236:239], a[176:179], v[144:159]
    ds_read_b64_tr_b16 v[220:221], v250 offset:22528
    ds_read_b64_tr_b16 v[222:223], v250 offset:23552
    s_waitcnt vmcnt(45)
    s_waitcnt lgkmcnt(6)
    v_mfma_f32_32x32x16_bf16 v[96:111], v[208:211], a[180:183], v[96:111]
    ds_read_b64_tr_b16 v[224:225], v249 offset:24576
    ds_read_b64_tr_b16 v[226:227], v249 offset:25600
    s_waitcnt lgkmcnt(6)
    v_mfma_f32_32x32x16_bf16 v[112:127], v[212:215], a[180:183], v[112:127]
    ds_read_b64_tr_b16 v[228:229], v250 offset:24576
    ds_read_b64_tr_b16 v[230:231], v250 offset:25600
    s_waitcnt lgkmcnt(6)
    v_mfma_f32_32x32x16_bf16 v[128:143], v[216:219], a[180:183], v[128:143]
    ds_read_b64_tr_b16 v[232:233], v249 offset:26624
    ds_read_b64_tr_b16 v[234:235], v249 offset:27648
    s_waitcnt lgkmcnt(6)
    v_mfma_f32_32x32x16_bf16 v[144:159], v[220:223], a[180:183], v[144:159]
    ds_read_b64_tr_b16 v[236:237], v250 offset:26624
    ds_read_b64_tr_b16 v[238:239], v250 offset:27648
    s_waitcnt vmcnt(44)
    s_waitcnt lgkmcnt(6)
    v_mfma_f32_32x32x16_bf16 v[96:111], v[224:227], a[184:187], v[96:111]
    ds_read_b64_tr_b16 v[208:209], v249 offset:28672
    ds_read_b64_tr_b16 v[210:211], v249 offset:29696
    s_waitcnt lgkmcnt(6)
    v_mfma_f32_32x32x16_bf16 v[112:127], v[228:231], a[184:187], v[112:127]
    ds_read_b64_tr_b16 v[212:213], v250 offset:28672
    ds_read_b64_tr_b16 v[214:215], v250 offset:29696
    s_waitcnt lgkmcnt(6)
    v_mfma_f32_32x32x16_bf16 v[128:143], v[232:235], a[184:187], v[128:143]
    ds_read_b64_tr_b16 v[216:217], v249 offset:30720
    ds_read_b64_tr_b16 v[218:219], v249 offset:31744
    s_waitcnt lgkmcnt(6)
    v_mfma_f32_32x32x16_bf16 v[144:159], v[236:239], a[184:187], v[144:159]
    ds_read_b64_tr_b16 v[220:221], v250 offset:30720
    ds_read_b64_tr_b16 v[222:223], v250 offset:31744
    s_waitcnt vmcnt(43)
    s_waitcnt lgkmcnt(6)
    v_mfma_f32_32x32x16_bf16 v[96:111], v[208:211], a[188:191], v[96:111]
    ds_read_b64_tr_b16 v[224:225], v240 offset:0
    ds_read_b64_tr_b16 v[226:227], v240 offset:1024
    s_waitcnt lgkmcnt(6)
    v_mfma_f32_32x32x16_bf16 v[112:127], v[212:215], a[188:191], v[112:127]
    ds_read_b64_tr_b16 v[228:229], v241 offset:0
    ds_read_b64_tr_b16 v[230:231], v241 offset:1024
    s_waitcnt lgkmcnt(6)
    v_mfma_f32_32x32x16_bf16 v[128:143], v[216:219], a[188:191], v[128:143]
    ds_read_b64_tr_b16 v[232:233], v240 offset:2048
    ds_read_b64_tr_b16 v[234:235], v240 offset:3072
    s_waitcnt lgkmcnt(6)
    v_mfma_f32_32x32x16_bf16 v[144:159], v[220:223], a[188:191], v[144:159]
    ds_read_b64_tr_b16 v[236:237], v241 offset:2048
    ds_read_b64_tr_b16 v[238:239], v241 offset:3072
    s_waitcnt vmcnt(0)
    v_mov_b32 v25, 1
    s_mov_b64 exec, 1
    global_store_dword v247, v25, s[56:57] sc1
    s_mov_b64 exec, -1
    s_mov_b32 s41, 27648
    buffer_load_dwordx4 a[140:143], v19, s[24:27], s41 offen sc1
    s_add_u32 m0, s74, 81920
    s_mov_b32 s40, 57344
    buffer_load_dwordx4 v19, s[16:19], s40 offen sc1 lds
    s_waitcnt lgkmcnt(6)
    v_mfma_f32_32x32x16_bf16 v[96:111], v[224:227], a[192:195], v[96:111]
    ds_read_b64_tr_b16 v[208:209], v240 offset:4096
    ds_read_b64_tr_b16 v[210:211], v240 offset:5120
    s_add_u32 m0, s74, 86016
    s_mov_b32 s40, 59392
    buffer_load_dwordx4 v19, s[16:19], s40 offen sc1 lds
    s_waitcnt lgkmcnt(6)
    v_mfma_f32_32x32x16_bf16 v[112:127], v[228:231], a[192:195], v[112:127]
    ds_read_b64_tr_b16 v[212:213], v241 offset:4096
    ds_read_b64_tr_b16 v[214:215], v241 offset:5120
    s_waitcnt lgkmcnt(6)
    v_mfma_f32_32x32x16_bf16 v[128:143], v[232:235], a[192:195], v[128:143]
    ds_read_b64_tr_b16 v[216:217], v240 offset:6144
    ds_read_b64_tr_b16 v[218:219], v240 offset:7168
    s_add_u32 m0, s74, 90112
    s_mov_b32 s40, 61440
    buffer_load_dwordx4 v19, s[16:19], s40 offen sc1 lds
    s_waitcnt lgkmcnt(6)
    v_mfma_f32_32x32x16_bf16 v[144:159], v[236:239], a[192:195], v[144:159]
    ds_read_b64_tr_b16 v[220:221], v241 offset:6144
    ds_read_b64_tr_b16 v[222:223], v241 offset:7168
    s_lshl_b32 s3, s72, 16
    s_lshl_b32 s58, s73, 7
    s_add_u32 s3, s3, s58
    s_add_u32 s64, s84, s3
    s_addc_u32 s65, s85, 0
    s_sub_u32 s66, 2097152, s3
    s_mov_b32 s67, 0x20000
    s_add_u32 s68, s90, s3
    s_addc_u32 s69, s91, 0
    s_sub_u32 s70, 2097152, s3
    s_mov_b32 s71, 0x20000
    s_waitcnt lgkmcnt(6)
    v_mfma_f32_32x32x16_bf16 v[96:111], v[208:211], a[196:199], v[96:111]
    ds_read_b64_tr_b16 v[224:225], v240 offset:8192
    ds_read_b64_tr_b16 v[226:227], v240 offset:9216
    s_add_u32 m0, s74, 94208
    s_mov_b32 s40, 63488
    buffer_load_dwordx4 v19, s[16:19], s40 offen sc1 lds
    s_waitcnt lgkmcnt(6)
    v_mfma_f32_32x32x16_bf16 v[112:127], v[212:215], a[196:199], v[112:127]
    ds_read_b64_tr_b16 v[228:229], v241 offset:8192
    ds_read_b64_tr_b16 v[230:231], v241 offset:9216
    s_waitcnt lgkmcnt(6)
    v_mfma_f32_32x32x16_bf16 v[128:143], v[216:219], a[196:199], v[128:143]
    ds_read_b64_tr_b16 v[232:233], v240 offset:10240
    ds_read_b64_tr_b16 v[234:235], v240 offset:11264
    s_add_u32 m0, s74, 98304
    s_mov_b32 s40, 65536
    buffer_load_dwordx4 v19, s[16:19], s40 offen sc1 lds
    s_waitcnt lgkmcnt(6)
    v_mfma_f32_32x32x16_bf16 v[144:159], v[220:223], a[196:199], v[144:159]
    ds_read_b64_tr_b16 v[236:237], v241 offset:10240
    ds_read_b64_tr_b16 v[238:239], v241 offset:11264
    s_and_b32 s3, s34, 1
    s_lshl_b32 s3, s3, 15
    s_lshr_b32 s58, s34, 1
    s_lshl_b32 s58, s58, 6
    s_add_u32 s3, s3, s58
    v_and_b32 v29, 0x1f0, v19
    v_lshlrev_b32 v29, 6, v29
    v_lshrrev_b32 v30, 5, v19
    v_and_b32 v30, 16, v30
    v_add3_u32 v244, v29, v30, s3
    s_barrier
    s_waitcnt lgkmcnt(6)
    v_mfma_f32_32x32x16_bf16 v[96:111], v[224:227], a[200:203], v[96:111]
    ds_read_b64_tr_b16 v[208:209], v240 offset:12288
    ds_read_b64_tr_b16 v[210:211], v240 offset:13312
    s_add_u32 m0, s74, 102400
    s_mov_b32 s40, 67584
    buffer_load_dwordx4 v19, s[16:19], s40 offen sc1 lds
    s_waitcnt lgkmcnt(6)
    v_mfma_f32_32x32x16_bf16 v[112:127], v[228:231], a[200:203], v[112:127]
    ds_read_b64_tr_b16 v[212:213], v241 offset:12288
    ds_read_b64_tr_b16 v[214:215], v241 offset:13312
    s_waitcnt lgkmcnt(6)
    v_mfma_f32_32x32x16_bf16 v[128:143], v[232:235], a[200:203], v[128:143]
    ds_read_b64_tr_b16 v[216:217], v240 offset:14336
    ds_read_b64_tr_b16 v[218:219], v240 offset:15360
    s_add_u32 m0, s74, 106496
    s_mov_b32 s40, 69632
    buffer_load_dwordx4 v19, s[16:19], s40 offen sc1 lds
    s_waitcnt lgkmcnt(6)
    v_mfma_f32_32x32x16_bf16 v[144:159], v[236:239], a[200:203], v[144:159]
    ds_read_b64_tr_b16 v[220:221], v241 offset:14336
    ds_read_b64_tr_b16 v[222:223], v241 offset:15360
    s_lshr_b32 s3, s72, 1
    s_lshl_b32 s3, s3, 2
    s_lshr_b32 s58, s73, 1
    s_add_u32 s3, s3, s58
    s_lshl_b32 s59, s3, 18
    s_add_u32 s59, s59, 50331648
    s_lshr_b32 s3, s34, 1
    s_lshl_b32 s3, s3, 16
    s_and_b32 s58, s34, 1
    s_lshl_b32 s58, s58, 11
    s_add_u32 s3, s3, s58
    s_and_b32 s58, s72, 1
    s_lshl_b32 s58, s58, 13
    s_add_u32 s3, s3, s58
    s_and_b32 s58, s73, 1
    s_lshl_b32 s58, s58, 14
    s_add_u32 s3, s3, s58
    s_sub_u32 s10, 262144, s3
    s_add_u32 s3, s3, s59
    s_add_u32 s8, s56, s3
    s_addc_u32 s9, s57, 0
    s_mov_b32 s11, 0x20000
    s_waitcnt lgkmcnt(6)
    v_mfma_f32_32x32x16_bf16 v[96:111], v[208:211], a[204:207], v[96:111]
    ds_read_b64_tr_b16 v[224:225], v240 offset:16384
    ds_read_b64_tr_b16 v[226:227], v240 offset:17408
    s_add_u32 m0, s74, 110592
    s_mov_b32 s40, 71680
    buffer_load_dwordx4 v19, s[16:19], s40 offen sc1 lds
    s_waitcnt lgkmcnt(6)
    v_mfma_f32_32x32x16_bf16 v[112:127], v[212:215], a[204:207], v[112:127]
    ds_read_b64_tr_b16 v[228:229], v241 offset:16384
    ds_read_b64_tr_b16 v[230:231], v241 offset:17408
    s_waitcnt lgkmcnt(6)
    v_mfma_f32_32x32x16_bf16 v[128:143], v[216:219], a[204:207], v[128:143]
    ds_read_b64_tr_b16 v[232:233], v240 offset:18432
    ds_read_b64_tr_b16 v[234:235], v240 offset:19456
    s_add_u32 m0, s74, 114688
    s_mov_b32 s40, 73728
    buffer_load_dwordx4 v19, s[16:19], s40 offen sc1 lds
    s_waitcnt lgkmcnt(6)
    v_mfma_f32_32x32x16_bf16 v[144:159], v[220:223], a[204:207], v[144:159]
    ds_read_b64_tr_b16 v[236:237], v241 offset:18432
    ds_read_b64_tr_b16 v[238:239], v241 offset:19456
    s_waitcnt lgkmcnt(6)
    v_mfma_f32_32x32x16_bf16 v[96:111], v[224:227], a[208:211], v[96:111]
    ds_read_b64_tr_b16 v[208:209], v240 offset:20480
    ds_read_b64_tr_b16 v[210:211], v240 offset:21504
    s_add_u32 m0, s74, 118784
    s_mov_b32 s40, 75776
    buffer_load_dwordx4 v19, s[16:19], s40 offen sc1 lds
    s_waitcnt lgkmcnt(6)
    v_mfma_f32_32x32x16_bf16 v[112:127], v[228:231], a[208:211], v[112:127]
    ds_read_b64_tr_b16 v[212:213], v241 offset:20480
    ds_read_b64_tr_b16 v[214:215], v241 offset:21504
    s_waitcnt lgkmcnt(6)
    v_mfma_f32_32x32x16_bf16 v[128:143], v[232:235], a[208:211], v[128:143]
    ds_read_b64_tr_b16 v[216:217], v240 offset:22528
    ds_read_b64_tr_b16 v[218:219], v240 offset:23552
    s_add_u32 m0, s74, 122880
    s_mov_b32 s40, 77824
    buffer_load_dwordx4 v19, s[16:19], s40 offen sc1 lds
    s_waitcnt lgkmcnt(6)
    v_mfma_f32_32x32x16_bf16 v[144:159], v[236:239], a[208:211], v[144:159]
    ds_read_b64_tr_b16 v[220:221], v241 offset:22528
    ds_read_b64_tr_b16 v[222:223], v241 offset:23552
    s_waitcnt lgkmcnt(6)
    v_mfma_f32_32x32x16_bf16 v[96:111], v[208:211], a[212:215], v[96:111]
    ds_read_b64_tr_b16 v[224:225], v240 offset:24576
    ds_read_b64_tr_b16 v[226:227], v240 offset:25600
    s_add_u32 m0, s74, 126976
    s_mov_b32 s40, 79872
    buffer_load_dwordx4 v19, s[16:19], s40 offen sc1 lds
    s_waitcnt lgkmcnt(6)
    v_mfma_f32_32x32x16_bf16 v[112:127], v[212:215], a[212:215], v[112:127]
    ds_read_b64_tr_b16 v[228:229], v241 offset:24576
    ds_read_b64_tr_b16 v[230:231], v241 offset:25600
    s_waitcnt lgkmcnt(6)
    v_mfma_f32_32x32x16_bf16 v[128:143], v[216:219], a[212:215], v[128:143]
    ds_read_b64_tr_b16 v[232:233], v240 offset:26624
    ds_read_b64_tr_b16 v[234:235], v240 offset:27648
    s_add_u32 m0, s74, 131072
    s_mov_b32 s40, 81920
    buffer_load_dwordx4 v19, s[16:19], s40 offen sc1 lds
    s_waitcnt lgkmcnt(6)
    v_mfma_f32_32x32x16_bf16 v[144:159], v[220:223], a[212:215], v[144:159]
    ds_read_b64_tr_b16 v[236:237], v241 offset:26624
    ds_read_b64_tr_b16 v[238:239], v241 offset:27648
    s_waitcnt lgkmcnt(6)
    v_mfma_f32_32x32x16_bf16 v[96:111], v[224:227], a[216:219], v[96:111]
    ds_read_b64_tr_b16 v[208:209], v240 offset:28672
    ds_read_b64_tr_b16 v[210:211], v240 offset:29696
    s_add_u32 m0, s74, 135168
    s_mov_b32 s40, 83968
    buffer_load_dwordx4 v19, s[16:19], s40 offen sc1 lds
    s_waitcnt lgkmcnt(6)
    v_mfma_f32_32x32x16_bf16 v[112:127], v[228:231], a[216:219], v[112:127]
    ds_read_b64_tr_b16 v[212:213], v241 offset:28672
    ds_read_b64_tr_b16 v[214:215], v241 offset:29696
    s_waitcnt lgkmcnt(6)
    v_mfma_f32_32x32x16_bf16 v[128:143], v[232:235], a[216:219], v[128:143]
    ds_read_b64_tr_b16 v[216:217], v240 offset:30720
    ds_read_b64_tr_b16 v[218:219], v240 offset:31744
    s_add_u32 m0, s74, 139264
    s_mov_b32 s40, 86016
    buffer_load_dwordx4 v19, s[16:19], s40 offen sc1 lds
    s_waitcnt lgkmcnt(6)
    v_mfma_f32_32x32x16_bf16 v[144:159], v[236:239], a[216:219], v[144:159]
    ds_read_b64_tr_b16 v[220:221], v241 offset:30720
    ds_read_b64_tr_b16 v[222:223], v241 offset:31744
    s_waitcnt lgkmcnt(6)
    v_mfma_f32_32x32x16_bf16 v[96:111], v[208:211], a[220:223], v[96:111]
    ds_read_b64_tr_b16 v[224:225], v242 offset:0
    ds_read_b64_tr_b16 v[226:227], v242 offset:1024
    s_add_u32 m0, s74, 143360
    s_mov_b32 s40, 88064
    buffer_load_dwordx4 v19, s[16:19], s40 offen sc1 lds
    s_waitcnt lgkmcnt(6)
    v_mfma_f32_32x32x16_bf16 v[112:127], v[212:215], a[220:223], v[112:127]
    ds_read_b64_tr_b16 v[228:229], v243 offset:0
    ds_read_b64_tr_b16 v[230:231], v243 offset:1024
    s_waitcnt lgkmcnt(6)
    v_mfma_f32_32x32x16_bf16 v[128:143], v[216:219], a[220:223], v[128:143]
    ds_read_b64_tr_b16 v[232:233], v242 offset:2048
    ds_read_b64_tr_b16 v[234:235], v242 offset:3072
    s_add_u32 m0, s74, 147456
    s_mov_b32 s40, 90112
    buffer_load_dwordx4 v19, s[16:19], s40 offen sc1 lds
    s_waitcnt lgkmcnt(6)
    v_mfma_f32_32x32x16_bf16 v[144:159], v[220:223], a[220:223], v[144:159]
    ds_read_b64_tr_b16 v[236:237], v243 offset:2048
    ds_read_b64_tr_b16 v[238:239], v243 offset:3072
    s_waitcnt lgkmcnt(6)
    v_mfma_f32_32x32x16_bf16 v[96:111], v[224:227], a[224:227], v[96:111]
    ds_read_b64_tr_b16 v[208:209], v242 offset:4096
    ds_read_b64_tr_b16 v[210:211], v242 offset:5120
    s_add_u32 m0, s74, 151552
    s_mov_b32 s40, 92160
    buffer_load_dwordx4 v19, s[16:19], s40 offen sc1 lds
    s_waitcnt lgkmcnt(6)
    v_mfma_f32_32x32x16_bf16 v[112:127], v[228:231], a[224:227], v[112:127]
    ds_read_b64_tr_b16 v[212:213], v243 offset:4096
    ds_read_b64_tr_b16 v[214:215], v243 offset:5120
    s_waitcnt lgkmcnt(6)
    v_mfma_f32_32x32x16_bf16 v[128:143], v[232:235], a[224:227], v[128:143]
    ds_read_b64_tr_b16 v[216:217], v242 offset:6144
    ds_read_b64_tr_b16 v[218:219], v242 offset:7168
    s_add_u32 m0, s74, 155648
    s_mov_b32 s40, 94208
    buffer_load_dwordx4 v19, s[16:19], s40 offen sc1 lds
    s_waitcnt lgkmcnt(6)
    v_mfma_f32_32x32x16_bf16 v[144:159], v[236:239], a[224:227], v[144:159]
    ds_read_b64_tr_b16 v[220:221], v243 offset:6144
    ds_read_b64_tr_b16 v[222:223], v243 offset:7168
    s_waitcnt lgkmcnt(6)
    v_mfma_f32_32x32x16_bf16 v[96:111], v[208:211], a[228:231], v[96:111]
    ds_read_b64_tr_b16 v[224:225], v242 offset:8192
    ds_read_b64_tr_b16 v[226:227], v242 offset:9216
    s_add_u32 m0, s74, 159744
    s_mov_b32 s40, 96256
    buffer_load_dwordx4 v19, s[16:19], s40 offen sc1 lds
    s_waitcnt lgkmcnt(6)
    v_mfma_f32_32x32x16_bf16 v[112:127], v[212:215], a[228:231], v[112:127]
    ds_read_b64_tr_b16 v[228:229], v243 offset:8192
    ds_read_b64_tr_b16 v[230:231], v243 offset:9216
    s_waitcnt lgkmcnt(6)
    v_mfma_f32_32x32x16_bf16 v[128:143], v[216:219], a[228:231], v[128:143]
    ds_read_b64_tr_b16 v[232:233], v242 offset:10240
    ds_read_b64_tr_b16 v[234:235], v242 offset:11264
    s_add_u32 m0, s74, 0
    s_mov_b32 s40, 98304
    buffer_load_dwordx4 v19, s[16:19], s40 offen sc1 lds
    s_waitcnt lgkmcnt(6)
    v_mfma_f32_32x32x16_bf16 v[144:159], v[220:223], a[228:231], v[144:159]
    ds_read_b64_tr_b16 v[236:237], v243 offset:10240
    ds_read_b64_tr_b16 v[238:239], v243 offset:11264
    s_waitcnt lgkmcnt(6)
    v_mfma_f32_32x32x16_bf16 v[96:111], v[224:227], a[232:235], v[96:111]
    ds_read_b64_tr_b16 v[208:209], v242 offset:12288
    ds_read_b64_tr_b16 v[210:211], v242 offset:13312
    v_mov_b32 v251, 0
    global_load_dword v251, v246, s[56:57] sc1
    s_add_u32 m0, s74, 4096
    s_mov_b32 s40, 100352
    buffer_load_dwordx4 v19, s[16:19], s40 offen sc1 lds
    s_waitcnt lgkmcnt(6)
    v_mfma_f32_32x32x16_bf16 v[112:127], v[228:231], a[232:235], v[112:127]
    ds_read_b64_tr_b16 v[212:213], v243 offset:12288
    ds_read_b64_tr_b16 v[214:215], v243 offset:13312
    s_waitcnt lgkmcnt(6)
    v_mfma_f32_32x32x16_bf16 v[128:143], v[232:235], a[232:235], v[128:143]
    ds_read_b64_tr_b16 v[216:217], v242 offset:14336
    ds_read_b64_tr_b16 v[218:219], v242 offset:15360
    s_waitcnt lgkmcnt(6)
    v_mfma_f32_32x32x16_bf16 v[144:159], v[236:239], a[232:235], v[144:159]
    ds_read_b64_tr_b16 v[220:221], v243 offset:14336
    ds_read_b64_tr_b16 v[222:223], v243 offset:15360
    s_waitcnt lgkmcnt(6)
    v_mfma_f32_32x32x16_bf16 v[96:111], v[208:211], a[236:239], v[96:111]
    ds_read_b64_tr_b16 v[224:225], v240 offset:32768
wpad10:
    s_cmp_eq_u32 s98, 1
    s_cbranch_scc1 WARMA_done
    ds_read_b64_tr_b16 v[226:227], v240 offset:33792
    s_waitcnt lgkmcnt(6)
    v_mfma_f32_32x32x16_bf16 v[112:127], v[212:215], a[236:239], v[112:127]
    ds_read_b64_tr_b16 v[228:229], v241 offset:32768
    ds_read_b64_tr_b16 v[230:231], v241 offset:33792
    s_waitcnt lgkmcnt(6)
    v_mfma_f32_32x32x16_bf16 v[128:143], v[216:219], a[236:239], v[128:143]
    ds_read_b64_tr_b16 v[232:233], v240 offset:34816
    ds_read_b64_tr_b16 v[234:235], v240 offset:35840
    s_waitcnt lgkmcnt(6)
    v_mfma_f32_32x32x16_bf16 v[144:159], v[220:223], a[236:239], v[144:159]
    ds_read_b64_tr_b16 v[236:237], v241 offset:34816
    ds_read_b64_tr_b16 v[238:239], v241 offset:35840
    s_waitcnt vmcnt(20)
    s_barrier
    s_add_u32 m0, s74, 8192
    s_mov_b32 s40, 102400
    buffer_load_dwordx4 v19, s[16:19], s40 offen sc1 lds
    s_add_u32 m0, s74, 12288
    s_mov_b32 s40, 104448
    buffer_load_dwordx4 v19, s[16:19], s40 offen sc1 lds
    s_add_u32 m0, s74, 16384
    s_mov_b32 s40, 106496
    buffer_load_dwordx4 v19, s[16:19], s40 offen sc1 lds
    s_add_u32 m0, s74, 20480
    s_mov_b32 s40, 108544
    buffer_load_dwordx4 v19, s[16:19], s40 offen sc1 lds
    s_add_u32 m0, s74, 24576
    s_mov_b32 s40, 110592
    buffer_load_dwordx4 v19, s[16:19], s40 offen sc1 lds
    s_add_u32 m0, s74, 28672
    s_mov_b32 s40, 112640
    buffer_load_dwordx4 v19, s[16:19], s40 offen sc1 lds
    s_add_u32 m0, s74, 65536
    s_mov_b32 s40, 114688
    buffer_load_dwordx4 v19, s[16:19], s40 offen sc1 lds
    s_add_u32 m0, s74, 69632
    s_mov_b32 s40, 116736
    buffer_load_dwordx4 v19, s[16:19], s40 offen sc1 lds
    s_add_u32 m0, s74, 73728
    s_mov_b32 s40, 118784
    buffer_load_dwordx4 v19, s[16:19], s40 offen sc1 lds
    s_add_u32 m0, s74, 77824
    s_mov_b32 s40, 120832
    buffer_load_dwordx4 v19, s[16:19], s40 offen sc1 lds
    s_waitcnt vmcnt(11)
    s_mov_b32 s79, 0x10000
owait_chk:
    v_cmp_eq_u32 vcc, 0, v251
    s_nop 3
    s_cmp_eq_u64 vcc, 0
    s_cbranch_scc1 owait_ok
    s_sub_u32 s79, s79, 1
    s_cbranch_scc1 owait_ok
    s_sleep 1
    global_load_dword v251, v246, s[56:57] sc1
    s_waitcnt vmcnt(0)
    s_branch owait_chk
owait_ok:
    s_mov_b32 s41, 0
    buffer_load_dwordx4 a[0:3], v19, s[28:31], s41 offen sc1
    s_mov_b32 s41, 1024
    buffer_load_dwordx4 a[4:7], v19, s[28:31], s41 offen sc1
    s_mov_b32 s41, 2048
    buffer_load_dwordx4 a[8:11], v19, s[28:31], s41 offen sc1
    s_mov_b32 s41, 3072
    buffer_load_dwordx4 a[12:15], v19, s[28:31], s41 offen sc1
    s_waitcnt lgkmcnt(6)
    v_mfma_f32_32x32x16_bf16 v[96:111], v[224:227], a[240:243], v[96:111]
    ds_read_b64_tr_b16 v[208:209], v240 offset:36864
    ds_read_b64_tr_b16 v[210:211], v240 offset:37888
    s_mov_b32 s41, 4096
    buffer_load_dwordx4 a[16:19], v19, s[28:31], s41 offen sc1
    s_waitcnt lgkmcnt(6)
    v_mfma_f32_32x32x16_bf16 v[112:127], v[228:231], a[240:243], v[112:127]
    ds_read_b64_tr_b16 v[212:213], v241 offset:36864
    ds_read_b64_tr_b16 v[214:215], v241 offset:37888
    s_mov_b32 s41, 5120
    buffer_load_dwordx4 a[20:23], v19, s[28:31], s41 offen sc1
    s_waitcnt lgkmcnt(6)
    v_mfma_f32_32x32x16_bf16 v[128:143], v[232:235], a[240:243], v[128:143]
    ds_read_b64_tr_b16 v[216:217], v240 offset:38912
    ds_read_b64_tr_b16 v[218:219], v240 offset:39936
    s_mov_b32 s41, 6144
    buffer_load_dwordx4 a[24:27], v19, s[28:31], s41 offen sc1
    s_waitcnt lgkmcnt(6)
    v_mfma_f32_32x32x16_bf16 v[144:159], v[236:239], a[240:243], v[144:159]
    ds_read_b64_tr_b16 v[220:221], v241 offset:38912
    ds_read_b64_tr_b16 v[222:223], v241 offset:39936
    s_mov_b32 s41, 7168
    buffer_load_dwordx4 a[28:31], v19, s[28:31], s41 offen sc1
    s_waitcnt lgkmcnt(6)
    v_mfma_f32_32x32x16_bf16 v[96:111], v[208:211], a[244:247], v[96:111]
    ds_read_b64_tr_b16 v[224:225], v240 offset:40960
    ds_read_b64_tr_b16 v[226:227], v240 offset:41984
    s_mov_b32 s41, 8192
    buffer_load_dwordx4 a[32:35], v19, s[28:31], s41 offen sc1
    s_waitcnt lgkmcnt(6)
    v_mfma_f32_32x32x16_bf16 v[112:127], v[212:215], a[244:247], v[112:127]
    ds_read_b64_tr_b16 v[228:229], v241 offset:40960
    ds_read_b64_tr_b16 v[230:231], v241 offset:41984
    s_mov_b32 s41, 9216
    buffer_load_dwordx4 a[36:39], v19, s[28:31], s41 offen sc1
    s_waitcnt lgkmcnt(6)
    v_mfma_f32_32x32x16_bf16 v[128:143], v[216:219], a[244:247], v[128:143]
    ds_read_b64_tr_b16 v[232:233], v240 offset:43008
    ds_read_b64_tr_b16 v[234:235], v240 offset:44032
    s_mov_b32 s41, 10240
    buffer_load_dwordx4 a[40:43], v19, s[28:31], s41 offen sc1
    s_waitcnt lgkmcnt(6)
    v_mfma_f32_32x32x16_bf16 v[144:159], v[220:223], a[244:247], v[144:159]
    ds_read_b64_tr_b16 v[236:237], v241 offset:43008
    ds_read_b64_tr_b16 v[238:239], v241 offset:44032
    s_mov_b32 s41, 11264
    buffer_load_dwordx4 a[44:47], v19, s[28:31], s41 offen sc1
    s_waitcnt lgkmcnt(6)
    v_mfma_f32_32x32x16_bf16 v[96:111], v[224:227], a[248:251], v[96:111]
    ds_read_b64_tr_b16 v[208:209], v240 offset:45056
    ds_read_b64_tr_b16 v[210:211], v240 offset:46080
    s_mov_b32 s41, 12288
    buffer_load_dwordx4 a[48:51], v19, s[28:31], s41 offen sc1
    s_waitcnt lgkmcnt(6)
    v_mfma_f32_32x32x16_bf16 v[112:127], v[228:231], a[248:251], v[112:127]
    ds_read_b64_tr_b16 v[212:213], v241 offset:45056
    ds_read_b64_tr_b16 v[214:215], v241 offset:46080
    s_mov_b32 s41, 13312
    buffer_load_dwordx4 a[52:55], v19, s[28:31], s41 offen sc1
    s_waitcnt lgkmcnt(6)
    v_mfma_f32_32x32x16_bf16 v[128:143], v[232:235], a[248:251], v[128:143]
    ds_read_b64_tr_b16 v[216:217], v240 offset:47104
    ds_read_b64_tr_b16 v[218:219], v240 offset:48128
    s_mov_b32 s41, 14336
    buffer_load_dwordx4 a[56:59], v19, s[28:31], s41 offen sc1
    s_waitcnt lgkmcnt(6)
    v_mfma_f32_32x32x16_bf16 v[144:159], v[236:239], a[248:251], v[144:159]
    ds_read_b64_tr_b16 v[220:221], v241 offset:47104
    ds_read_b64_tr_b16 v[222:223], v241 offset:48128
    s_mov_b32 s41, 15360
    buffer_load_dwordx4 a[60:63], v19, s[28:31], s41 offen sc1
    s_waitcnt lgkmcnt(6)
    v_mfma_f32_32x32x16_bf16 v[96:111], v[208:211], a[252:255], v[96:111]
    ds_read_b64_tr_b16 v[224:225], v240 offset:49152
    ds_read_b64_tr_b16 v[226:227], v240 offset:50176
    s_mov_b32 s41, 16384
    buffer_load_dwordx4 a[64:67], v19, s[28:31], s41 offen sc1
    s_waitcnt lgkmcnt(6)
    v_mfma_f32_32x32x16_bf16 v[112:127], v[212:215], a[252:255], v[112:127]
    ds_read_b64_tr_b16 v[228:229], v241 offset:49152
    ds_read_b64_tr_b16 v[230:231], v241 offset:50176
    s_mov_b32 s41, 17408
    buffer_load_dwordx4 a[68:71], v19, s[28:31], s41 offen sc1
    s_waitcnt lgkmcnt(6)
    v_mfma_f32_32x32x16_bf16 v[128:143], v[216:219], a[252:255], v[128:143]
    ds_read_b64_tr_b16 v[232:233], v240 offset:51200
    ds_read_b64_tr_b16 v[234:235], v240 offset:52224
    s_mov_b32 s41, 18432
    buffer_load_dwordx4 a[72:75], v19, s[28:31], s41 offen sc1
    s_waitcnt lgkmcnt(6)
    v_mfma_f32_32x32x16_bf16 v[144:159], v[220:223], a[252:255], v[144:159]
    ds_read_b64_tr_b16 v[236:237], v241 offset:51200
    ds_read_b64_tr_b16 v[238:239], v241 offset:52224
    s_mov_b32 s41, 19456
    buffer_load_dwordx4 a[76:79], v19, s[28:31], s41 offen sc1
    s_waitcnt lgkmcnt(6)
    v_mfma_f32_32x32x16_bf16 v[96:111], v[224:227], a[128:131], v[96:111]
    ds_read_b64_tr_b16 v[208:209], v240 offset:53248
    ds_read_b64_tr_b16 v[210:211], v240 offset:54272
    s_mov_b32 s41, 20480
    buffer_load_dwordx4 a[80:83], v19, s[28:31], s41 offen sc1
    s_waitcnt lgkmcnt(6)
    v_mfma_f32_32x32x16_bf16 v[112:127], v[228:231], a[128:131], v[112:127]
    ds_read_b64_tr_b16 v[212:213], v241 offset:53248
    ds_read_b64_tr_b16 v[214:215], v241 offset:54272
    s_mov_b32 s41, 21504
    buffer_load_dwordx4 a[84:87], v19, s[28:31], s41 offen sc1
    s_waitcnt lgkmcnt(6)
    v_mfma_f32_32x32x16_bf16 v[128:143], v[232:235], a[128:131], v[128:143]
    ds_read_b64_tr_b16 v[216:217], v240 offset:55296
    ds_read_b64_tr_b16 v[218:219], v240 offset:56320
    s_mov_b32 s41, 22528
    buffer_load_dwordx4 a[88:91], v19, s[28:31], s41 offen sc1
    s_waitcnt lgkmcnt(6)
    v_mfma_f32_32x32x16_bf16 v[144:159], v[236:239], a[128:131], v[144:159]
    ds_read_b64_tr_b16 v[220:221], v241 offset:55296
    ds_read_b64_tr_b16 v[222:223], v241 offset:56320
    s_mov_b32 s41, 23552
    buffer_load_dwordx4 a[92:95], v19, s[28:31], s41 offen sc1
    s_waitcnt lgkmcnt(6)
    v_mfma_f32_32x32x16_bf16 v[96:111], v[208:211], a[132:135], v[96:111]
    ds_read_b64_tr_b16 v[224:225], v240 offset:57344
    ds_read_b64_tr_b16 v[226:227], v240 offset:58368
    s_mov_b32 s41, 24576
    buffer_load_dwordx4 a[96:99], v19, s[28:31], s41 offen sc1
    s_waitcnt lgkmcnt(6)
    v_mfma_f32_32x32x16_bf16 v[112:127], v[212:215], a[132:135], v[112:127]
    ds_read_b64_tr_b16 v[228:229], v241 offset:57344
    ds_read_b64_tr_b16 v[230:231], v241 offset:58368
    s_mov_b32 s41, 25600
    buffer_load_dwordx4 a[100:103], v19, s[28:31], s41 offen sc1
    s_waitcnt lgkmcnt(6)
    v_mfma_f32_32x32x16_bf16 v[128:143], v[216:219], a[132:135], v[128:143]
    ds_read_b64_tr_b16 v[232:233], v240 offset:59392
    ds_read_b64_tr_b16 v[234:235], v240 offset:60416
    s_mov_b32 s41, 26624
    buffer_load_dwordx4 a[104:107], v19, s[28:31], s41 offen sc1
    s_waitcnt lgkmcnt(6)
    v_mfma_f32_32x32x16_bf16 v[144:159], v[220:223], a[132:135], v[144:159]
    ds_read_b64_tr_b16 v[236:237], v241 offset:59392
    ds_read_b64_tr_b16 v[238:239], v241 offset:60416
    s_mov_b32 s41, 27648
    buffer_load_dwordx4 a[108:111], v19, s[28:31], s41 offen sc1
    s_waitcnt lgkmcnt(6)
    v_mfma_f32_32x32x16_bf16 v[96:111], v[224:227], a[136:139], v[96:111]
    ds_read_b64_tr_b16 v[208:209], v240 offset:61440
    ds_read_b64_tr_b16 v[210:211], v240 offset:62464
    s_mov_b32 s41, 28672
    buffer_load_dwordx4 a[112:115], v19, s[28:31], s41 offen sc1
    s_waitcnt lgkmcnt(6)
    v_mfma_f32_32x32x16_bf16 v[112:127], v[228:231], a[136:139], v[112:127]
    ds_read_b64_tr_b16 v[212:213], v241 offset:61440
    ds_read_b64_tr_b16 v[214:215], v241 offset:62464
    s_mov_b32 s41, 29696
    buffer_load_dwordx4 a[116:119], v19, s[28:31], s41 offen sc1
    s_waitcnt lgkmcnt(6)
    v_mfma_f32_32x32x16_bf16 v[128:143], v[232:235], a[136:139], v[128:143]
    ds_read_b64_tr_b16 v[216:217], v240 offset:63488
    ds_read_b64_tr_b16 v[218:219], v240 offset:64512
    s_mov_b32 s41, 30720
    buffer_load_dwordx4 a[120:123], v19, s[28:31], s41 offen sc1
    s_waitcnt lgkmcnt(6)
    v_mfma_f32_32x32x16_bf16 v[144:159], v[236:239], a[136:139], v[144:159]
    ds_read_b64_tr_b16 v[220:221], v241 offset:63488
    ds_read_b64_tr_b16 v[222:223], v241 offset:64512
    s_mov_b32 s41, 31744
    buffer_load_dwordx4 a[124:127], v19, s[28:31], s41 offen sc1
    s_waitcnt lgkmcnt(6)
    v_mfma_f32_32x32x16_bf16 v[96:111], v[208:211], a[140:143], v[96:111]
    ds_read_b64_tr_b16 v[224:225], v242 offset:16384
    ds_read_b64_tr_b16 v[226:227], v242 offset:17408
    s_mov_b32 s41, 32768
    buffer_load_dwordx4 a[128:131], v19, s[28:31], s41 offen sc1
    s_waitcnt lgkmcnt(6)
    v_mfma_f32_32x32x16_bf16 v[112:127], v[212:215], a[140:143], v[112:127]
    ds_read_b64_tr_b16 v[228:229], v243 offset:16384
    ds_read_b64_tr_b16 v[230:231], v243 offset:17408
    s_mov_b32 s41, 33792
    buffer_load_dwordx4 a[132:135], v19, s[28:31], s41 offen sc1
    s_waitcnt lgkmcnt(6)
    v_mfma_f32_32x32x16_bf16 v[128:143], v[216:219], a[140:143], v[128:143]
    ds_read_b64_tr_b16 v[232:233], v242 offset:18432
    ds_read_b64_tr_b16 v[234:235], v242 offset:19456
    s_mov_b32 s41, 34816
    buffer_load_dwordx4 a[136:139], v19, s[28:31], s41 offen sc1
    s_waitcnt lgkmcnt(6)
    v_mfma_f32_32x32x16_bf16 v[144:159], v[220:223], a[140:143], v[144:159]
    ds_read_b64_tr_b16 v[236:237], v243 offset:18432
    ds_read_b64_tr_b16 v[238:239], v243 offset:19456
    s_mov_b32 s41, 36864
    buffer_load_dwordx4 a[144:147], v19, s[28:31], s41 offen sc1
    s_waitcnt vmcnt(35)
    s_waitcnt lgkmcnt(6)
    v_mfma_f32_32x32x16_bf16 v[32:47], v[224:227], a[0:3], 0
    ds_read_b64_tr_b16 v[208:209], v242 offset:20480
    ds_read_b64_tr_b16 v[210:211], v242 offset:21504
    s_mov_b32 s41, 35840
    buffer_load_dwordx4 a[140:143], v19, s[28:31], s41 offen sc1
    s_waitcnt lgkmcnt(6)
    v_mfma_f32_32x32x16_bf16 v[48:63], v[228:231], a[0:3], 0
    ds_read_b64_tr_b16 v[212:213], v243 offset:20480
    ds_read_b64_tr_b16 v[214:215], v243 offset:21504
    s_mov_b32 s41, 37888
    buffer_load_dwordx4 a[148:151], v19, s[28:31], s41 offen sc1
    s_waitcnt lgkmcnt(6)
    v_mfma_f32_32x32x16_bf16 v[64:79], v[232:235], a[0:3], 0
    ds_read_b64_tr_b16 v[216:217], v242 offset:22528
    ds_read_b64_tr_b16 v[218:219], v242 offset:23552
    s_mov_b32 s41, 38912
    buffer_load_dwordx4 a[152:155], v19, s[28:31], s41 offen sc1
    s_waitcnt lgkmcnt(6)
    v_mfma_f32_32x32x16_bf16 v[80:95], v[236:239], a[0:3], 0
    ds_read_b64_tr_b16 v[220:221], v243 offset:22528
    ds_read_b64_tr_b16 v[222:223], v243 offset:23552
    s_waitcnt vmcnt(37)
    s_waitcnt lgkmcnt(6)
    v_mfma_f32_32x32x16_bf16 v[32:47], v[208:211], a[4:7], v[32:47]
    ds_read_b64_tr_b16 v[224:225], v242 offset:24576
    ds_read_b64_tr_b16 v[226:227], v242 offset:25600
    s_mov_b32 s41, 39936
    buffer_load_dwordx4 a[156:159], v19, s[28:31], s41 offen sc1
    s_waitcnt lgkmcnt(6)
    v_mfma_f32_32x32x16_bf16 v[48:63], v[212:215], a[4:7], v[48:63]
    ds_read_b64_tr_b16 v[228:229], v243 offset:24576
    ds_read_b64_tr_b16 v[230:231], v243 offset:25600
    s_mov_b32 s41, 40960
    buffer_load_dwordx4 a[160:163], v19, s[28:31], s41 offen sc1
    s_waitcnt lgkmcnt(6)
    v_mfma_f32_32x32x16_bf16 v[64:79], v[216:219], a[4:7], v[64:79]
    ds_read_b64_tr_b16 v[232:233], v242 offset:26624
    ds_read_b64_tr_b16 v[234:235], v242 offset:27648
    s_mov_b32 s41, 41984
    buffer_load_dwordx4 a[164:167], v19, s[28:31], s41 offen sc1
    s_waitcnt lgkmcnt(6)
    v_mfma_f32_32x32x16_bf16 v[80:95], v[220:223], a[4:7], v[80:95]
    ds_read_b64_tr_b16 v[236:237], v243 offset:26624
    ds_read_b64_tr_b16 v[238:239], v243 offset:27648
    s_barrier
    s_waitcnt vmcnt(39)
    s_waitcnt lgkmcnt(6)
    v_mfma_f32_32x32x16_bf16 v[32:47], v[224:227], a[8:11], v[32:47]
    ds_read_b64_tr_b16 v[208:209], v242 offset:28672
    ds_read_b64_tr_b16 v[210:211], v242 offset:29696
    s_add_u32 m0, s74, 32768
    s_mov_b32 s40, 122880
    buffer_load_dwordx4 v19, s[16:19], s40 offen sc1 lds
    s_waitcnt lgkmcnt(6)
    v_mfma_f32_32x32x16_bf16 v[48:63], v[228:231], a[8:11], v[48:63]
    ds_read_b64_tr_b16 v[212:213], v243 offset:28672
    ds_read_b64_tr_b16 v[214:215], v243 offset:29696
    s_add_u32 m0, s74, 36864
    s_mov_b32 s40, 124928
    buffer_load_dwordx4 v19, s[16:19], s40 offen sc1 lds
    s_waitcnt lgkmcnt(6)
    v_mfma_f32_32x32x16_bf16 v[64:79], v[232:235], a[8:11], v[64:79]
    ds_read_b64_tr_b16 v[216:217], v242 offset:30720
    ds_read_b64_tr_b16 v[218:219], v242 offset:31744
    s_add_u32 m0, s74, 40960
    s_mov_b32 s40, 126976
    buffer_load_dwordx4 v19, s[16:19], s40 offen sc1 lds
    s_waitcnt lgkmcnt(6)
    v_mfma_f32_32x32x16_bf16 v[80:95], v[236:239], a[8:11], v[80:95]
    ds_read_b64_tr_b16 v[220:221], v243 offset:30720
    ds_read_b64_tr_b16 v[222:223], v243 offset:31744
    s_waitcnt vmcnt(41)
    s_waitcnt lgkmcnt(6)
    v_mfma_f32_32x32x16_bf16 v[32:47], v[208:211], a[12:15], v[32:47]
    ds_read_b64_tr_b16 v[224:225], v242 offset:32768
    ds_read_b64_tr_b16 v[226:227], v242 offset:33792
    s_add_u32 m0, s74, 45056
    s_mov_b32 s40, 129024
    buffer_load_dwordx4 v19, s[16:19], s40 offen sc1 lds
    s_waitcnt lgkmcnt(6)
    v_mfma_f32_32x32x16_bf16 v[48:63], v[212:215], a[12:15], v[48:63]
    ds_read_b64_tr_b16 v[228:229], v243 offset:32768
    ds_read_b64_tr_b16 v[230:231], v243 offset:33792
    s_add_u32 m0, s74, 49152
    s_mov_b32 s40, 131072
    buffer_load_dwordx4 v19, s[16:19], s40 offen sc1 lds
    s_waitcnt lgkmcnt(6)
    v_mfma_f32_32x32x16_bf16 v[64:79], v[216:219], a[12:15], v[64:79]
    ds_read_b64_tr_b16 v[232:233], v242 offset:34816
    ds_read_b64_tr_b16 v[234:235], v242 offset:35840
    s_add_u32 m0, s74, 53248
    s_mov_b32 s40, 133120
    buffer_load_dwordx4 v19, s[16:19], s40 offen sc1 lds
    s_waitcnt lgkmcnt(6)
    v_mfma_f32_32x32x16_bf16 v[80:95], v[220:223], a[12:15], v[80:95]
    ds_read_b64_tr_b16 v[236:237], v243 offset:34816
    ds_read_b64_tr_b16 v[238:239], v243 offset:35840
    s_waitcnt vmcnt(43)
    s_waitcnt lgkmcnt(6)
    v_mfma_f32_32x32x16_bf16 v[32:47], v[224:227], a[16:19], v[32:47]
    ds_read_b64_tr_b16 v[208:209], v242 offset:36864
    ds_read_b64_tr_b16 v[210:211], v242 offset:37888
    s_add_u32 m0, s74, 57344
    s_mov_b32 s40, 135168
    buffer_load_dwordx4 v19, s[16:19], s40 offen sc1 lds
    s_waitcnt lgkmcnt(6)
    v_mfma_f32_32x32x16_bf16 v[48:63], v[228:231], a[16:19], v[48:63]
    ds_read_b64_tr_b16 v[212:213], v243 offset:36864
    ds_read_b64_tr_b16 v[214:215], v243 offset:37888
    s_mov_b32 s41, 43008
    buffer_load_dwordx4 a[168:171], v19, s[28:31], s41 offen sc1
    s_waitcnt lgkmcnt(6)
    v_mfma_f32_32x32x16_bf16 v[64:79], v[232:235], a[16:19], v[64:79]
    ds_read_b64_tr_b16 v[216:217], v242 offset:38912
    ds_read_b64_tr_b16 v[218:219], v242 offset:39936
    s_mov_b32 s41, 44032
    buffer_load_dwordx4 a[172:175], v19, s[28:31], s41 offen sc1
    s_waitcnt lgkmcnt(6)
    v_mfma_f32_32x32x16_bf16 v[80:95], v[236:239], a[16:19], v[80:95]
    ds_read_b64_tr_b16 v[220:221], v243 offset:38912
    ds_read_b64_tr_b16 v[222:223], v243 offset:39936
    s_waitcnt vmcnt(45)
    s_waitcnt lgkmcnt(6)
    v_mfma_f32_32x32x16_bf16 v[32:47], v[208:211], a[20:23], v[32:47]
    ds_read_b64_tr_b16 v[224:225], v242 offset:40960
    ds_read_b64_tr_b16 v[226:227], v242 offset:41984
    s_mov_b32 s41, 45056
    buffer_load_dwordx4 a[176:179], v19, s[28:31], s41 offen sc1
    s_waitcnt lgkmcnt(6)
    v_mfma_f32_32x32x16_bf16 v[48:63], v[212:215], a[20:23], v[48:63]
    ds_read_b64_tr_b16 v[228:229], v243 offset:40960
    ds_read_b64_tr_b16 v[230:231], v243 offset:41984
    s_mov_b32 s41, 46080
    buffer_load_dwordx4 a[180:183], v19, s[28:31], s41 offen sc1
    s_waitcnt lgkmcnt(6)
    v_mfma_f32_32x32x16_bf16 v[64:79], v[216:219], a[20:23], v[64:79]
    ds_read_b64_tr_b16 v[232:233], v242 offset:43008
    ds_read_b64_tr_b16 v[234:235], v242 offset:44032
    s_mov_b32 s41, 47104
    buffer_load_dwordx4 a[184:187], v19, s[28:31], s41 offen sc1
    s_waitcnt lgkmcnt(6)
    v_mfma_f32_32x32x16_bf16 v[80:95], v[220:223], a[20:23], v[80:95]
    ds_read_b64_tr_b16 v[236:237], v243 offset:43008
    ds_read_b64_tr_b16 v[238:239], v243 offset:44032
    s_waitcnt vmcnt(47)
    s_waitcnt lgkmcnt(6)
    v_mfma_f32_32x32x16_bf16 v[32:47], v[224:227], a[24:27], v[32:47]
    ds_read_b64_tr_b16 v[208:209], v242 offset:45056
    ds_read_b64_tr_b16 v[210:211], v242 offset:46080
    s_mov_b32 s41, 48128
    buffer_load_dwordx4 a[188:191], v19, s[28:31], s41 offen sc1
    s_waitcnt lgkmcnt(6)
    v_mfma_f32_32x32x16_bf16 v[48:63], v[228:231], a[24:27], v[48:63]
    ds_read_b64_tr_b16 v[212:213], v243 offset:45056
    ds_read_b64_tr_b16 v[214:215], v243 offset:46080
    s_add_u32 m0, s74, 61440
    s_mov_b32 s40, 137216
    buffer_load_dwordx4 v19, s[16:19], s40 offen sc1 lds
    s_waitcnt lgkmcnt(6)
    v_mfma_f32_32x32x16_bf16 v[64:79], v[232:235], a[24:27], v[64:79]
    ds_read_b64_tr_b16 v[216:217], v242 offset:47104
    ds_read_b64_tr_b16 v[218:219], v242 offset:48128
    s_add_u32 m0, s74, 81920
    s_mov_b32 s40, 139264
    buffer_load_dwordx4 v19, s[16:19], s40 offen sc1 lds
    s_waitcnt lgkmcnt(6)
    v_mfma_f32_32x32x16_bf16 v[80:95], v[236:239], a[24:27], v[80:95]
    ds_read_b64_tr_b16 v[220:221], v243 offset:47104
    ds_read_b64_tr_b16 v[222:223], v243 offset:48128
    s_waitcnt vmcnt(49)
    s_waitcnt lgkmcnt(6)
    v_mfma_f32_32x32x16_bf16 v[32:47], v[208:211], a[28:31], v[32:47]
    ds_read_b64_tr_b16 v[224:225], v242 offset:49152
    ds_read_b64_tr_b16 v[226:227], v242 offset:50176
    s_add_u32 m0, s74, 86016
    s_mov_b32 s40, 141312
    buffer_load_dwordx4 v19, s[16:19], s40 offen sc1 lds
    s_waitcnt lgkmcnt(6)
    v_mfma_f32_32x32x16_bf16 v[48:63], v[212:215], a[28:31], v[48:63]
    ds_read_b64_tr_b16 v[228:229], v243 offset:49152
    ds_read_b64_tr_b16 v[230:231], v243 offset:50176
    s_mov_b32 s41, 49152
    buffer_load_dwordx4 a[192:195], v19, s[28:31], s41 offen sc1
    s_waitcnt lgkmcnt(6)
    v_mfma_f32_32x32x16_bf16 v[64:79], v[216:219], a[28:31], v[64:79]
    ds_read_b64_tr_b16 v[232:233], v242 offset:51200
    ds_read_b64_tr_b16 v[234:235], v242 offset:52224
    s_mov_b32 s41, 50176
    buffer_load_dwordx4 a[196:199], v19, s[28:31], s41 offen sc1
    s_waitcnt lgkmcnt(6)
    v_mfma_f32_32x32x16_bf16 v[80:95], v[220:223], a[28:31], v[80:95]
    ds_read_b64_tr_b16 v[236:237], v243 offset:51200
    ds_read_b64_tr_b16 v[238:239], v243 offset:52224
    s_waitcnt vmcnt(51)
    s_waitcnt lgkmcnt(6)
    v_mfma_f32_32x32x16_bf16 v[32:47], v[224:227], a[32:35], v[32:47]
    ds_read_b64_tr_b16 v[208:209], v242 offset:53248
    ds_read_b64_tr_b16 v[210:211], v242 offset:54272
    s_mov_b32 s41, 51200
    buffer_load_dwordx4 a[200:203], v19, s[28:31], s41 offen sc1
    s_waitcnt lgkmcnt(6)
    v_mfma_f32_32x32x16_bf16 v[48:63], v[228:231], a[32:35], v[48:63]
    ds_read_b64_tr_b16 v[212:213], v243 offset:53248
    ds_read_b64_tr_b16 v[214:215], v243 offset:54272
    s_mov_b32 s41, 52224
    buffer_load_dwordx4 a[204:207], v19, s[28:31], s41 offen sc1
    s_waitcnt lgkmcnt(6)
    v_mfma_f32_32x32x16_bf16 v[64:79], v[232:235], a[32:35], v[64:79]
    ds_read_b64_tr_b16 v[216:217], v242 offset:55296
    ds_read_b64_tr_b16 v[218:219], v242 offset:56320
    s_mov_b32 s41, 53248
    buffer_load_dwordx4 a[208:211], v19, s[28:31], s41 offen sc1
    s_waitcnt lgkmcnt(6)
    v_mfma_f32_32x32x16_bf16 v[80:95], v[236:239], a[32:35], v[80:95]
    ds_read_b64_tr_b16 v[220:221], v243 offset:55296
    ds_read_b64_tr_b16 v[222:223], v243 offset:56320
    s_waitcnt vmcnt(53)
    s_waitcnt lgkmcnt(6)
    v_mfma_f32_32x32x16_bf16 v[32:47], v[208:211], a[36:39], v[32:47]
    ds_read_b64_tr_b16 v[224:225], v242 offset:57344
    ds_read_b64_tr_b16 v[226:227], v242 offset:58368
    s_mov_b32 s41, 54272
    buffer_load_dwordx4 a[212:215], v19, s[28:31], s41 offen sc1
    s_waitcnt lgkmcnt(6)
    v_mfma_f32_32x32x16_bf16 v[48:63], v[212:215], a[36:39], v[48:63]
    ds_read_b64_tr_b16 v[228:229], v243 offset:57344
    ds_read_b64_tr_b16 v[230:231], v243 offset:58368
    s_mov_b32 s41, 55296
    buffer_load_dwordx4 a[216:219], v19, s[28:31], s41 offen sc1
    s_waitcnt lgkmcnt(6)
    v_mfma_f32_32x32x16_bf16 v[64:79], v[216:219], a[36:39], v[64:79]
    ds_read_b64_tr_b16 v[232:233], v242 offset:59392
    ds_read_b64_tr_b16 v[234:235], v242 offset:60416
    s_mov_b32 s41, 56320
    buffer_load_dwordx4 a[220:223], v19, s[28:31], s41 offen sc1
    s_waitcnt lgkmcnt(6)
    v_mfma_f32_32x32x16_bf16 v[80:95], v[220:223], a[36:39], v[80:95]
    ds_read_b64_tr_b16 v[236:237], v243 offset:59392
    ds_read_b64_tr_b16 v[238:239], v243 offset:60416
    s_waitcnt vmcnt(55)
    s_waitcnt lgkmcnt(6)
    v_mfma_f32_32x32x16_bf16 v[32:47], v[224:227], a[40:43], v[32:47]
    ds_read_b64_tr_b16 v[208:209], v242 offset:61440
    ds_read_b64_tr_b16 v[210:211], v242 offset:62464
    s_mov_b32 s41, 57344
    buffer_load_dwordx4 a[224:227], v19, s[28:31], s41 offen sc1
    s_waitcnt lgkmcnt(6)
    v_mfma_f32_32x32x16_bf16 v[48:63], v[228:231], a[40:43], v[48:63]
    ds_read_b64_tr_b16 v[212:213], v243 offset:61440
    ds_read_b64_tr_b16 v[214:215], v243 offset:62464
    s_mov_b32 s41, 58368
    buffer_load_dwordx4 a[228:231], v19, s[28:31], s41 offen sc1
    s_waitcnt lgkmcnt(6)
    v_mfma_f32_32x32x16_bf16 v[64:79], v[232:235], a[40:43], v[64:79]
    ds_read_b64_tr_b16 v[216:217], v242 offset:63488
    ds_read_b64_tr_b16 v[218:219], v242 offset:64512
    s_mov_b32 s41, 59392
    buffer_load_dwordx4 a[232:235], v19, s[28:31], s41 offen sc1
    s_waitcnt lgkmcnt(6)
    v_mfma_f32_32x32x16_bf16 v[80:95], v[236:239], a[40:43], v[80:95]
    ds_read_b64_tr_b16 v[220:221], v243 offset:63488
    ds_read_b64_tr_b16 v[222:223], v243 offset:64512
    s_waitcnt vmcnt(57)
    s_waitcnt lgkmcnt(6)
    v_mfma_f32_32x32x16_bf16 v[32:47], v[208:211], a[44:47], v[32:47]
    ds_read_b64_tr_b16 v[224:225], v249 offset:0
    ds_read_b64_tr_b16 v[226:227], v249 offset:1024
    s_mov_b32 s41, 60416
    buffer_load_dwordx4 a[236:239], v19, s[28:31], s41 offen sc1
    s_waitcnt lgkmcnt(6)
    v_mfma_f32_32x32x16_bf16 v[48:63], v[212:215], a[44:47], v[48:63]
    ds_read_b64_tr_b16 v[228:229], v250 offset:0
    ds_read_b64_tr_b16 v[230:231], v250 offset:1024
    s_mov_b32 s41, 61440
    buffer_load_dwordx4 a[240:243], v19, s[28:31], s41 offen sc1
    s_waitcnt lgkmcnt(6)
    v_mfma_f32_32x32x16_bf16 v[64:79], v[216:219], a[44:47], v[64:79]
    ds_read_b64_tr_b16 v[232:233], v249 offset:2048
    ds_read_b64_tr_b16 v[234:235], v249 offset:3072
    s_mov_b32 s41, 62464
    buffer_load_dwordx4 a[244:247], v19, s[28:31], s41 offen sc1
    s_waitcnt lgkmcnt(6)
    v_mfma_f32_32x32x16_bf16 v[80:95], v[220:223], a[44:47], v[80:95]
    ds_read_b64_tr_b16 v[236:237], v250 offset:2048
    ds_read_b64_tr_b16 v[238:239], v250 offset:3072
    s_barrier
    s_waitcnt vmcnt(59)
    s_waitcnt lgkmcnt(6)
    v_mfma_f32_32x32x16_bf16 v[32:47], v[224:227], a[48:51], v[32:47]
    ds_read_b64_tr_b16 v[208:209], v249 offset:4096
    ds_read_b64_tr_b16 v[210:211], v249 offset:5120
    s_add_u32 m0, s74, 90112
    s_mov_b32 s40, 143360
    buffer_load_dwordx4 v19, s[16:19], s40 offen sc1 lds
    s_waitcnt lgkmcnt(6)
    v_mfma_f32_32x32x16_bf16 v[48:63], v[228:231], a[48:51], v[48:63]
    ds_read_b64_tr_b16 v[212:213], v250 offset:4096
    ds_read_b64_tr_b16 v[214:215], v250 offset:5120
    s_add_u32 m0, s74, 94208
    s_mov_b32 s40, 145408
    buffer_load_dwordx4 v19, s[16:19], s40 offen sc1 lds
    s_waitcnt lgkmcnt(6)
    v_mfma_f32_32x32x16_bf16 v[64:79], v[232:235], a[48:51], v[64:79]
    ds_read_b64_tr_b16 v[216:217], v249 offset:6144
    ds_read_b64_tr_b16 v[218:219], v249 offset:7168
    s_add_u32 m0, s74, 98304
    s_mov_b32 s40, 147456
    buffer_load_dwordx4 v19, s[16:19], s40 offen sc1 lds
    s_waitcnt lgkmcnt(6)
wpad11:
    s_cmp_eq_u32 s98, 1
    s_cbranch_scc1 WARMA_done
    v_mfma_f32_32x32x16_bf16 v[80:95], v[236:239], a[48:51], v[80:95]
    ds_read_b64_tr_b16 v[220:221], v250 offset:6144
    ds_read_b64_tr_b16 v[222:223], v250 offset:7168
    s_waitcnt vmcnt(61)
    s_waitcnt lgkmcnt(6)
    v_mfma_f32_32x32x16_bf16 v[32:47], v[208:211], a[52:55], v[32:47]
    ds_read_b64_tr_b16 v[224:225], v249 offset:8192
    ds_read_b64_tr_b16 v[226:227], v249 offset:9216
    s_add_u32 m0, s74, 102400
    s_mov_b32 s40, 149504
    buffer_load_dwordx4 v19, s[16:19], s40 offen sc1 lds
    s_waitcnt lgkmcnt(6)
    v_mfma_f32_32x32x16_bf16 v[48:63], v[212:215], a[52:55], v[48:63]
    ds_read_b64_tr_b16 v[228:229], v250 offset:8192
    ds_read_b64_tr_b16 v[230:231], v250 offset:9216
    s_waitcnt vmcnt(56)
    s_add_u32 m0, s74, 106496
    s_mov_b32 s40, 151552
    buffer_load_dwordx4 v19, s[16:19], s40 offen sc1 lds
    s_waitcnt lgkmcnt(6)
    v_mfma_f32_32x32x16_bf16 v[64:79], v[216:219], a[52:55], v[64:79]
    ds_read_b64_tr_b16 v[232:233], v249 offset:10240
    ds_read_b64_tr_b16 v[234:235], v249 offset:11264
    s_add_u32 m0, s74, 110592
    s_mov_b32 s40, 153600
    buffer_load_dwordx4 v19, s[16:19], s40 offen sc1 lds
    s_waitcnt lgkmcnt(6)
    v_mfma_f32_32x32x16_bf16 v[80:95], v[220:223], a[52:55], v[80:95]
    ds_read_b64_tr_b16 v[236:237], v250 offset:10240
    ds_read_b64_tr_b16 v[238:239], v250 offset:11264
    s_waitcnt lgkmcnt(6)
    v_mfma_f32_32x32x16_bf16 v[32:47], v[224:227], a[56:59], v[32:47]
    ds_read_b64_tr_b16 v[208:209], v249 offset:12288
    ds_read_b64_tr_b16 v[210:211], v249 offset:13312
    s_add_u32 m0, s74, 114688
    s_mov_b32 s40, 155648
    buffer_load_dwordx4 v19, s[16:19], s40 offen sc1 lds
    s_waitcnt lgkmcnt(6)
    v_mfma_f32_32x32x16_bf16 v[48:63], v[228:231], a[56:59], v[48:63]
    ds_read_b64_tr_b16 v[212:213], v250 offset:12288
    ds_read_b64_tr_b16 v[214:215], v250 offset:13312
    s_add_u32 m0, s74, 118784
    s_mov_b32 s40, 157696
    buffer_load_dwordx4 v19, s[16:19], s40 offen sc1 lds
    s_waitcnt lgkmcnt(6)
    v_mfma_f32_32x32x16_bf16 v[64:79], v[232:235], a[56:59], v[64:79]
    ds_read_b64_tr_b16 v[216:217], v249 offset:14336
    ds_read_b64_tr_b16 v[218:219], v249 offset:15360
    s_add_u32 m0, s74, 122880
    s_mov_b32 s40, 159744
    buffer_load_dwordx4 v19, s[16:19], s40 offen sc1 lds
    s_waitcnt lgkmcnt(6)
    v_mfma_f32_32x32x16_bf16 v[80:95], v[236:239], a[56:59], v[80:95]
    ds_read_b64_tr_b16 v[220:221], v250 offset:14336
    ds_read_b64_tr_b16 v[222:223], v250 offset:15360
    s_waitcnt lgkmcnt(6)
    v_mfma_f32_32x32x16_bf16 v[32:47], v[208:211], a[60:63], v[32:47]
    ds_read_b64_tr_b16 v[224:225], v249 offset:16384
    ds_read_b64_tr_b16 v[226:227], v249 offset:17408
    s_add_u32 m0, s74, 126976
    s_mov_b32 s40, 161792
    buffer_load_dwordx4 v19, s[16:19], s40 offen sc1 lds
    s_waitcnt lgkmcnt(6)
    v_mfma_f32_32x32x16_bf16 v[48:63], v[212:215], a[60:63], v[48:63]
    ds_read_b64_tr_b16 v[228:229], v250 offset:16384
    ds_read_b64_tr_b16 v[230:231], v250 offset:17408
    s_waitcnt vmcnt(56)
    s_mov_b32 s41, 63488
    buffer_load_dwordx4 a[248:251], v19, s[28:31], s41 offen sc1
    s_waitcnt lgkmcnt(6)
    v_mfma_f32_32x32x16_bf16 v[64:79], v[216:219], a[60:63], v[64:79]
    ds_read_b64_tr_b16 v[232:233], v249 offset:18432
    ds_read_b64_tr_b16 v[234:235], v249 offset:19456
    s_mov_b32 s41, 64512
    buffer_load_dwordx4 a[252:255], v19, s[28:31], s41 offen sc1
    s_waitcnt lgkmcnt(6)
    v_mfma_f32_32x32x16_bf16 v[80:95], v[220:223], a[60:63], v[80:95]
    ds_read_b64_tr_b16 v[236:237], v250 offset:18432
    ds_read_b64_tr_b16 v[238:239], v250 offset:19456
    s_waitcnt lgkmcnt(6)
    v_mfma_f32_32x32x16_bf16 v[32:47], v[224:227], a[64:67], v[32:47]
    ds_read_b64_tr_b16 v[208:209], v249 offset:20480
    ds_read_b64_tr_b16 v[210:211], v249 offset:21504
    s_waitcnt lgkmcnt(6)
    v_mfma_f32_32x32x16_bf16 v[48:63], v[228:231], a[64:67], v[48:63]
    ds_read_b64_tr_b16 v[212:213], v250 offset:20480
    ds_read_b64_tr_b16 v[214:215], v250 offset:21504
    s_waitcnt lgkmcnt(6)
    v_mfma_f32_32x32x16_bf16 v[64:79], v[232:235], a[64:67], v[64:79]
    ds_read_b64_tr_b16 v[216:217], v249 offset:22528
    ds_read_b64_tr_b16 v[218:219], v249 offset:23552
    s_waitcnt lgkmcnt(6)
    v_mfma_f32_32x32x16_bf16 v[80:95], v[236:239], a[64:67], v[80:95]
    ds_read_b64_tr_b16 v[220:221], v250 offset:22528
    ds_read_b64_tr_b16 v[222:223], v250 offset:23552
    s_waitcnt lgkmcnt(6)
    v_mfma_f32_32x32x16_bf16 v[32:47], v[208:211], a[68:71], v[32:47]
    ds_read_b64_tr_b16 v[224:225], v249 offset:24576
    ds_read_b64_tr_b16 v[226:227], v249 offset:25600
    s_waitcnt lgkmcnt(6)
    v_mfma_f32_32x32x16_bf16 v[48:63], v[212:215], a[68:71], v[48:63]
    ds_read_b64_tr_b16 v[228:229], v250 offset:24576
    ds_read_b64_tr_b16 v[230:231], v250 offset:25600
    s_waitcnt lgkmcnt(6)
    v_mfma_f32_32x32x16_bf16 v[64:79], v[216:219], a[68:71], v[64:79]
    ds_read_b64_tr_b16 v[232:233], v249 offset:26624
    ds_read_b64_tr_b16 v[234:235], v249 offset:27648
    s_waitcnt lgkmcnt(6)
    v_mfma_f32_32x32x16_bf16 v[80:95], v[220:223], a[68:71], v[80:95]
    ds_read_b64_tr_b16 v[236:237], v250 offset:26624
    ds_read_b64_tr_b16 v[238:239], v250 offset:27648
    s_waitcnt lgkmcnt(6)
    v_mfma_f32_32x32x16_bf16 v[32:47], v[224:227], a[72:75], v[32:47]
    ds_read_b64_tr_b16 v[208:209], v249 offset:28672
    ds_read_b64_tr_b16 v[210:211], v249 offset:29696
    s_waitcnt lgkmcnt(6)
    v_mfma_f32_32x32x16_bf16 v[48:63], v[228:231], a[72:75], v[48:63]
    ds_read_b64_tr_b16 v[212:213], v250 offset:28672
    ds_read_b64_tr_b16 v[214:215], v250 offset:29696
    s_waitcnt lgkmcnt(6)
    v_mfma_f32_32x32x16_bf16 v[64:79], v[232:235], a[72:75], v[64:79]
    ds_read_b64_tr_b16 v[216:217], v249 offset:30720
    ds_read_b64_tr_b16 v[218:219], v249 offset:31744
    s_waitcnt lgkmcnt(6)
    v_mfma_f32_32x32x16_bf16 v[80:95], v[236:239], a[72:75], v[80:95]
    ds_read_b64_tr_b16 v[220:221], v250 offset:30720
    ds_read_b64_tr_b16 v[222:223], v250 offset:31744
    s_waitcnt lgkmcnt(6)
    v_mfma_f32_32x32x16_bf16 v[32:47], v[208:211], a[76:79], v[32:47]
    ds_read_b64_tr_b16 v[224:225], v240 offset:0
    ds_read_b64_tr_b16 v[226:227], v240 offset:1024
    s_waitcnt lgkmcnt(6)
    v_mfma_f32_32x32x16_bf16 v[48:63], v[212:215], a[76:79], v[48:63]
    ds_read_b64_tr_b16 v[228:229], v241 offset:0
    ds_read_b64_tr_b16 v[230:231], v241 offset:1024
    s_waitcnt lgkmcnt(6)
    v_mfma_f32_32x32x16_bf16 v[64:79], v[216:219], a[76:79], v[64:79]
    ds_read_b64_tr_b16 v[232:233], v240 offset:2048
    ds_read_b64_tr_b16 v[234:235], v240 offset:3072
    s_waitcnt lgkmcnt(6)
    v_mfma_f32_32x32x16_bf16 v[80:95], v[220:223], a[76:79], v[80:95]
    ds_read_b64_tr_b16 v[236:237], v241 offset:2048
    ds_read_b64_tr_b16 v[238:239], v241 offset:3072
    s_waitcnt lgkmcnt(6)
    v_mfma_f32_32x32x16_bf16 v[32:47], v[224:227], a[80:83], v[32:47]
    ds_read_b64_tr_b16 v[208:209], v240 offset:4096
    ds_read_b64_tr_b16 v[210:211], v240 offset:5120
    s_waitcnt lgkmcnt(6)
    v_mfma_f32_32x32x16_bf16 v[48:63], v[228:231], a[80:83], v[48:63]
    ds_read_b64_tr_b16 v[212:213], v241 offset:4096
    ds_read_b64_tr_b16 v[214:215], v241 offset:5120
    s_waitcnt lgkmcnt(6)
    v_mfma_f32_32x32x16_bf16 v[64:79], v[232:235], a[80:83], v[64:79]
    ds_read_b64_tr_b16 v[216:217], v240 offset:6144
    ds_read_b64_tr_b16 v[218:219], v240 offset:7168
    s_waitcnt lgkmcnt(6)
    v_mfma_f32_32x32x16_bf16 v[80:95], v[236:239], a[80:83], v[80:95]
    ds_read_b64_tr_b16 v[220:221], v241 offset:6144
    ds_read_b64_tr_b16 v[222:223], v241 offset:7168
    s_waitcnt lgkmcnt(6)
    v_mfma_f32_32x32x16_bf16 v[32:47], v[208:211], a[84:87], v[32:47]
    ds_read_b64_tr_b16 v[224:225], v240 offset:8192
    ds_read_b64_tr_b16 v[226:227], v240 offset:9216
    s_waitcnt lgkmcnt(6)
    v_mfma_f32_32x32x16_bf16 v[48:63], v[212:215], a[84:87], v[48:63]
    ds_read_b64_tr_b16 v[228:229], v241 offset:8192
    ds_read_b64_tr_b16 v[230:231], v241 offset:9216
    s_waitcnt lgkmcnt(6)
    v_mfma_f32_32x32x16_bf16 v[64:79], v[216:219], a[84:87], v[64:79]
    ds_read_b64_tr_b16 v[232:233], v240 offset:10240
    ds_read_b64_tr_b16 v[234:235], v240 offset:11264
    s_waitcnt lgkmcnt(6)
    v_mfma_f32_32x32x16_bf16 v[80:95], v[220:223], a[84:87], v[80:95]
    ds_read_b64_tr_b16 v[236:237], v241 offset:10240
    ds_read_b64_tr_b16 v[238:239], v241 offset:11264
    s_waitcnt lgkmcnt(6)
    v_mfma_f32_32x32x16_bf16 v[32:47], v[224:227], a[88:91], v[32:47]
    ds_read_b64_tr_b16 v[208:209], v240 offset:12288
    ds_read_b64_tr_b16 v[210:211], v240 offset:13312
    s_waitcnt lgkmcnt(6)
    v_mfma_f32_32x32x16_bf16 v[48:63], v[228:231], a[88:91], v[48:63]
    ds_read_b64_tr_b16 v[212:213], v241 offset:12288
    ds_read_b64_tr_b16 v[214:215], v241 offset:13312
    s_waitcnt lgkmcnt(6)
    v_mfma_f32_32x32x16_bf16 v[64:79], v[232:235], a[88:91], v[64:79]
    ds_read_b64_tr_b16 v[216:217], v240 offset:14336
    ds_read_b64_tr_b16 v[218:219], v240 offset:15360
    s_waitcnt lgkmcnt(6)
    v_mfma_f32_32x32x16_bf16 v[80:95], v[236:239], a[88:91], v[80:95]
    ds_read_b64_tr_b16 v[220:221], v241 offset:14336
    ds_read_b64_tr_b16 v[222:223], v241 offset:15360
    s_waitcnt lgkmcnt(6)
    v_mfma_f32_32x32x16_bf16 v[32:47], v[208:211], a[92:95], v[32:47]
    ds_read_b64_tr_b16 v[224:225], v240 offset:16384
    ds_read_b64_tr_b16 v[226:227], v240 offset:17408
    s_waitcnt lgkmcnt(6)
    v_mfma_f32_32x32x16_bf16 v[48:63], v[212:215], a[92:95], v[48:63]
    ds_read_b64_tr_b16 v[228:229], v241 offset:16384
    ds_read_b64_tr_b16 v[230:231], v241 offset:17408
    s_waitcnt lgkmcnt(6)
    v_mfma_f32_32x32x16_bf16 v[64:79], v[216:219], a[92:95], v[64:79]
    ds_read_b64_tr_b16 v[232:233], v240 offset:18432
    ds_read_b64_tr_b16 v[234:235], v240 offset:19456
    s_waitcnt lgkmcnt(6)
    v_mfma_f32_32x32x16_bf16 v[80:95], v[220:223], a[92:95], v[80:95]
    ds_read_b64_tr_b16 v[236:237], v241 offset:18432
    ds_read_b64_tr_b16 v[238:239], v241 offset:19456
    s_waitcnt vmcnt(35)
    s_barrier
    s_waitcnt lgkmcnt(6)
    v_mfma_f32_32x32x16_bf16 v[32:47], v[224:227], a[96:99], v[32:47]
    ds_read_b64_tr_b16 v[208:209], v240 offset:20480
    ds_read_b64_tr_b16 v[210:211], v240 offset:21504
    s_add_u32 m0, s74, 131072
    s_mov_b32 s40, 163840
    buffer_load_dwordx4 v19, s[16:19], s40 offen sc1 lds
    s_waitcnt lgkmcnt(6)
    v_mfma_f32_32x32x16_bf16 v[48:63], v[228:231], a[96:99], v[48:63]
    ds_read_b64_tr_b16 v[212:213], v241 offset:20480
    ds_read_b64_tr_b16 v[214:215], v241 offset:21504
    s_add_u32 m0, s74, 135168
    s_mov_b32 s40, 165888
    buffer_load_dwordx4 v19, s[16:19], s40 offen sc1 lds
    s_waitcnt lgkmcnt(6)
    v_mfma_f32_32x32x16_bf16 v[64:79], v[232:235], a[96:99], v[64:79]
    ds_read_b64_tr_b16 v[216:217], v240 offset:22528
    ds_read_b64_tr_b16 v[218:219], v240 offset:23552
    s_add_u32 m0, s74, 139264
    s_mov_b32 s40, 167936
    buffer_load_dwordx4 v19, s[16:19], s40 offen sc1 lds
    s_waitcnt lgkmcnt(6)
    v_mfma_f32_32x32x16_bf16 v[80:95], v[236:239], a[96:99], v[80:95]
    ds_read_b64_tr_b16 v[220:221], v241 offset:22528
    ds_read_b64_tr_b16 v[222:223], v241 offset:23552
    s_waitcnt lgkmcnt(6)
    v_mfma_f32_32x32x16_bf16 v[32:47], v[208:211], a[100:103], v[32:47]
    ds_read_b64_tr_b16 v[224:225], v240 offset:24576
    ds_read_b64_tr_b16 v[226:227], v240 offset:25600
    s_add_u32 m0, s74, 143360
    s_mov_b32 s40, 169984
    buffer_load_dwordx4 v19, s[16:19], s40 offen sc1 lds
    s_waitcnt lgkmcnt(6)
    v_mfma_f32_32x32x16_bf16 v[48:63], v[212:215], a[100:103], v[48:63]
    ds_read_b64_tr_b16 v[228:229], v241 offset:24576
    ds_read_b64_tr_b16 v[230:231], v241 offset:25600
    s_add_u32 m0, s74, 147456
    s_mov_b32 s40, 172032
    buffer_load_dwordx4 v19, s[16:19], s40 offen sc1 lds
    s_waitcnt lgkmcnt(6)
    v_mfma_f32_32x32x16_bf16 v[64:79], v[216:219], a[100:103], v[64:79]
    ds_read_b64_tr_b16 v[232:233], v240 offset:26624
    ds_read_b64_tr_b16 v[234:235], v240 offset:27648
    s_add_u32 m0, s74, 151552
    s_mov_b32 s40, 174080
    buffer_load_dwordx4 v19, s[16:19], s40 offen sc1 lds
    s_waitcnt lgkmcnt(6)
    v_mfma_f32_32x32x16_bf16 v[80:95], v[220:223], a[100:103], v[80:95]
    ds_read_b64_tr_b16 v[236:237], v241 offset:26624
    ds_read_b64_tr_b16 v[238:239], v241 offset:27648
    s_waitcnt lgkmcnt(6)
    v_mfma_f32_32x32x16_bf16 v[32:47], v[224:227], a[104:107], v[32:47]
    ds_read_b64_tr_b16 v[208:209], v240 offset:28672
    ds_read_b64_tr_b16 v[210:211], v240 offset:29696
    s_add_u32 m0, s74, 155648
    s_mov_b32 s40, 176128
    buffer_load_dwordx4 v19, s[16:19], s40 offen sc1 lds
    s_waitcnt lgkmcnt(6)
    v_mfma_f32_32x32x16_bf16 v[48:63], v[228:231], a[104:107], v[48:63]
    ds_read_b64_tr_b16 v[212:213], v241 offset:28672
    ds_read_b64_tr_b16 v[214:215], v241 offset:29696
    s_add_u32 m0, s74, 159744
    s_mov_b32 s40, 178176
    buffer_load_dwordx4 v19, s[16:19], s40 offen sc1 lds
    s_waitcnt lgkmcnt(6)
    v_mfma_f32_32x32x16_bf16 v[64:79], v[232:235], a[104:107], v[64:79]
    ds_read_b64_tr_b16 v[216:217], v240 offset:30720
    ds_read_b64_tr_b16 v[218:219], v240 offset:31744
    s_add_u32 m0, s74, 0
    s_mov_b32 s40, 180224
    buffer_load_dwordx4 v19, s[16:19], s40 offen sc1 lds
    s_waitcnt lgkmcnt(6)
    v_mfma_f32_32x32x16_bf16 v[80:95], v[236:239], a[104:107], v[80:95]
    ds_read_b64_tr_b16 v[220:221], v241 offset:30720
    ds_read_b64_tr_b16 v[222:223], v241 offset:31744
    s_waitcnt lgkmcnt(6)
    v_mfma_f32_32x32x16_bf16 v[32:47], v[208:211], a[108:111], v[32:47]
    ds_read_b64_tr_b16 v[224:225], v242 offset:0
    ds_read_b64_tr_b16 v[226:227], v242 offset:1024
    s_add_u32 m0, s74, 4096
    s_mov_b32 s40, 182272
    buffer_load_dwordx4 v19, s[16:19], s40 offen sc1 lds
    s_waitcnt lgkmcnt(6)
    v_mfma_f32_32x32x16_bf16 v[48:63], v[212:215], a[108:111], v[48:63]
    ds_read_b64_tr_b16 v[228:229], v243 offset:0
    ds_read_b64_tr_b16 v[230:231], v243 offset:1024
    s_add_u32 m0, s74, 8192
    s_mov_b32 s40, 184320
    buffer_load_dwordx4 v19, s[16:19], s40 offen sc1 lds
    s_waitcnt lgkmcnt(6)
    v_mfma_f32_32x32x16_bf16 v[64:79], v[216:219], a[108:111], v[64:79]
    ds_read_b64_tr_b16 v[232:233], v242 offset:2048
    ds_read_b64_tr_b16 v[234:235], v242 offset:3072
    s_add_u32 m0, s74, 12288
    s_mov_b32 s40, 186368
    buffer_load_dwordx4 v19, s[16:19], s40 offen sc1 lds
    s_waitcnt lgkmcnt(6)
    v_mfma_f32_32x32x16_bf16 v[80:95], v[220:223], a[108:111], v[80:95]
    ds_read_b64_tr_b16 v[236:237], v243 offset:2048
    ds_read_b64_tr_b16 v[238:239], v243 offset:3072
    s_waitcnt lgkmcnt(6)
    v_mfma_f32_32x32x16_bf16 v[32:47], v[224:227], a[112:115], v[32:47]
    ds_read_b64_tr_b16 v[208:209], v242 offset:4096
    ds_read_b64_tr_b16 v[210:211], v242 offset:5120
    s_waitcnt lgkmcnt(6)
    v_mfma_f32_32x32x16_bf16 v[48:63], v[228:231], a[112:115], v[48:63]
    ds_read_b64_tr_b16 v[212:213], v243 offset:4096
    ds_read_b64_tr_b16 v[214:215], v243 offset:5120
    v_cvt_pk_bf16_f32 v160, v96, v97
    v_cvt_pk_bf16_f32 v161, v98, v99
    v_cvt_pk_bf16_f32 v162, v100, v101
    s_waitcnt lgkmcnt(6)
    v_mfma_f32_32x32x16_bf16 v[64:79], v[232:235], a[112:115], v[64:79]
    ds_read_b64_tr_b16 v[216:217], v242 offset:6144
    ds_read_b64_tr_b16 v[218:219], v242 offset:7168
    v_cvt_pk_bf16_f32 v163, v102, v103
    s_mov_b32 s43, 0
    buffer_store_dwordx4 v[160:163], v19, s[8:11], s43 offen offset:0 sc1
    s_waitcnt lgkmcnt(6)
    v_mfma_f32_32x32x16_bf16 v[80:95], v[236:239], a[112:115], v[80:95]
    ds_read_b64_tr_b16 v[220:221], v243 offset:6144
    ds_read_b64_tr_b16 v[222:223], v243 offset:7168
    v_cvt_pk_bf16_f32 v164, v104, v105
    v_cvt_pk_bf16_f32 v165, v106, v107
    v_cvt_pk_bf16_f32 v166, v108, v109
    s_waitcnt lgkmcnt(6)
    v_mfma_f32_32x32x16_bf16 v[32:47], v[208:211], a[116:119], v[32:47]
    ds_read_b64_tr_b16 v[224:225], v242 offset:8192
    ds_read_b64_tr_b16 v[226:227], v242 offset:9216
    s_waitcnt lgkmcnt(6)
    v_mfma_f32_32x32x16_bf16 v[48:63], v[212:215], a[116:119], v[48:63]
    ds_read_b64_tr_b16 v[228:229], v243 offset:8192
    ds_read_b64_tr_b16 v[230:231], v243 offset:9216
    v_cvt_pk_bf16_f32 v167, v110, v111
    s_mov_b32 s43, 0
    buffer_store_dwordx4 v[164:167], v19, s[8:11], s43 offen offset:1024 sc1
    s_waitcnt lgkmcnt(6)
    v_mfma_f32_32x32x16_bf16 v[64:79], v[216:219], a[116:119], v[64:79]
    ds_read_b64_tr_b16 v[232:233], v242 offset:10240
    ds_read_b64_tr_b16 v[234:235], v242 offset:11264
    v_cvt_pk_bf16_f32 v168, v112, v113
    v_cvt_pk_bf16_f32 v169, v114, v115
    v_cvt_pk_bf16_f32 v170, v116, v117
    s_waitcnt lgkmcnt(6)
    v_mfma_f32_32x32x16_bf16 v[80:95], v[220:223], a[116:119], v[80:95]
    ds_read_b64_tr_b16 v[236:237], v243 offset:10240
    ds_read_b64_tr_b16 v[238:239], v243 offset:11264
    v_cvt_pk_bf16_f32 v171, v118, v119
    s_mov_b32 s43, 4096
    buffer_store_dwordx4 v[168:171], v19, s[8:11], s43 offen offset:0 sc1
    s_waitcnt lgkmcnt(6)
    v_mfma_f32_32x32x16_bf16 v[32:47], v[224:227], a[120:123], v[32:47]
    ds_read_b64_tr_b16 v[208:209], v242 offset:12288
    ds_read_b64_tr_b16 v[210:211], v242 offset:13312
    s_waitcnt lgkmcnt(6)
    v_mfma_f32_32x32x16_bf16 v[48:63], v[228:231], a[120:123], v[48:63]
    ds_read_b64_tr_b16 v[212:213], v243 offset:12288
    ds_read_b64_tr_b16 v[214:215], v243 offset:13312
    v_cvt_pk_bf16_f32 v172, v120, v121
    v_cvt_pk_bf16_f32 v173, v122, v123
    v_cvt_pk_bf16_f32 v174, v124, v125
    s_waitcnt lgkmcnt(6)
    v_mfma_f32_32x32x16_bf16 v[64:79], v[232:235], a[120:123], v[64:79]
    ds_read_b64_tr_b16 v[216:217], v242 offset:14336
    ds_read_b64_tr_b16 v[218:219], v242 offset:15360
    v_cvt_pk_bf16_f32 v175, v126, v127
    s_mov_b32 s43, 4096
    buffer_store_dwordx4 v[172:175], v19, s[8:11], s43 offen offset:1024 sc1
    s_waitcnt lgkmcnt(6)
    v_mfma_f32_32x32x16_bf16 v[80:95], v[236:239], a[120:123], v[80:95]
    ds_read_b64_tr_b16 v[220:221], v243 offset:14336
    ds_read_b64_tr_b16 v[222:223], v243 offset:15360
    v_cvt_pk_bf16_f32 v160, v128, v129
    v_cvt_pk_bf16_f32 v161, v130, v131
    v_cvt_pk_bf16_f32 v162, v132, v133
    s_waitcnt lgkmcnt(6)
    v_mfma_f32_32x32x16_bf16 v[32:47], v[208:211], a[124:127], v[32:47]
    ds_read_b64_tr_b16 v[224:225], v240 offset:32768
    ds_read_b64_tr_b16 v[226:227], v240 offset:33792
    s_waitcnt lgkmcnt(6)
    v_mfma_f32_32x32x16_bf16 v[48:63], v[212:215], a[124:127], v[48:63]
    ds_read_b64_tr_b16 v[228:229], v241 offset:32768
    ds_read_b64_tr_b16 v[230:231], v241 offset:33792
    v_cvt_pk_bf16_f32 v163, v134, v135
    s_mov_b32 s43, 131072
    buffer_store_dwordx4 v[160:163], v19, s[8:11], s43 offen offset:0 sc1
    s_waitcnt lgkmcnt(6)
    v_mfma_f32_32x32x16_bf16 v[64:79], v[216:219], a[124:127], v[64:79]
    ds_read_b64_tr_b16 v[232:233], v240 offset:34816
    ds_read_b64_tr_b16 v[234:235], v240 offset:35840
    v_cvt_pk_bf16_f32 v164, v136, v137
    v_cvt_pk_bf16_f32 v165, v138, v139
    v_cvt_pk_bf16_f32 v166, v140, v141
    s_waitcnt lgkmcnt(6)
    v_mfma_f32_32x32x16_bf16 v[80:95], v[220:223], a[124:127], v[80:95]
    ds_read_b64_tr_b16 v[236:237], v241 offset:34816
    ds_read_b64_tr_b16 v[238:239], v241 offset:35840
    v_cvt_pk_bf16_f32 v167, v142, v143
    s_mov_b32 s43, 131072
    buffer_store_dwordx4 v[164:167], v19, s[8:11], s43 offen offset:1024 sc1
    s_waitcnt lgkmcnt(6)
    v_mfma_f32_32x32x16_bf16 v[32:47], v[224:227], a[128:131], v[32:47]
    ds_read_b64_tr_b16 v[208:209], v240 offset:36864
    ds_read_b64_tr_b16 v[210:211], v240 offset:37888
    s_waitcnt lgkmcnt(6)
    v_mfma_f32_32x32x16_bf16 v[48:63], v[228:231], a[128:131], v[48:63]
    ds_read_b64_tr_b16 v[212:213], v241 offset:36864
    ds_read_b64_tr_b16 v[214:215], v241 offset:37888
    v_cvt_pk_bf16_f32 v168, v144, v145
    v_cvt_pk_bf16_f32 v169, v146, v147
    v_cvt_pk_bf16_f32 v170, v148, v149
    s_waitcnt lgkmcnt(6)
    v_mfma_f32_32x32x16_bf16 v[64:79], v[232:235], a[128:131], v[64:79]
    ds_read_b64_tr_b16 v[216:217], v240 offset:38912
    ds_read_b64_tr_b16 v[218:219], v240 offset:39936
    v_cvt_pk_bf16_f32 v171, v150, v151
    s_mov_b32 s43, 135168
    buffer_store_dwordx4 v[168:171], v19, s[8:11], s43 offen offset:0 sc1
    s_waitcnt lgkmcnt(6)
    v_mfma_f32_32x32x16_bf16 v[80:95], v[236:239], a[128:131], v[80:95]
    ds_read_b64_tr_b16 v[220:221], v241 offset:38912
    ds_read_b64_tr_b16 v[222:223], v241 offset:39936
    v_cvt_pk_bf16_f32 v172, v152, v153
    v_cvt_pk_bf16_f32 v173, v154, v155
    v_cvt_pk_bf16_f32 v174, v156, v157
    s_waitcnt lgkmcnt(6)
    v_mfma_f32_32x32x16_bf16 v[32:47], v[208:211], a[132:135], v[32:47]
    ds_read_b64_tr_b16 v[224:225], v240 offset:40960
    ds_read_b64_tr_b16 v[226:227], v240 offset:41984
    s_waitcnt lgkmcnt(6)
    v_mfma_f32_32x32x16_bf16 v[48:63], v[212:215], a[132:135], v[48:63]
    ds_read_b64_tr_b16 v[228:229], v241 offset:40960
    ds_read_b64_tr_b16 v[230:231], v241 offset:41984
    v_cvt_pk_bf16_f32 v175, v158, v159
    s_mov_b32 s43, 135168
    buffer_store_dwordx4 v[172:175], v19, s[8:11], s43 offen offset:1024 sc1
    s_waitcnt lgkmcnt(6)
    v_mfma_f32_32x32x16_bf16 v[64:79], v[216:219], a[132:135], v[64:79]
    ds_read_b64_tr_b16 v[232:233], v240 offset:43008
    ds_read_b64_tr_b16 v[234:235], v240 offset:44032
    s_waitcnt lgkmcnt(6)
    v_mfma_f32_32x32x16_bf16 v[80:95], v[220:223], a[132:135], v[80:95]
    ds_read_b64_tr_b16 v[236:237], v241 offset:43008
    ds_read_b64_tr_b16 v[238:239], v241 offset:44032
    s_waitcnt lgkmcnt(6)
    v_mfma_f32_32x32x16_bf16 v[32:47], v[224:227], a[136:139], v[32:47]
    ds_read_b64_tr_b16 v[208:209], v240 offset:45056
    ds_read_b64_tr_b16 v[210:211], v240 offset:46080
    s_waitcnt lgkmcnt(6)
    v_mfma_f32_32x32x16_bf16 v[48:63], v[228:231], a[136:139], v[48:63]
    ds_read_b64_tr_b16 v[212:213], v241 offset:45056
    ds_read_b64_tr_b16 v[214:215], v241 offset:46080
    s_waitcnt lgkmcnt(6)
    v_mfma_f32_32x32x16_bf16 v[64:79], v[232:235], a[136:139], v[64:79]
    ds_read_b64_tr_b16 v[216:217], v240 offset:47104
    ds_read_b64_tr_b16 v[218:219], v240 offset:48128
    s_waitcnt lgkmcnt(6)
    v_mfma_f32_32x32x16_bf16 v[80:95], v[236:239], a[136:139], v[80:95]
    ds_read_b64_tr_b16 v[220:221], v241 offset:47104
    ds_read_b64_tr_b16 v[222:223], v241 offset:48128
    s_waitcnt lgkmcnt(6)
    v_mfma_f32_32x32x16_bf16 v[32:47], v[208:211], a[140:143], v[32:47]
    ds_read_b64_tr_b16 v[224:225], v240 offset:49152
    ds_read_b64_tr_b16 v[226:227], v240 offset:50176
    s_waitcnt lgkmcnt(6)
    v_mfma_f32_32x32x16_bf16 v[48:63], v[212:215], a[140:143], v[48:63]
    ds_read_b64_tr_b16 v[228:229], v241 offset:49152
    ds_read_b64_tr_b16 v[230:231], v241 offset:50176
    s_waitcnt lgkmcnt(6)
    v_mfma_f32_32x32x16_bf16 v[64:79], v[216:219], a[140:143], v[64:79]
    ds_read_b64_tr_b16 v[232:233], v240 offset:51200
    ds_read_b64_tr_b16 v[234:235], v240 offset:52224
    s_waitcnt lgkmcnt(6)
    v_mfma_f32_32x32x16_bf16 v[80:95], v[220:223], a[140:143], v[80:95]
    ds_read_b64_tr_b16 v[236:237], v241 offset:51200
    ds_read_b64_tr_b16 v[238:239], v241 offset:52224
    s_waitcnt lgkmcnt(6)
    v_mfma_f32_32x32x16_bf16 v[32:47], v[224:227], a[144:147], v[32:47]
    ds_read_b64_tr_b16 v[208:209], v240 offset:53248
    ds_read_b64_tr_b16 v[210:211], v240 offset:54272
    s_waitcnt lgkmcnt(6)
    v_mfma_f32_32x32x16_bf16 v[48:63], v[228:231], a[144:147], v[48:63]
    ds_read_b64_tr_b16 v[212:213], v241 offset:53248
    ds_read_b64_tr_b16 v[214:215], v241 offset:54272
    s_waitcnt lgkmcnt(6)
    v_mfma_f32_32x32x16_bf16 v[64:79], v[232:235], a[144:147], v[64:79]
    ds_read_b64_tr_b16 v[216:217], v240 offset:55296
    ds_read_b64_tr_b16 v[218:219], v240 offset:56320
    s_waitcnt lgkmcnt(6)
    v_mfma_f32_32x32x16_bf16 v[80:95], v[236:239], a[144:147], v[80:95]
    ds_read_b64_tr_b16 v[220:221], v241 offset:55296
    ds_read_b64_tr_b16 v[222:223], v241 offset:56320
    s_waitcnt lgkmcnt(6)
    v_mfma_f32_32x32x16_bf16 v[32:47], v[208:211], a[148:151], v[32:47]
    ds_read_b64_tr_b16 v[224:225], v240 offset:57344
    ds_read_b64_tr_b16 v[226:227], v240 offset:58368
    s_waitcnt lgkmcnt(6)
    v_mfma_f32_32x32x16_bf16 v[48:63], v[212:215], a[148:151], v[48:63]
    ds_read_b64_tr_b16 v[228:229], v241 offset:57344
    ds_read_b64_tr_b16 v[230:231], v241 offset:58368
    s_waitcnt lgkmcnt(6)
    v_mfma_f32_32x32x16_bf16 v[64:79], v[216:219], a[148:151], v[64:79]
    ds_read_b64_tr_b16 v[232:233], v240 offset:59392
    ds_read_b64_tr_b16 v[234:235], v240 offset:60416
    s_waitcnt lgkmcnt(6)
    v_mfma_f32_32x32x16_bf16 v[80:95], v[220:223], a[148:151], v[80:95]
    ds_read_b64_tr_b16 v[236:237], v241 offset:59392
    ds_read_b64_tr_b16 v[238:239], v241 offset:60416
    s_waitcnt vmcnt(23)
    s_barrier
    s_waitcnt lgkmcnt(6)
    v_mfma_f32_32x32x16_bf16 v[32:47], v[224:227], a[152:155], v[32:47]
    ds_read_b64_tr_b16 v[208:209], v240 offset:61440
    ds_read_b64_tr_b16 v[210:211], v240 offset:62464
    s_waitcnt lgkmcnt(6)
    v_mfma_f32_32x32x16_bf16 v[48:63], v[228:231], a[152:155], v[48:63]
    ds_read_b64_tr_b16 v[212:213], v241 offset:61440
    ds_read_b64_tr_b16 v[214:215], v241 offset:62464
    s_waitcnt lgkmcnt(6)
    v_mfma_f32_32x32x16_bf16 v[64:79], v[232:235], a[152:155], v[64:79]
    ds_read_b64_tr_b16 v[216:217], v240 offset:63488
    ds_read_b64_tr_b16 v[218:219], v240 offset:64512
    s_waitcnt lgkmcnt(6)
    v_mfma_f32_32x32x16_bf16 v[80:95], v[236:239], a[152:155], v[80:95]
    ds_read_b64_tr_b16 v[220:221], v241 offset:63488
    ds_read_b64_tr_b16 v[222:223], v241 offset:64512
    s_waitcnt lgkmcnt(6)
    v_mfma_f32_32x32x16_bf16 v[32:47], v[208:211], a[156:159], v[32:47]
    ds_read_b64_tr_b16 v[224:225], v242 offset:16384
    ds_read_b64_tr_b16 v[226:227], v242 offset:17408
    s_waitcnt lgkmcnt(6)
    v_mfma_f32_32x32x16_bf16 v[48:63], v[212:215], a[156:159], v[48:63]
    ds_read_b64_tr_b16 v[228:229], v243 offset:16384
    ds_read_b64_tr_b16 v[230:231], v243 offset:17408
    s_waitcnt lgkmcnt(6)
    v_mfma_f32_32x32x16_bf16 v[64:79], v[216:219], a[156:159], v[64:79]
    ds_read_b64_tr_b16 v[232:233], v242 offset:18432
    ds_read_b64_tr_b16 v[234:235], v242 offset:19456
    s_waitcnt lgkmcnt(6)
    v_mfma_f32_32x32x16_bf16 v[80:95], v[220:223], a[156:159], v[80:95]
    ds_read_b64_tr_b16 v[236:237], v243 offset:18432
    ds_read_b64_tr_b16 v[238:239], v243 offset:19456
    s_waitcnt lgkmcnt(6)
    v_mfma_f32_32x32x16_bf16 v[32:47], v[224:227], a[160:163], v[32:47]
    ds_read_b64_tr_b16 v[208:209], v242 offset:20480
    ds_read_b64_tr_b16 v[210:211], v242 offset:21504
    s_waitcnt lgkmcnt(6)
    v_mfma_f32_32x32x16_bf16 v[48:63], v[228:231], a[160:163], v[48:63]
    ds_read_b64_tr_b16 v[212:213], v243 offset:20480
    ds_read_b64_tr_b16 v[214:215], v243 offset:21504
    s_waitcnt lgkmcnt(6)
    v_mfma_f32_32x32x16_bf16 v[64:79], v[232:235], a[160:163], v[64:79]
    ds_read_b64_tr_b16 v[216:217], v242 offset:22528
    ds_read_b64_tr_b16 v[218:219], v242 offset:23552
    s_waitcnt lgkmcnt(6)
    v_mfma_f32_32x32x16_bf16 v[80:95], v[236:239], a[160:163], v[80:95]
    ds_read_b64_tr_b16 v[220:221], v243 offset:22528
    ds_read_b64_tr_b16 v[222:223], v243 offset:23552
    s_waitcnt lgkmcnt(6)
    v_mfma_f32_32x32x16_bf16 v[32:47], v[208:211], a[164:167], v[32:47]
    ds_read_b64_tr_b16 v[224:225], v242 offset:24576
    ds_read_b64_tr_b16 v[226:227], v242 offset:25600
    s_waitcnt lgkmcnt(6)
    v_mfma_f32_32x32x16_bf16 v[48:63], v[212:215], a[164:167], v[48:63]
wpad12:
    s_cmp_eq_u32 s98, 1
    s_cbranch_scc1 WARMA_done
    ds_read_b64_tr_b16 v[228:229], v243 offset:24576
    ds_read_b64_tr_b16 v[230:231], v243 offset:25600
    s_waitcnt lgkmcnt(6)
    v_mfma_f32_32x32x16_bf16 v[64:79], v[216:219], a[164:167], v[64:79]
    ds_read_b64_tr_b16 v[232:233], v242 offset:26624
    ds_read_b64_tr_b16 v[234:235], v242 offset:27648
    s_waitcnt lgkmcnt(6)
    v_mfma_f32_32x32x16_bf16 v[80:95], v[220:223], a[164:167], v[80:95]
    ds_read_b64_tr_b16 v[236:237], v243 offset:26624
    ds_read_b64_tr_b16 v[238:239], v243 offset:27648
    s_waitcnt lgkmcnt(6)
    v_mfma_f32_32x32x16_bf16 v[32:47], v[224:227], a[168:171], v[32:47]
    ds_read_b64_tr_b16 v[208:209], v242 offset:28672
    ds_read_b64_tr_b16 v[210:211], v242 offset:29696
    s_waitcnt lgkmcnt(6)
    v_mfma_f32_32x32x16_bf16 v[48:63], v[228:231], a[168:171], v[48:63]
    ds_read_b64_tr_b16 v[212:213], v243 offset:28672
    ds_read_b64_tr_b16 v[214:215], v243 offset:29696
    s_waitcnt lgkmcnt(6)
    v_mfma_f32_32x32x16_bf16 v[64:79], v[232:235], a[168:171], v[64:79]
    ds_read_b64_tr_b16 v[216:217], v242 offset:30720
    ds_read_b64_tr_b16 v[218:219], v242 offset:31744
    s_waitcnt lgkmcnt(6)
    v_mfma_f32_32x32x16_bf16 v[80:95], v[236:239], a[168:171], v[80:95]
    ds_read_b64_tr_b16 v[220:221], v243 offset:30720
    ds_read_b64_tr_b16 v[222:223], v243 offset:31744
    s_waitcnt lgkmcnt(6)
    v_mfma_f32_32x32x16_bf16 v[32:47], v[208:211], a[172:175], v[32:47]
    ds_read_b64_tr_b16 v[224:225], v242 offset:32768
    ds_read_b64_tr_b16 v[226:227], v242 offset:33792
    s_waitcnt lgkmcnt(6)
    v_mfma_f32_32x32x16_bf16 v[48:63], v[212:215], a[172:175], v[48:63]
    ds_read_b64_tr_b16 v[228:229], v243 offset:32768
    ds_read_b64_tr_b16 v[230:231], v243 offset:33792
    s_waitcnt lgkmcnt(6)
    v_mfma_f32_32x32x16_bf16 v[64:79], v[216:219], a[172:175], v[64:79]
    ds_read_b64_tr_b16 v[232:233], v242 offset:34816
    ds_read_b64_tr_b16 v[234:235], v242 offset:35840
    s_waitcnt lgkmcnt(6)
    v_mfma_f32_32x32x16_bf16 v[80:95], v[220:223], a[172:175], v[80:95]
    ds_read_b64_tr_b16 v[236:237], v243 offset:34816
    ds_read_b64_tr_b16 v[238:239], v243 offset:35840
    s_waitcnt lgkmcnt(6)
    v_mfma_f32_32x32x16_bf16 v[32:47], v[224:227], a[176:179], v[32:47]
    ds_read_b64_tr_b16 v[208:209], v242 offset:36864
    ds_read_b64_tr_b16 v[210:211], v242 offset:37888
    s_waitcnt lgkmcnt(6)
    v_mfma_f32_32x32x16_bf16 v[48:63], v[228:231], a[176:179], v[48:63]
    ds_read_b64_tr_b16 v[212:213], v243 offset:36864
    ds_read_b64_tr_b16 v[214:215], v243 offset:37888
    s_waitcnt lgkmcnt(6)
    v_mfma_f32_32x32x16_bf16 v[64:79], v[232:235], a[176:179], v[64:79]
    ds_read_b64_tr_b16 v[216:217], v242 offset:38912
    ds_read_b64_tr_b16 v[218:219], v242 offset:39936
    s_waitcnt lgkmcnt(6)
    v_mfma_f32_32x32x16_bf16 v[80:95], v[236:239], a[176:179], v[80:95]
    ds_read_b64_tr_b16 v[220:221], v243 offset:38912
    ds_read_b64_tr_b16 v[222:223], v243 offset:39936
    s_waitcnt lgkmcnt(6)
    v_mfma_f32_32x32x16_bf16 v[32:47], v[208:211], a[180:183], v[32:47]
    ds_read_b64_tr_b16 v[224:225], v242 offset:40960
    ds_read_b64_tr_b16 v[226:227], v242 offset:41984
    s_waitcnt lgkmcnt(6)
    v_mfma_f32_32x32x16_bf16 v[48:63], v[212:215], a[180:183], v[48:63]
    ds_read_b64_tr_b16 v[228:229], v243 offset:40960
    ds_read_b64_tr_b16 v[230:231], v243 offset:41984
    s_waitcnt lgkmcnt(6)
    v_mfma_f32_32x32x16_bf16 v[64:79], v[216:219], a[180:183], v[64:79]
    ds_read_b64_tr_b16 v[232:233], v242 offset:43008
    ds_read_b64_tr_b16 v[234:235], v242 offset:44032
    s_waitcnt lgkmcnt(6)
    v_mfma_f32_32x32x16_bf16 v[80:95], v[220:223], a[180:183], v[80:95]
    ds_read_b64_tr_b16 v[236:237], v243 offset:43008
    ds_read_b64_tr_b16 v[238:239], v243 offset:44032
    s_waitcnt lgkmcnt(6)
    v_mfma_f32_32x32x16_bf16 v[32:47], v[224:227], a[184:187], v[32:47]
    ds_read_b64_tr_b16 v[208:209], v242 offset:45056
    ds_read_b64_tr_b16 v[210:211], v242 offset:46080
    s_waitcnt lgkmcnt(6)
    v_mfma_f32_32x32x16_bf16 v[48:63], v[228:231], a[184:187], v[48:63]
    ds_read_b64_tr_b16 v[212:213], v243 offset:45056
    ds_read_b64_tr_b16 v[214:215], v243 offset:46080
    s_waitcnt lgkmcnt(6)
    v_mfma_f32_32x32x16_bf16 v[64:79], v[232:235], a[184:187], v[64:79]
    ds_read_b64_tr_b16 v[216:217], v242 offset:47104
    ds_read_b64_tr_b16 v[218:219], v242 offset:48128
    s_waitcnt lgkmcnt(6)
    v_mfma_f32_32x32x16_bf16 v[80:95], v[236:239], a[184:187], v[80:95]
    ds_read_b64_tr_b16 v[220:221], v243 offset:47104
    ds_read_b64_tr_b16 v[222:223], v243 offset:48128
    s_waitcnt lgkmcnt(6)
    v_mfma_f32_32x32x16_bf16 v[32:47], v[208:211], a[188:191], v[32:47]
    ds_read_b64_tr_b16 v[224:225], v242 offset:49152
    ds_read_b64_tr_b16 v[226:227], v242 offset:50176
    s_waitcnt lgkmcnt(6)
    v_mfma_f32_32x32x16_bf16 v[48:63], v[212:215], a[188:191], v[48:63]
    ds_read_b64_tr_b16 v[228:229], v243 offset:49152
    ds_read_b64_tr_b16 v[230:231], v243 offset:50176
    s_waitcnt lgkmcnt(6)
    v_mfma_f32_32x32x16_bf16 v[64:79], v[216:219], a[188:191], v[64:79]
    ds_read_b64_tr_b16 v[232:233], v242 offset:51200
    ds_read_b64_tr_b16 v[234:235], v242 offset:52224
    s_waitcnt lgkmcnt(6)
    v_mfma_f32_32x32x16_bf16 v[80:95], v[220:223], a[188:191], v[80:95]
    ds_read_b64_tr_b16 v[236:237], v243 offset:51200
    ds_read_b64_tr_b16 v[238:239], v243 offset:52224
    s_waitcnt lgkmcnt(6)
    v_mfma_f32_32x32x16_bf16 v[32:47], v[224:227], a[192:195], v[32:47]
    ds_read_b64_tr_b16 v[208:209], v242 offset:53248
    ds_read_b64_tr_b16 v[210:211], v242 offset:54272
    s_waitcnt lgkmcnt(6)
    v_mfma_f32_32x32x16_bf16 v[48:63], v[228:231], a[192:195], v[48:63]
    ds_read_b64_tr_b16 v[212:213], v243 offset:53248
    ds_read_b64_tr_b16 v[214:215], v243 offset:54272
    s_waitcnt lgkmcnt(6)
    v_mfma_f32_32x32x16_bf16 v[64:79], v[232:235], a[192:195], v[64:79]
    ds_read_b64_tr_b16 v[216:217], v242 offset:55296
    ds_read_b64_tr_b16 v[218:219], v242 offset:56320
    s_waitcnt lgkmcnt(6)
    v_mfma_f32_32x32x16_bf16 v[80:95], v[236:239], a[192:195], v[80:95]
    ds_read_b64_tr_b16 v[220:221], v243 offset:55296
    ds_read_b64_tr_b16 v[222:223], v243 offset:56320
    s_waitcnt lgkmcnt(6)
    v_mfma_f32_32x32x16_bf16 v[32:47], v[208:211], a[196:199], v[32:47]
    ds_read_b64_tr_b16 v[224:225], v242 offset:57344
    ds_read_b64_tr_b16 v[226:227], v242 offset:58368
    s_waitcnt lgkmcnt(6)
    v_mfma_f32_32x32x16_bf16 v[48:63], v[212:215], a[196:199], v[48:63]
    ds_read_b64_tr_b16 v[228:229], v243 offset:57344
    ds_read_b64_tr_b16 v[230:231], v243 offset:58368
    s_waitcnt lgkmcnt(6)
    v_mfma_f32_32x32x16_bf16 v[64:79], v[216:219], a[196:199], v[64:79]
    ds_read_b64_tr_b16 v[232:233], v242 offset:59392
    ds_read_b64_tr_b16 v[234:235], v242 offset:60416
    s_waitcnt lgkmcnt(6)
    v_mfma_f32_32x32x16_bf16 v[80:95], v[220:223], a[196:199], v[80:95]
    ds_read_b64_tr_b16 v[236:237], v243 offset:59392
    ds_read_b64_tr_b16 v[238:239], v243 offset:60416
    s_waitcnt vmcnt(8)
    s_barrier
    s_waitcnt lgkmcnt(6)
    v_mfma_f32_32x32x16_bf16 v[32:47], v[224:227], a[200:203], v[32:47]
    ds_read_b64_tr_b16 v[208:209], v242 offset:61440
    ds_read_b64_tr_b16 v[210:211], v242 offset:62464
    s_waitcnt lgkmcnt(6)
    v_mfma_f32_32x32x16_bf16 v[48:63], v[228:231], a[200:203], v[48:63]
    ds_read_b64_tr_b16 v[212:213], v243 offset:61440
    ds_read_b64_tr_b16 v[214:215], v243 offset:62464
    s_waitcnt lgkmcnt(6)
    v_mfma_f32_32x32x16_bf16 v[64:79], v[232:235], a[200:203], v[64:79]
    ds_read_b64_tr_b16 v[216:217], v242 offset:63488
    ds_read_b64_tr_b16 v[218:219], v242 offset:64512
    s_waitcnt lgkmcnt(6)
    v_mfma_f32_32x32x16_bf16 v[80:95], v[236:239], a[200:203], v[80:95]
    ds_read_b64_tr_b16 v[220:221], v243 offset:63488
    ds_read_b64_tr_b16 v[222:223], v243 offset:64512
    s_waitcnt lgkmcnt(6)
    v_mfma_f32_32x32x16_bf16 v[32:47], v[208:211], a[204:207], v[32:47]
    ds_read_b64_tr_b16 v[224:225], v249 offset:0
    ds_read_b64_tr_b16 v[226:227], v249 offset:1024
    s_waitcnt lgkmcnt(6)
    v_mfma_f32_32x32x16_bf16 v[48:63], v[212:215], a[204:207], v[48:63]
    ds_read_b64_tr_b16 v[228:229], v250 offset:0
    ds_read_b64_tr_b16 v[230:231], v250 offset:1024
    s_waitcnt lgkmcnt(6)
    v_mfma_f32_32x32x16_bf16 v[64:79], v[216:219], a[204:207], v[64:79]
    ds_read_b64_tr_b16 v[232:233], v249 offset:2048
    ds_read_b64_tr_b16 v[234:235], v249 offset:3072
    s_waitcnt lgkmcnt(6)
    v_mfma_f32_32x32x16_bf16 v[80:95], v[220:223], a[204:207], v[80:95]
    ds_read_b64_tr_b16 v[236:237], v250 offset:2048
    ds_read_b64_tr_b16 v[238:239], v250 offset:3072
    s_waitcnt lgkmcnt(6)
    v_mfma_f32_32x32x16_bf16 v[32:47], v[224:227], a[208:211], v[32:47]
    ds_read_b64_tr_b16 v[208:209], v249 offset:4096
    ds_read_b64_tr_b16 v[210:211], v249 offset:5120
    s_waitcnt lgkmcnt(6)
    v_mfma_f32_32x32x16_bf16 v[48:63], v[228:231], a[208:211], v[48:63]
    ds_read_b64_tr_b16 v[212:213], v250 offset:4096
    ds_read_b64_tr_b16 v[214:215], v250 offset:5120
    s_waitcnt lgkmcnt(6)
    v_mfma_f32_32x32x16_bf16 v[64:79], v[232:235], a[208:211], v[64:79]
    ds_read_b64_tr_b16 v[216:217], v249 offset:6144
    ds_read_b64_tr_b16 v[218:219], v249 offset:7168
    s_waitcnt lgkmcnt(6)
    v_mfma_f32_32x32x16_bf16 v[80:95], v[236:239], a[208:211], v[80:95]
    ds_read_b64_tr_b16 v[220:221], v250 offset:6144
    ds_read_b64_tr_b16 v[222:223], v250 offset:7168
    s_waitcnt lgkmcnt(6)
    v_mfma_f32_32x32x16_bf16 v[32:47], v[208:211], a[212:215], v[32:47]
    ds_read_b64_tr_b16 v[224:225], v249 offset:8192
    ds_read_b64_tr_b16 v[226:227], v249 offset:9216
    s_waitcnt lgkmcnt(6)
    v_mfma_f32_32x32x16_bf16 v[48:63], v[212:215], a[212:215], v[48:63]
    ds_read_b64_tr_b16 v[228:229], v250 offset:8192
    ds_read_b64_tr_b16 v[230:231], v250 offset:9216
    s_waitcnt lgkmcnt(6)
    v_mfma_f32_32x32x16_bf16 v[64:79], v[216:219], a[212:215], v[64:79]
    ds_read_b64_tr_b16 v[232:233], v249 offset:10240
    ds_read_b64_tr_b16 v[234:235], v249 offset:11264
    s_waitcnt lgkmcnt(6)
    v_mfma_f32_32x32x16_bf16 v[80:95], v[220:223], a[212:215], v[80:95]
    ds_read_b64_tr_b16 v[236:237], v250 offset:10240
    ds_read_b64_tr_b16 v[238:239], v250 offset:11264
    s_waitcnt lgkmcnt(6)
    v_mfma_f32_32x32x16_bf16 v[32:47], v[224:227], a[216:219], v[32:47]
    ds_read_b64_tr_b16 v[208:209], v249 offset:12288
    ds_read_b64_tr_b16 v[210:211], v249 offset:13312
    s_waitcnt lgkmcnt(6)
    v_mfma_f32_32x32x16_bf16 v[48:63], v[228:231], a[216:219], v[48:63]
    ds_read_b64_tr_b16 v[212:213], v250 offset:12288
    ds_read_b64_tr_b16 v[214:215], v250 offset:13312
    s_waitcnt lgkmcnt(6)
    v_mfma_f32_32x32x16_bf16 v[64:79], v[232:235], a[216:219], v[64:79]
    ds_read_b64_tr_b16 v[216:217], v249 offset:14336
    ds_read_b64_tr_b16 v[218:219], v249 offset:15360
    s_waitcnt lgkmcnt(6)
    v_mfma_f32_32x32x16_bf16 v[80:95], v[236:239], a[216:219], v[80:95]
    ds_read_b64_tr_b16 v[220:221], v250 offset:14336
    ds_read_b64_tr_b16 v[222:223], v250 offset:15360
    s_waitcnt lgkmcnt(6)
    v_mfma_f32_32x32x16_bf16 v[32:47], v[208:211], a[220:223], v[32:47]
    ds_read_b64_tr_b16 v[224:225], v249 offset:16384
    ds_read_b64_tr_b16 v[226:227], v249 offset:17408
    s_waitcnt lgkmcnt(6)
    v_mfma_f32_32x32x16_bf16 v[48:63], v[212:215], a[220:223], v[48:63]
    ds_read_b64_tr_b16 v[228:229], v250 offset:16384
    ds_read_b64_tr_b16 v[230:231], v250 offset:17408
    s_waitcnt lgkmcnt(6)
    v_mfma_f32_32x32x16_bf16 v[64:79], v[216:219], a[220:223], v[64:79]
    ds_read_b64_tr_b16 v[232:233], v249 offset:18432
    ds_read_b64_tr_b16 v[234:235], v249 offset:19456
    s_waitcnt lgkmcnt(6)
    v_mfma_f32_32x32x16_bf16 v[80:95], v[220:223], a[220:223], v[80:95]
    ds_read_b64_tr_b16 v[236:237], v250 offset:18432
    ds_read_b64_tr_b16 v[238:239], v250 offset:19456
    s_waitcnt lgkmcnt(6)
    v_mfma_f32_32x32x16_bf16 v[32:47], v[224:227], a[224:227], v[32:47]
    ds_read_b64_tr_b16 v[208:209], v249 offset:20480
    ds_read_b64_tr_b16 v[210:211], v249 offset:21504
    s_add_u32 s43, s36, 0
    buffer_load_dwordx4 v[96:99], v19, s[12:15], s43 offen offset:0 sc1
    s_waitcnt lgkmcnt(6)
    v_mfma_f32_32x32x16_bf16 v[48:63], v[228:231], a[224:227], v[48:63]
    ds_read_b64_tr_b16 v[212:213], v250 offset:20480
    ds_read_b64_tr_b16 v[214:215], v250 offset:21504
    buffer_load_dwordx4 v[100:103], v19, s[12:15], s43 offen offset:1024 sc1
    s_waitcnt lgkmcnt(6)
    v_mfma_f32_32x32x16_bf16 v[64:79], v[232:235], a[224:227], v[64:79]
    ds_read_b64_tr_b16 v[216:217], v249 offset:22528
    ds_read_b64_tr_b16 v[218:219], v249 offset:23552
    s_add_u32 s43, s36, 8192
    buffer_load_dwordx4 v[104:107], v19, s[12:15], s43 offen offset:0 sc1
    s_waitcnt lgkmcnt(6)
    v_mfma_f32_32x32x16_bf16 v[80:95], v[236:239], a[224:227], v[80:95]
    ds_read_b64_tr_b16 v[220:221], v250 offset:22528
    ds_read_b64_tr_b16 v[222:223], v250 offset:23552
    s_waitcnt lgkmcnt(6)
    v_mfma_f32_32x32x16_bf16 v[32:47], v[208:211], a[228:231], v[32:47]
    ds_read_b64_tr_b16 v[224:225], v249 offset:24576
    ds_read_b64_tr_b16 v[226:227], v249 offset:25600
    buffer_load_dwordx4 v[108:111], v19, s[12:15], s43 offen offset:1024 sc1
    s_waitcnt lgkmcnt(6)
    v_mfma_f32_32x32x16_bf16 v[48:63], v[212:215], a[228:231], v[48:63]
    ds_read_b64_tr_b16 v[228:229], v250 offset:24576
    ds_read_b64_tr_b16 v[230:231], v250 offset:25600
    s_add_u32 s43, s36, 16384
    buffer_load_dwordx4 v[112:115], v19, s[12:15], s43 offen offset:0 sc1
    s_waitcnt lgkmcnt(6)
    v_mfma_f32_32x32x16_bf16 v[64:79], v[216:219], a[228:231], v[64:79]
    ds_read_b64_tr_b16 v[232:233], v249 offset:26624
    ds_read_b64_tr_b16 v[234:235], v249 offset:27648
    buffer_load_dwordx4 v[116:119], v19, s[12:15], s43 offen offset:1024 sc1
    s_waitcnt lgkmcnt(6)
    v_mfma_f32_32x32x16_bf16 v[80:95], v[220:223], a[228:231], v[80:95]
    ds_read_b64_tr_b16 v[236:237], v250 offset:26624
    ds_read_b64_tr_b16 v[238:239], v250 offset:27648
    s_waitcnt lgkmcnt(6)
    v_mfma_f32_32x32x16_bf16 v[32:47], v[224:227], a[232:235], v[32:47]
    ds_read_b64_tr_b16 v[208:209], v249 offset:28672
    ds_read_b64_tr_b16 v[210:211], v249 offset:29696
    s_add_u32 s43, s36, 24576
    buffer_load_dwordx4 v[120:123], v19, s[12:15], s43 offen offset:0 sc1
    s_waitcnt lgkmcnt(6)
    v_mfma_f32_32x32x16_bf16 v[48:63], v[228:231], a[232:235], v[48:63]
    ds_read_b64_tr_b16 v[212:213], v250 offset:28672
    ds_read_b64_tr_b16 v[214:215], v250 offset:29696
    buffer_load_dwordx4 v[124:127], v19, s[12:15], s43 offen offset:1024 sc1
    s_waitcnt lgkmcnt(6)
    v_mfma_f32_32x32x16_bf16 v[64:79], v[232:235], a[232:235], v[64:79]
    ds_read_b64_tr_b16 v[216:217], v249 offset:30720
    ds_read_b64_tr_b16 v[218:219], v249 offset:31744
    buffer_load_dwordx4 v[128:131], v244, s[64:67], 0 offen
    s_waitcnt lgkmcnt(6)
    v_mfma_f32_32x32x16_bf16 v[80:95], v[236:239], a[232:235], v[80:95]
    ds_read_b64_tr_b16 v[220:221], v250 offset:30720
    ds_read_b64_tr_b16 v[222:223], v250 offset:31744
    s_waitcnt lgkmcnt(6)
    v_mfma_f32_32x32x16_bf16 v[32:47], v[208:211], a[236:239], v[32:47]
    ds_read_b64_tr_b16 v[224:225], v240 offset:0
    ds_read_b64_tr_b16 v[226:227], v240 offset:1024
    buffer_load_dwordx4 v[132:135], v244, s[64:67], 0 offen offset:32
    s_waitcnt lgkmcnt(6)
    v_mfma_f32_32x32x16_bf16 v[48:63], v[212:215], a[236:239], v[48:63]
    ds_read_b64_tr_b16 v[228:229], v241 offset:0
    ds_read_b64_tr_b16 v[230:231], v241 offset:1024
    s_waitcnt lgkmcnt(6)
    v_mfma_f32_32x32x16_bf16 v[64:79], v[216:219], a[236:239], v[64:79]
    ds_read_b64_tr_b16 v[232:233], v240 offset:2048
    ds_read_b64_tr_b16 v[234:235], v240 offset:3072
    s_waitcnt lgkmcnt(6)
    v_mfma_f32_32x32x16_bf16 v[80:95], v[220:223], a[236:239], v[80:95]
    ds_read_b64_tr_b16 v[236:237], v241 offset:2048
    ds_read_b64_tr_b16 v[238:239], v241 offset:3072
    s_waitcnt lgkmcnt(6)
    v_mfma_f32_32x32x16_bf16 v[32:47], v[224:227], a[240:243], v[32:47]
    ds_read_b64_tr_b16 v[208:209], v240 offset:4096
    ds_read_b64_tr_b16 v[210:211], v240 offset:5120
    s_waitcnt lgkmcnt(6)
    v_mfma_f32_32x32x16_bf16 v[48:63], v[228:231], a[240:243], v[48:63]
    ds_read_b64_tr_b16 v[212:213], v241 offset:4096
    ds_read_b64_tr_b16 v[214:215], v241 offset:5120
    s_waitcnt lgkmcnt(6)
    v_mfma_f32_32x32x16_bf16 v[64:79], v[232:235], a[240:243], v[64:79]
    ds_read_b64_tr_b16 v[216:217], v240 offset:6144
    ds_read_b64_tr_b16 v[218:219], v240 offset:7168
    s_waitcnt lgkmcnt(6)
    v_mfma_f32_32x32x16_bf16 v[80:95], v[236:239], a[240:243], v[80:95]
    ds_read_b64_tr_b16 v[220:221], v241 offset:6144
    ds_read_b64_tr_b16 v[222:223], v241 offset:7168
    s_waitcnt lgkmcnt(6)
    v_mfma_f32_32x32x16_bf16 v[32:47], v[208:211], a[244:247], v[32:47]
    ds_read_b64_tr_b16 v[224:225], v240 offset:8192
    ds_read_b64_tr_b16 v[226:227], v240 offset:9216
    s_waitcnt lgkmcnt(6)
    v_mfma_f32_32x32x16_bf16 v[48:63], v[212:215], a[244:247], v[48:63]
    ds_read_b64_tr_b16 v[228:229], v241 offset:8192
    ds_read_b64_tr_b16 v[230:231], v241 offset:9216
    s_waitcnt lgkmcnt(6)
    v_mfma_f32_32x32x16_bf16 v[64:79], v[216:219], a[244:247], v[64:79]
    ds_read_b64_tr_b16 v[232:233], v240 offset:10240
    ds_read_b64_tr_b16 v[234:235], v240 offset:11264
    s_waitcnt lgkmcnt(6)
    v_mfma_f32_32x32x16_bf16 v[80:95], v[220:223], a[244:247], v[80:95]
    ds_read_b64_tr_b16 v[236:237], v241 offset:10240
    ds_read_b64_tr_b16 v[238:239], v241 offset:11264
    s_waitcnt lgkmcnt(6)
    v_mfma_f32_32x32x16_bf16 v[32:47], v[224:227], a[248:251], v[32:47]
    ds_read_b64_tr_b16 v[208:209], v240 offset:12288
    ds_read_b64_tr_b16 v[210:211], v240 offset:13312
    s_waitcnt lgkmcnt(6)
    v_mfma_f32_32x32x16_bf16 v[48:63], v[228:231], a[248:251], v[48:63]
    ds_read_b64_tr_b16 v[212:213], v241 offset:12288
    ds_read_b64_tr_b16 v[214:215], v241 offset:13312
    s_waitcnt lgkmcnt(6)
    v_mfma_f32_32x32x16_bf16 v[64:79], v[232:235], a[248:251], v[64:79]
    ds_read_b64_tr_b16 v[216:217], v240 offset:14336
    ds_read_b64_tr_b16 v[218:219], v240 offset:15360
    s_waitcnt lgkmcnt(6)
    v_mfma_f32_32x32x16_bf16 v[80:95], v[236:239], a[248:251], v[80:95]
    ds_read_b64_tr_b16 v[220:221], v241 offset:14336
    ds_read_b64_tr_b16 v[222:223], v241 offset:15360
    s_waitcnt lgkmcnt(6)
    v_mfma_f32_32x32x16_bf16 v[32:47], v[208:211], a[252:255], v[32:47]
    s_waitcnt lgkmcnt(4)
    v_mfma_f32_32x32x16_bf16 v[48:63], v[212:215], a[252:255], v[48:63]
    s_waitcnt lgkmcnt(2)
    v_mfma_f32_32x32x16_bf16 v[64:79], v[216:219], a[252:255], v[64:79]
    s_waitcnt lgkmcnt(0)
    v_mfma_f32_32x32x16_bf16 v[80:95], v[220:223], a[252:255], v[80:95]
    s_nop 11
    v_cvt_pk_bf16_f32 v176, v32, v33
    v_cvt_pk_bf16_f32 v177, v34, v35
    v_cvt_pk_bf16_f32 v178, v36, v37
    v_cvt_pk_bf16_f32 v179, v38, v39
    s_mov_b32 s43, 32768
    buffer_store_dwordx4 v[176:179], v19, s[8:11], s43 offen offset:0 sc1
    v_cvt_pk_bf16_f32 v180, v40, v41
    v_cvt_pk_bf16_f32 v181, v42, v43
    v_cvt_pk_bf16_f32 v182, v44, v45
    v_cvt_pk_bf16_f32 v183, v46, v47
    s_mov_b32 s43, 32768
    buffer_store_dwordx4 v[180:183], v19, s[8:11], s43 offen offset:1024 sc1
    v_cvt_pk_bf16_f32 v184, v48, v49
    v_cvt_pk_bf16_f32 v185, v50, v51
    v_cvt_pk_bf16_f32 v186, v52, v53
    v_cvt_pk_bf16_f32 v187, v54, v55
    s_mov_b32 s43, 36864
    buffer_store_dwordx4 v[184:187], v19, s[8:11], s43 offen offset:0 sc1
    v_cvt_pk_bf16_f32 v188, v56, v57
    v_cvt_pk_bf16_f32 v189, v58, v59
    v_cvt_pk_bf16_f32 v190, v60, v61
    v_cvt_pk_bf16_f32 v191, v62, v63
    s_mov_b32 s43, 36864
    buffer_store_dwordx4 v[188:191], v19, s[8:11], s43 offen offset:1024 sc1
    v_cvt_pk_bf16_f32 v192, v64, v65
    v_cvt_pk_bf16_f32 v193, v66, v67
    v_cvt_pk_bf16_f32 v194, v68, v69
    v_cvt_pk_bf16_f32 v195, v70, v71
    s_mov_b32 s43, 163840
    buffer_store_dwordx4 v[192:195], v19, s[8:11], s43 offen offset:0 sc1
    v_cvt_pk_bf16_f32 v196, v72, v73
    v_cvt_pk_bf16_f32 v197, v74, v75
    v_cvt_pk_bf16_f32 v198, v76, v77
    v_cvt_pk_bf16_f32 v199, v78, v79
    s_mov_b32 s43, 163840
    buffer_store_dwordx4 v[196:199], v19, s[8:11], s43 offen offset:1024 sc1
    v_cvt_pk_bf16_f32 v200, v80, v81
    v_cvt_pk_bf16_f32 v201, v82, v83
    v_cvt_pk_bf16_f32 v202, v84, v85
    v_cvt_pk_bf16_f32 v203, v86, v87
    s_mov_b32 s43, 167936
    buffer_store_dwordx4 v[200:203], v19, s[8:11], s43 offen offset:0 sc1
    v_cvt_pk_bf16_f32 v204, v88, v89
    v_cvt_pk_bf16_f32 v205, v90, v91
    v_cvt_pk_bf16_f32 v206, v92, v93
    v_cvt_pk_bf16_f32 v207, v94, v95
    s_mov_b32 s43, 167936
    buffer_store_dwordx4 v[204:207], v19, s[8:11], s43 offen offset:1024 sc1
    s_mov_b32 s79, 0x10000
    s_waitcnt vmcnt(10)
xf_chk:
    v_max3_u32 v24, v96, v97, v98
    v_max3_u32 v24, v24, v99, v100
    v_max3_u32 v24, v24, v101, v102
    v_max3_u32 v24, v24, v103, v104
    v_max3_u32 v24, v24, v105, v106
    v_max3_u32 v24, v24, v107, v108
    v_max3_u32 v24, v24, v109, v110
    v_max3_u32 v25, v112, v113, v114
    v_max3_u32 v25, v25, v115, v116
    v_max3_u32 v25, v25, v117, v118
    v_max3_u32 v25, v25, v119, v120
    v_max3_u32 v25, v25, v121, v122
    v_max3_u32 v25, v25, v123, v124
    v_max3_u32 v25, v25, v125, v126
    v_max3_u32 v24, v24, v111, v127
    v_max_u32 v24, v24, v25
    v_cmp_eq_u32 vcc, -1, v24
    s_nop 3
    s_cmp_eq_u64 vcc, 0
    s_cbranch_scc1 xf_ok
    s_sub_u32 s79, s79, 1
    s_cbranch_scc1 xf_ok
    s_sleep 1
    s_add_u32 s43, s36, 0
    buffer_load_dwordx4 v[96:99], v19, s[12:15], s43 offen offset:0 sc1
    buffer_load_dwordx4 v[100:103], v19, s[12:15], s43 offen offset:1024 sc1
    s_add_u32 s43, s36, 8192
    buffer_load_dwordx4 v[104:107], v19, s[12:15], s43 offen offset:0 sc1
    buffer_load_dwordx4 v[108:111], v19, s[12:15], s43 offen offset:1024 sc1
    s_add_u32 s43, s36, 16384
    buffer_load_dwordx4 v[112:115], v19, s[12:15], s43 offen offset:0 sc1
    buffer_load_dwordx4 v[116:119], v19, s[12:15], s43 offen offset:1024 sc1
    s_add_u32 s43, s36, 24576
    buffer_load_dwordx4 v[120:123], v19, s[12:15], s43 offen offset:0 sc1
    buffer_load_dwordx4 v[124:127], v19, s[12:15], s43 offen offset:1024 sc1
    s_waitcnt vmcnt(0)
    s_branch xf_chk
xf_ok:
    v_lshlrev_b32 v32, 16, v96
    v_and_b32 v33, 0xffff0000, v96
    v_lshlrev_b32 v34, 16, v97
    v_and_b32 v35, 0xffff0000, v97
    v_lshlrev_b32 v36, 16, v98
    v_and_b32 v37, 0xffff0000, v98
    v_lshlrev_b32 v38, 16, v99
    v_and_b32 v39, 0xffff0000, v99
    v_lshlrev_b32 v40, 16, v100
    v_and_b32 v41, 0xffff0000, v100
    v_lshlrev_b32 v42, 16, v101
    v_and_b32 v43, 0xffff0000, v101
    v_lshlrev_b32 v44, 16, v102
    v_and_b32 v45, 0xffff0000, v102
    v_lshlrev_b32 v46, 16, v103
    v_and_b32 v47, 0xffff0000, v103
    v_lshlrev_b32 v48, 16, v104
    v_and_b32 v49, 0xffff0000, v104
    v_lshlrev_b32 v50, 16, v105
    v_and_b32 v51, 0xffff0000, v105
    v_lshlrev_b32 v52, 16, v106
    v_and_b32 v53, 0xffff0000, v106
    v_lshlrev_b32 v54, 16, v107
    v_and_b32 v55, 0xffff0000, v107
    v_lshlrev_b32 v56, 16, v108
    v_and_b32 v57, 0xffff0000, v108
    v_lshlrev_b32 v58, 16, v109
    v_and_b32 v59, 0xffff0000, v109
    v_lshlrev_b32 v60, 16, v110
    v_and_b32 v61, 0xffff0000, v110
    v_lshlrev_b32 v62, 16, v111
    v_and_b32 v63, 0xffff0000, v111
    v_pk_add_f32 v[32:33], v[32:33], v[48:49]
    v_pk_add_f32 v[34:35], v[34:35], v[50:51]
    v_pk_add_f32 v[36:37], v[36:37], v[52:53]
    v_pk_add_f32 v[38:39], v[38:39], v[54:55]
    v_pk_add_f32 v[40:41], v[40:41], v[56:57]
    v_pk_add_f32 v[42:43], v[42:43], v[58:59]
    v_pk_add_f32 v[44:45], v[44:45], v[60:61]
    v_pk_add_f32 v[46:47], v[46:47], v[62:63]
    v_lshlrev_b32 v48, 16, v112
    v_and_b32 v49, 0xffff0000, v112
    v_lshlrev_b32 v50, 16, v113
    v_and_b32 v51, 0xffff0000, v113
    v_lshlrev_b32 v52, 16, v114
    v_and_b32 v53, 0xffff0000, v114
    v_lshlrev_b32 v54, 16, v115
    v_and_b32 v55, 0xffff0000, v115
    v_lshlrev_b32 v56, 16, v116
    v_and_b32 v57, 0xffff0000, v116
    v_lshlrev_b32 v58, 16, v117
    v_and_b32 v59, 0xffff0000, v117
    v_lshlrev_b32 v60, 16, v118
    v_and_b32 v61, 0xffff0000, v118
    v_lshlrev_b32 v62, 16, v119
    v_and_b32 v63, 0xffff0000, v119
    v_pk_add_f32 v[32:33], v[32:33], v[48:49]
    v_pk_add_f32 v[34:35], v[34:35], v[50:51]
    v_pk_add_f32 v[36:37], v[36:37], v[52:53]
    v_pk_add_f32 v[38:39], v[38:39], v[54:55]
    v_pk_add_f32 v[40:41], v[40:41], v[56:57]
    v_pk_add_f32 v[42:43], v[42:43], v[58:59]
    v_pk_add_f32 v[44:45], v[44:45], v[60:61]
    v_pk_add_f32 v[46:47], v[46:47], v[62:63]
    v_lshlrev_b32 v48, 16, v120
    v_and_b32 v49, 0xffff0000, v120
    v_lshlrev_b32 v50, 16, v121
    v_and_b32 v51, 0xffff0000, v121
    v_lshlrev_b32 v52, 16, v122
    v_and_b32 v53, 0xffff0000, v122
    v_lshlrev_b32 v54, 16, v123
    v_and_b32 v55, 0xffff0000, v123
    v_lshlrev_b32 v56, 16, v124
    v_and_b32 v57, 0xffff0000, v124
    v_lshlrev_b32 v58, 16, v125
    v_and_b32 v59, 0xffff0000, v125
    v_lshlrev_b32 v60, 16, v126
    v_and_b32 v61, 0xffff0000, v126
    v_lshlrev_b32 v62, 16, v127
    v_and_b32 v63, 0xffff0000, v127
    v_pk_add_f32 v[32:33], v[32:33], v[48:49]
    v_pk_add_f32 v[34:35], v[34:35], v[50:51]
    v_pk_add_f32 v[36:37], v[36:37], v[52:53]
    v_pk_add_f32 v[38:39], v[38:39], v[54:55]
    v_pk_add_f32 v[40:41], v[40:41], v[56:57]
    v_pk_add_f32 v[42:43], v[42:43], v[58:59]
    v_pk_add_f32 v[44:45], v[44:45], v[60:61]
    v_pk_add_f32 v[46:47], v[46:47], v[62:63]
    v_mul_f32 v48, s47, v32
    v_mul_f32 v49, s47, v33
    v_mul_f32 v50, s47, v34
    v_mul_f32 v51, s47, v35
    v_mul_f32 v52, s47, v36
    v_mul_f32 v53, s47, v37
    v_mul_f32 v54, s47, v38
    v_mul_f32 v55, s47, v39
    v_mul_f32 v56, s47, v40
    v_mul_f32 v57, s47, v41
    v_mul_f32 v58, s47, v42
    v_mul_f32 v59, s47, v43
    v_mul_f32 v60, s47, v44
    v_mul_f32 v61, s47, v45
    v_mul_f32 v62, s47, v46
    v_mul_f32 v63, s47, v47
    v_exp_f32 v48, v48
    v_exp_f32 v49, v49
    v_exp_f32 v50, v50
    v_exp_f32 v51, v51
    v_exp_f32 v52, v52
    v_exp_f32 v53, v53
    v_exp_f32 v54, v54
    v_exp_f32 v55, v55
    v_exp_f32 v56, v56
    v_exp_f32 v57, v57
    v_exp_f32 v58, v58
    v_exp_f32 v59, v59
    v_exp_f32 v60, v60
    v_exp_f32 v61, v61
    v_exp_f32 v62, v62
    v_exp_f32 v63, v63
    v_add_f32 v48, 1.0, v48
    v_add_f32 v49, 1.0, v49
    v_add_f32 v50, 1.0, v50
    v_add_f32 v51, 1.0, v51
    v_add_f32 v52, 1.0, v52
    v_add_f32 v53, 1.0, v53
    v_add_f32 v54, 1.0, v54
    v_add_f32 v55, 1.0, v55
    v_add_f32 v56, 1.0, v56
    v_add_f32 v57, 1.0, v57
    v_add_f32 v58, 1.0, v58
    v_add_f32 v59, 1.0, v59
    v_add_f32 v60, 1.0, v60
    v_add_f32 v61, 1.0, v61
    v_add_f32 v62, 1.0, v62
    v_add_f32 v63, 1.0, v63
    v_rcp_f32 v48, v48
    v_rcp_f32 v49, v49
    v_rcp_f32 v50, v50
    v_rcp_f32 v51, v51
    v_rcp_f32 v52, v52
    v_rcp_f32 v53, v53
    v_rcp_f32 v54, v54
    v_rcp_f32 v55, v55
    v_rcp_f32 v56, v56
    v_rcp_f32 v57, v57
    v_rcp_f32 v58, v58
    v_rcp_f32 v59, v59
    v_rcp_f32 v60, v60
    v_rcp_f32 v61, v61
    v_rcp_f32 v62, v62
    v_rcp_f32 v63, v63
    v_mul_f32 v32, v32, v48
    v_mul_f32 v33, v33, v49
    v_mul_f32 v34, v34, v50
    v_mul_f32 v35, v35, v51
wpad13:
    s_cmp_eq_u32 s98, 1
    s_cbranch_scc1 WARMA_done
    v_mul_f32 v36, v36, v52
    v_mul_f32 v37, v37, v53
    v_mul_f32 v38, v38, v54
    v_mul_f32 v39, v39, v55
    v_mul_f32 v40, v40, v56
    v_mul_f32 v41, v41, v57
    v_mul_f32 v42, v42, v58
    v_mul_f32 v43, v43, v59
    v_mul_f32 v44, v44, v60
    v_mul_f32 v45, v45, v61
    v_mul_f32 v46, v46, v62
    v_mul_f32 v47, v47, v63
    s_waitcnt vmcnt(8)
    v_lshlrev_b32 v80, 16, v128
    v_and_b32 v81, 0xffff0000, v128
    v_lshlrev_b32 v82, 16, v129
    v_and_b32 v83, 0xffff0000, v129
    v_lshlrev_b32 v84, 16, v130
    v_and_b32 v85, 0xffff0000, v130
    v_lshlrev_b32 v86, 16, v131
    v_and_b32 v87, 0xffff0000, v131
    v_lshlrev_b32 v88, 16, v132
    v_and_b32 v89, 0xffff0000, v132
    v_lshlrev_b32 v90, 16, v133
    v_and_b32 v91, 0xffff0000, v133
    v_lshlrev_b32 v92, 16, v134
    v_and_b32 v93, 0xffff0000, v134
    v_lshlrev_b32 v94, 16, v135
    v_and_b32 v95, 0xffff0000, v135
    s_add_u32 s43, s36, 32768
    buffer_load_dwordx4 v[136:139], v19, s[12:15], s43 offen offset:0 sc1
    buffer_load_dwordx4 v[140:143], v19, s[12:15], s43 offen offset:1024 sc1
    s_add_u32 s43, s36, 40960
    buffer_load_dwordx4 v[144:147], v19, s[12:15], s43 offen offset:0 sc1
    buffer_load_dwordx4 v[148:151], v19, s[12:15], s43 offen offset:1024 sc1
    s_add_u32 s43, s36, 49152
    buffer_load_dwordx4 v[152:155], v19, s[12:15], s43 offen offset:0 sc1
    buffer_load_dwordx4 v[156:159], v19, s[12:15], s43 offen offset:1024 sc1
    s_add_u32 s43, s36, 57344
    buffer_load_dwordx4 v[160:163], v19, s[12:15], s43 offen offset:0 sc1
    buffer_load_dwordx4 v[164:167], v19, s[12:15], s43 offen offset:1024 sc1
    s_mov_b32 s79, 0x10000
    s_waitcnt vmcnt(0)
xs_chk:
    v_max3_u32 v24, v136, v137, v138
    v_max3_u32 v24, v24, v139, v140
    v_max3_u32 v24, v24, v141, v142
    v_max3_u32 v24, v24, v143, v144
    v_max3_u32 v24, v24, v145, v146
    v_max3_u32 v24, v24, v147, v148
    v_max3_u32 v24, v24, v149, v150
    v_max3_u32 v25, v152, v153, v154
    v_max3_u32 v25, v25, v155, v156
    v_max3_u32 v25, v25, v157, v158
    v_max3_u32 v25, v25, v159, v160
    v_max3_u32 v25, v25, v161, v162
    v_max3_u32 v25, v25, v163, v164
    v_max3_u32 v25, v25, v165, v166
    v_max3_u32 v24, v24, v151, v167
    v_max_u32 v24, v24, v25
    v_cmp_eq_u32 vcc, -1, v24
    s_nop 3
    s_cmp_eq_u64 vcc, 0
    s_cbranch_scc1 xs_ok
    s_sub_u32 s79, s79, 1
    s_cbranch_scc1 xs_ok
    s_sleep 1
    s_add_u32 s43, s36, 32768
    buffer_load_dwordx4 v[136:139], v19, s[12:15], s43 offen offset:0 sc1
    buffer_load_dwordx4 v[140:143], v19, s[12:15], s43 offen offset:1024 sc1
    s_add_u32 s43, s36, 40960
    buffer_load_dwordx4 v[144:147], v19, s[12:15], s43 offen offset:0 sc1
    buffer_load_dwordx4 v[148:151], v19, s[12:15], s43 offen offset:1024 sc1
    s_add_u32 s43, s36, 49152
    buffer_load_dwordx4 v[152:155], v19, s[12:15], s43 offen offset:0 sc1
    buffer_load_dwordx4 v[156:159], v19, s[12:15], s43 offen offset:1024 sc1
    s_add_u32 s43, s36, 57344
    buffer_load_dwordx4 v[160:163], v19, s[12:15], s43 offen offset:0 sc1
    buffer_load_dwordx4 v[164:167], v19, s[12:15], s43 offen offset:1024 sc1
    s_waitcnt vmcnt(0)
    s_branch xs_chk
xs_ok:
    v_lshlrev_b32 v96, 16, v136
    v_and_b32 v97, 0xffff0000, v136
    v_lshlrev_b32 v98, 16, v137
    v_and_b32 v99, 0xffff0000, v137
    v_lshlrev_b32 v100, 16, v138
    v_and_b32 v101, 0xffff0000, v138
    v_lshlrev_b32 v102, 16, v139
    v_and_b32 v103, 0xffff0000, v139
    v_lshlrev_b32 v104, 16, v140
    v_and_b32 v105, 0xffff0000, v140
    v_lshlrev_b32 v106, 16, v141
    v_and_b32 v107, 0xffff0000, v141
    v_lshlrev_b32 v108, 16, v142
    v_and_b32 v109, 0xffff0000, v142
    v_lshlrev_b32 v110, 16, v143
    v_and_b32 v111, 0xffff0000, v143
    v_lshlrev_b32 v48, 16, v144
    v_and_b32 v49, 0xffff0000, v144
    v_lshlrev_b32 v50, 16, v145
    v_and_b32 v51, 0xffff0000, v145
    v_lshlrev_b32 v52, 16, v146
    v_and_b32 v53, 0xffff0000, v146
    v_lshlrev_b32 v54, 16, v147
    v_and_b32 v55, 0xffff0000, v147
    v_lshlrev_b32 v56, 16, v148
    v_and_b32 v57, 0xffff0000, v148
    v_lshlrev_b32 v58, 16, v149
    v_and_b32 v59, 0xffff0000, v149
    v_lshlrev_b32 v60, 16, v150
    v_and_b32 v61, 0xffff0000, v150
    v_lshlrev_b32 v62, 16, v151
    v_and_b32 v63, 0xffff0000, v151
    v_pk_add_f32 v[96:97], v[96:97], v[48:49]
    v_pk_add_f32 v[98:99], v[98:99], v[50:51]
    v_pk_add_f32 v[100:101], v[100:101], v[52:53]
    v_pk_add_f32 v[102:103], v[102:103], v[54:55]
    v_pk_add_f32 v[104:105], v[104:105], v[56:57]
    v_pk_add_f32 v[106:107], v[106:107], v[58:59]
    v_pk_add_f32 v[108:109], v[108:109], v[60:61]
    v_pk_add_f32 v[110:111], v[110:111], v[62:63]
    v_lshlrev_b32 v48, 16, v152
    v_and_b32 v49, 0xffff0000, v152
    v_lshlrev_b32 v50, 16, v153
    v_and_b32 v51, 0xffff0000, v153
    v_lshlrev_b32 v52, 16, v154
    v_and_b32 v53, 0xffff0000, v154
    v_lshlrev_b32 v54, 16, v155
    v_and_b32 v55, 0xffff0000, v155
    v_lshlrev_b32 v56, 16, v156
    v_and_b32 v57, 0xffff0000, v156
    v_lshlrev_b32 v58, 16, v157
    v_and_b32 v59, 0xffff0000, v157
    v_lshlrev_b32 v60, 16, v158
    v_and_b32 v61, 0xffff0000, v158
    v_lshlrev_b32 v62, 16, v159
    v_and_b32 v63, 0xffff0000, v159
    v_pk_add_f32 v[96:97], v[96:97], v[48:49]
    v_pk_add_f32 v[98:99], v[98:99], v[50:51]
    v_pk_add_f32 v[100:101], v[100:101], v[52:53]
    v_pk_add_f32 v[102:103], v[102:103], v[54:55]
    v_pk_add_f32 v[104:105], v[104:105], v[56:57]
    v_pk_add_f32 v[106:107], v[106:107], v[58:59]
    v_pk_add_f32 v[108:109], v[108:109], v[60:61]
    v_pk_add_f32 v[110:111], v[110:111], v[62:63]
    v_lshlrev_b32 v48, 16, v160
    v_and_b32 v49, 0xffff0000, v160
    v_lshlrev_b32 v50, 16, v161
    v_and_b32 v51, 0xffff0000, v161
    v_lshlrev_b32 v52, 16, v162
    v_and_b32 v53, 0xffff0000, v162
    v_lshlrev_b32 v54, 16, v163
    v_and_b32 v55, 0xffff0000, v163
    v_lshlrev_b32 v56, 16, v164
    v_and_b32 v57, 0xffff0000, v164
    v_lshlrev_b32 v58, 16, v165
    v_and_b32 v59, 0xffff0000, v165
    v_lshlrev_b32 v60, 16, v166
    v_and_b32 v61, 0xffff0000, v166
    v_lshlrev_b32 v62, 16, v167
    v_and_b32 v63, 0xffff0000, v167
    v_pk_add_f32 v[96:97], v[96:97], v[48:49]
    v_pk_add_f32 v[98:99], v[98:99], v[50:51]
    v_pk_add_f32 v[100:101], v[100:101], v[52:53]
    v_pk_add_f32 v[102:103], v[102:103], v[54:55]
    v_pk_add_f32 v[104:105], v[104:105], v[56:57]
    v_pk_add_f32 v[106:107], v[106:107], v[58:59]
    v_pk_add_f32 v[108:109], v[108:109], v[60:61]
    v_pk_add_f32 v[110:111], v[110:111], v[62:63]
    v_pk_fma_f32 v[80:81], v[96:97], v[32:33], v[80:81]
    v_pk_fma_f32 v[82:83], v[98:99], v[34:35], v[82:83]
    v_pk_fma_f32 v[84:85], v[100:101], v[36:37], v[84:85]
    v_pk_fma_f32 v[86:87], v[102:103], v[38:39], v[86:87]
    v_pk_fma_f32 v[88:89], v[104:105], v[40:41], v[88:89]
    v_pk_fma_f32 v[90:91], v[106:107], v[42:43], v[90:91]
    v_pk_fma_f32 v[92:93], v[108:109], v[44:45], v[92:93]
    v_pk_fma_f32 v[94:95], v[110:111], v[46:47], v[94:95]
    v_cvt_pk_bf16_f32 v64, v80, v81
    v_cvt_pk_bf16_f32 v65, v82, v83
    v_cvt_pk_bf16_f32 v66, v84, v85
    v_cvt_pk_bf16_f32 v67, v86, v87
    v_cvt_pk_bf16_f32 v68, v88, v89
    v_cvt_pk_bf16_f32 v69, v90, v91
    v_cvt_pk_bf16_f32 v70, v92, v93
    v_cvt_pk_bf16_f32 v71, v94, v95
    buffer_store_dwordx4 v[64:67], v244, s[68:71], 0 offen
    buffer_store_dwordx4 v[68:71], v244, s[68:71], 0 offen offset:32
    s_endpgm
attn_fallback:
    s_waitcnt vmcnt(0) lgkmcnt(0)
    s_mov_b32 s42, 1
    v_mov_b32 v24, 0xff800000
    v_mov_b32 v25, 0xff800000
    v_mov_b32 v26, 0xff800000
    v_mov_b32 v27, 0xff800000
    s_mov_b32 s37, 0
attn_fb_loop:
    s_barrier
    s_add_u32 m0, s35, 0
    s_nop 0
    buffer_load_dwordx4 v14, s[4:7], s37 offen offset:0 lds
    buffer_load_dwordx4 v15, s[4:7], s37 offen offset:1024 lds
    buffer_load_dwordx4 v16, s[4:7], s37 offen offset:2048 lds
    buffer_load_dwordx4 v17, s[4:7], s37 offen offset:3072 lds
    s_waitcnt vmcnt(0)
    s_barrier
    ds_read_b128 a[128:131], v2 offset:0
    s_waitcnt lgkmcnt(0)
    v_mfma_f32_16x16x32_bf16 v[96:99], a[128:131], v[32:35], 0
    v_mfma_f32_16x16x32_bf16 v[100:103], a[128:131], v[36:39], 0
    v_mfma_f32_16x16x32_bf16 v[104:107], a[128:131], v[64:67], 0
    v_mfma_f32_16x16x32_bf16 v[108:111], a[128:131], v[68:71], 0
    ds_read_b128 a[132:135], v3 offset:0
    s_waitcnt lgkmcnt(0)
    v_mfma_f32_16x16x32_bf16 v[96:99], a[132:135], v[40:43], v[96:99]
    v_mfma_f32_16x16x32_bf16 v[100:103], a[132:135], v[44:47], v[100:103]
    v_mfma_f32_16x16x32_bf16 v[104:107], a[132:135], v[72:75], v[104:107]
    v_mfma_f32_16x16x32_bf16 v[108:111], a[132:135], v[76:79], v[108:111]
    ds_read_b128 a[136:139], v4 offset:0
    s_waitcnt lgkmcnt(0)
    v_mfma_f32_16x16x32_bf16 v[96:99], a[136:139], v[48:51], v[96:99]
    v_mfma_f32_16x16x32_bf16 v[100:103], a[136:139], v[52:55], v[100:103]
    v_mfma_f32_16x16x32_bf16 v[104:107], a[136:139], v[80:83], v[104:107]
    v_mfma_f32_16x16x32_bf16 v[108:111], a[136:139], v[84:87], v[108:111]
    ds_read_b128 a[140:143], v5 offset:0
    s_waitcnt lgkmcnt(0)
    v_mfma_f32_16x16x32_bf16 v[96:99], a[140:143], v[56:59], v[96:99]
    v_mfma_f32_16x16x32_bf16 v[100:103], a[140:143], v[60:63], v[100:103]
    v_mfma_f32_16x16x32_bf16 v[104:107], a[140:143], v[88:91], v[104:107]
    v_mfma_f32_16x16x32_bf16 v[108:111], a[140:143], v[92:95], v[108:111]
    ds_read_b128 a[128:131], v2 offset:4096
    s_waitcnt lgkmcnt(0)
    v_mfma_f32_16x16x32_bf16 v[112:115], a[128:131], v[32:35], 0
    v_mfma_f32_16x16x32_bf16 v[116:119], a[128:131], v[36:39], 0
    v_mfma_f32_16x16x32_bf16 v[120:123], a[128:131], v[64:67], 0
    v_mfma_f32_16x16x32_bf16 v[124:127], a[128:131], v[68:71], 0
    ds_read_b128 a[132:135], v3 offset:4096
    s_waitcnt lgkmcnt(0)
    v_mfma_f32_16x16x32_bf16 v[112:115], a[132:135], v[40:43], v[112:115]
    v_mfma_f32_16x16x32_bf16 v[116:119], a[132:135], v[44:47], v[116:119]
    v_mfma_f32_16x16x32_bf16 v[120:123], a[132:135], v[72:75], v[120:123]
    v_mfma_f32_16x16x32_bf16 v[124:127], a[132:135], v[76:79], v[124:127]
    ds_read_b128 a[136:139], v4 offset:4096
    s_waitcnt lgkmcnt(0)
    v_mfma_f32_16x16x32_bf16 v[112:115], a[136:139], v[48:51], v[112:115]
    v_mfma_f32_16x16x32_bf16 v[116:119], a[136:139], v[52:55], v[116:119]
    v_mfma_f32_16x16x32_bf16 v[120:123], a[136:139], v[80:83], v[120:123]
    v_mfma_f32_16x16x32_bf16 v[124:127], a[136:139], v[84:87], v[124:127]
    ds_read_b128 a[140:143], v5 offset:4096
    s_waitcnt lgkmcnt(0)
    v_mfma_f32_16x16x32_bf16 v[112:115], a[140:143], v[56:59], v[112:115]
    v_mfma_f32_16x16x32_bf16 v[116:119], a[140:143], v[60:63], v[116:119]
    v_mfma_f32_16x16x32_bf16 v[120:123], a[140:143], v[88:91], v[120:123]
    v_mfma_f32_16x16x32_bf16 v[124:127], a[140:143], v[92:95], v[124:127]
    s_nop 9
    v_max3_f32 v24, v24, v96, v97
    v_max3_f32 v24, v24, v98, v99
    v_max3_f32 v24, v24, v112, v113
    v_max3_f32 v24, v24, v114, v115
    v_max3_f32 v25, v25, v100, v101
    v_max3_f32 v25, v25, v102, v103
    v_max3_f32 v25, v25, v116, v117
    v_max3_f32 v25, v25, v118, v119
    v_max3_f32 v26, v26, v104, v105
    v_max3_f32 v26, v26, v106, v107
    v_max3_f32 v26, v26, v120, v121
    v_max3_f32 v26, v26, v122, v123
    v_max3_f32 v27, v27, v108, v109
    v_max3_f32 v27, v27, v110, v111
    v_max3_f32 v27, v27, v124, v125
    v_max3_f32 v27, v27, v126, v127
    s_nop 3
    ds_read_b128 a[128:131], v2 offset:8192
    s_waitcnt lgkmcnt(0)
    v_mfma_f32_16x16x32_bf16 v[96:99], a[128:131], v[32:35], 0
    v_mfma_f32_16x16x32_bf16 v[100:103], a[128:131], v[36:39], 0
    v_mfma_f32_16x16x32_bf16 v[104:107], a[128:131], v[64:67], 0
    v_mfma_f32_16x16x32_bf16 v[108:111], a[128:131], v[68:71], 0
    ds_read_b128 a[132:135], v3 offset:8192
    s_waitcnt lgkmcnt(0)
    v_mfma_f32_16x16x32_bf16 v[96:99], a[132:135], v[40:43], v[96:99]
    v_mfma_f32_16x16x32_bf16 v[100:103], a[132:135], v[44:47], v[100:103]
    v_mfma_f32_16x16x32_bf16 v[104:107], a[132:135], v[72:75], v[104:107]
    v_mfma_f32_16x16x32_bf16 v[108:111], a[132:135], v[76:79], v[108:111]
    ds_read_b128 a[136:139], v4 offset:8192
    s_waitcnt lgkmcnt(0)
    v_mfma_f32_16x16x32_bf16 v[96:99], a[136:139], v[48:51], v[96:99]
    v_mfma_f32_16x16x32_bf16 v[100:103], a[136:139], v[52:55], v[100:103]
    v_mfma_f32_16x16x32_bf16 v[104:107], a[136:139], v[80:83], v[104:107]
    v_mfma_f32_16x16x32_bf16 v[108:111], a[136:139], v[84:87], v[108:111]
    ds_read_b128 a[140:143], v5 offset:8192
    s_waitcnt lgkmcnt(0)
    v_mfma_f32_16x16x32_bf16 v[96:99], a[140:143], v[56:59], v[96:99]
    v_mfma_f32_16x16x32_bf16 v[100:103], a[140:143], v[60:63], v[100:103]
    v_mfma_f32_16x16x32_bf16 v[104:107], a[140:143], v[88:91], v[104:107]
    v_mfma_f32_16x16x32_bf16 v[108:111], a[140:143], v[92:95], v[108:111]
    ds_read_b128 a[128:131], v2 offset:12288
    s_waitcnt lgkmcnt(0)
    v_mfma_f32_16x16x32_bf16 v[112:115], a[128:131], v[32:35], 0
    v_mfma_f32_16x16x32_bf16 v[116:119], a[128:131], v[36:39], 0
    v_mfma_f32_16x16x32_bf16 v[120:123], a[128:131], v[64:67], 0
    v_mfma_f32_16x16x32_bf16 v[124:127], a[128:131], v[68:71], 0
    ds_read_b128 a[132:135], v3 offset:12288
    s_waitcnt lgkmcnt(0)
    v_mfma_f32_16x16x32_bf16 v[112:115], a[132:135], v[40:43], v[112:115]
    v_mfma_f32_16x16x32_bf16 v[116:119], a[132:135], v[44:47], v[116:119]
    v_mfma_f32_16x16x32_bf16 v[120:123], a[132:135], v[72:75], v[120:123]
    v_mfma_f32_16x16x32_bf16 v[124:127], a[132:135], v[76:79], v[124:127]
    ds_read_b128 a[136:139], v4 offset:12288
    s_waitcnt lgkmcnt(0)
    v_mfma_f32_16x16x32_bf16 v[112:115], a[136:139], v[48:51], v[112:115]
    v_mfma_f32_16x16x32_bf16 v[116:119], a[136:139], v[52:55], v[116:119]
    v_mfma_f32_16x16x32_bf16 v[120:123], a[136:139], v[80:83], v[120:123]
    v_mfma_f32_16x16x32_bf16 v[124:127], a[136:139], v[84:87], v[124:127]
    ds_read_b128 a[140:143], v5 offset:12288
    s_waitcnt lgkmcnt(0)
    v_mfma_f32_16x16x32_bf16 v[112:115], a[140:143], v[56:59], v[112:115]
    v_mfma_f32_16x16x32_bf16 v[116:119], a[140:143], v[60:63], v[116:119]
    v_mfma_f32_16x16x32_bf16 v[120:123], a[140:143], v[88:91], v[120:123]
    v_mfma_f32_16x16x32_bf16 v[124:127], a[140:143], v[92:95], v[124:127]
    s_nop 9
    v_max3_f32 v24, v24, v96, v97
    v_max3_f32 v24, v24, v98, v99
    v_max3_f32 v24, v24, v112, v113
    v_max3_f32 v24, v24, v114, v115
    v_max3_f32 v25, v25, v100, v101
    v_max3_f32 v25, v25, v102, v103
    v_max3_f32 v25, v25, v116, v117
    v_max3_f32 v25, v25, v118, v119
    v_max3_f32 v26, v26, v104, v105
    v_max3_f32 v26, v26, v106, v107
    v_max3_f32 v26, v26, v120, v121
    v_max3_f32 v26, v26, v122, v123
    v_max3_f32 v27, v27, v108, v109
    v_max3_f32 v27, v27, v110, v111
    v_max3_f32 v27, v27, v124, v125
    v_max3_f32 v27, v27, v126, v127
    s_nop 3
    s_add_u32 s37, s37, 16384
    s_cmp_lt_u32 s37, 0x80000
    s_cbranch_scc1 attn_fb_loop
    v_mov_b32 v28, v24
    v_mov_b32 v29, v25
    v_mov_b32 v30, v26
    v_mov_b32 v31, v27
    s_nop 0
    v_permlane16_swap_b32 v24, v28
    v_permlane16_swap_b32 v25, v29
    v_permlane16_swap_b32 v26, v30
    v_permlane16_swap_b32 v27, v31
    s_nop 0
    v_max_f32 v24, v24, v28
    v_max_f32 v25, v25, v29
    v_max_f32 v26, v26, v30
    v_max_f32 v27, v27, v31
    v_mov_b32 v28, v24
    v_mov_b32 v29, v25
    v_mov_b32 v30, v26
    v_mov_b32 v31, v27
    s_nop 0
    v_permlane32_swap_b32 v24, v28
    v_permlane32_swap_b32 v25, v29
    v_permlane32_swap_b32 v26, v30
    v_permlane32_swap_b32 v27, v31
    s_nop 0
    v_max_f32 v24, v24, v28
    v_max_f32 v25, v25, v29
    v_max_f32 v26, v26, v30
    v_max_f32 v27, v27, v31
    v_sub_f32 v160, 0, v24
    v_sub_f32 v161, 0, v24
    v_sub_f32 v162, 0, v24
    v_sub_f32 v163, 0, v24
    v_sub_f32 v164, 0, v25
    v_sub_f32 v165, 0, v25
    v_sub_f32 v166, 0, v25
    v_sub_f32 v167, 0, v25
    v_sub_f32 v168, 0, v26
    v_sub_f32 v169, 0, v26
    v_sub_f32 v170, 0, v26
    v_sub_f32 v171, 0, v26
    v_sub_f32 v172, 0, v27
    v_sub_f32 v173, 0, v27
    v_sub_f32 v174, 0, v27
    v_sub_f32 v175, 0, v27
    s_barrier
    s_add_u32 m0, s35, 65536
    s_mov_b32 s43, 0
    s_nop 0
    buffer_load_dwordx4 v18, s[8:11], s43 offen offset:0 lds
    buffer_load_dwordx4 v1, s[8:11], s43 offen offset:1024 lds
    buffer_load_dwordx4 v18, s[8:11], s43 offen offset:2048 lds
    buffer_load_dwordx4 v1, s[8:11], s43 offen offset:3072 lds
    s_add_u32 m0, s35, 81920
    s_mov_b32 s43, 16384
    s_nop 0
    buffer_load_dwordx4 v18, s[8:11], s43 offen offset:0 lds
    buffer_load_dwordx4 v1, s[8:11], s43 offen offset:1024 lds
    buffer_load_dwordx4 v18, s[8:11], s43 offen offset:2048 lds
    buffer_load_dwordx4 v1, s[8:11], s43 offen offset:3072 lds
    s_add_u32 m0, s35, 0
    s_mov_b32 s43, 0
    s_nop 0
    buffer_load_dwordx4 v14, s[4:7], s43 offen offset:0 lds
    buffer_load_dwordx4 v15, s[4:7], s43 offen offset:1024 lds
    buffer_load_dwordx4 v16, s[4:7], s43 offen offset:2048 lds
    buffer_load_dwordx4 v17, s[4:7], s43 offen offset:3072 lds
    s_add_u32 m0, s35, 16384
    s_mov_b32 s43, 16384
    s_nop 0
    buffer_load_dwordx4 v14, s[4:7], s43 offen offset:0 lds
    buffer_load_dwordx4 v15, s[4:7], s43 offen offset:1024 lds
    buffer_load_dwordx4 v16, s[4:7], s43 offen offset:2048 lds
    buffer_load_dwordx4 v17, s[4:7], s43 offen offset:3072 lds
    s_add_u32 m0, s35, 32768
    s_mov_b32 s43, 32768
    s_nop 0
    buffer_load_dwordx4 v14, s[4:7], s43 offen offset:0 lds
    buffer_load_dwordx4 v15, s[4:7], s43 offen offset:1024 lds
    buffer_load_dwordx4 v16, s[4:7], s43 offen offset:2048 lds
    buffer_load_dwordx4 v17, s[4:7], s43 offen offset:3072 lds
    s_waitcnt vmcnt(0)
    s_branch attn_go
main_done:
    s_endpgm
.section .rodata,"a"
.p2align 6
.amdhsa_kernel recurrent_scan__mha_block_cached__dense_activation_silu__prompt_kernel
  .amdhsa_next_free_vgpr 512
  .amdhsa_next_free_sgpr 102
  .amdhsa_accum_offset 256
  .amdhsa_group_segment_fixed_size 0
  .amdhsa_kernarg_size 88
  .amdhsa_user_sgpr_count 2
  .amdhsa_user_sgpr_kernarg_segment_ptr 1
  .amdhsa_system_sgpr_workgroup_id_x 1
.end_amdhsa_kernel
```
